```python
import torch

def _softmax(x, axis=-1):
    return torch.softmax(x, dim=axis)
def _gelu(x):
    return torch.nn.functional.gelu(x, approximate="tanh")
def _silu(x):
    return torch.nn.functional.silu(x)
def _sigmoid(x):
    return torch.sigmoid(x)
def _layernorm(x, axis=-1, eps=1e-5):
    m = x.mean(dim=axis, keepdim=True)
    v = x.var(dim=axis, keepdim=True, unbiased=False)
    return (x - m) / torch.sqrt(v + eps)
def _scatter_add(tgt, idx, src, axis=0):
    return tgt.clone().index_add_(axis, idx, src)
def _segment_sum(src, seg, n):
    out = torch.zeros((n,) + src.shape[1:], dtype=src.dtype)
    return out.index_add_(0, seg, src)
def _pad(x, pw):
    flat = tuple(v for pair in reversed(pw) for v in pair)
    return torch.nn.functional.pad(x, flat)

kernel_name = 'sequential_preLN__linear_kernel_hedgehog__mixer_token_mlp__prompt'

def setup_inputs():

    _w = (lambda a: (lambda t: t.to(torch.bfloat16) if t.is_floating_point() else t)(torch.as_tensor(a)))
    def _A_setup():
        B, S, D, H = 1, 2048, 576, 32
        Dh = D // H
        return {
            "x": _w((lambda *s: torch.randn(*s, dtype=torch.bfloat16) * 0.05)(B, S, D)),
            "wqkv": _w((lambda *s: torch.randn(*s, dtype=torch.bfloat16) * 0.2)(D, 3 * D)),
            "w_phi": _w((lambda *s: torch.randn(*s, dtype=torch.bfloat16) * 0.2)(H, Dh, Dh) * (Dh ** -0.5)),
            "wo": _w((lambda *s: torch.randn(*s, dtype=torch.bfloat16) * 0.05)(D, D)),
        }
    _A_in = _A_setup()

    def _B_setup():
        B, S, D, F = 1, 2048, 576, 4608
        return {
            "x": _w((lambda *s: torch.randn(*s, dtype=torch.bfloat16) * 0.05)(B, S, D)),
            "w1": _w((lambda *s: torch.randn(*s, dtype=torch.bfloat16) * 0.4)(S, F) * (S ** -0.5)),
            "b1": _w((lambda *s: torch.randn(*s, dtype=torch.bfloat16) * 12.8)(F) * 0.02),
            "w2": _w((lambda *s: torch.randn(*s, dtype=torch.bfloat16) * 0.4)(F, S) * (F ** -0.5)),
            "b2": _w((lambda *s: torch.randn(*s, dtype=torch.bfloat16) * 6.4)(S) * 0.02),
        }
    _B_in = _B_setup()

    return {
        "A_x": _A_in["x"],
        "A_wqkv": _A_in["wqkv"],
        "A_w_phi": _A_in["w_phi"],
        "A_wo": _A_in["wo"],
        "B_x": _B_in["x"],
        "B_w1": _B_in["w1"],
        "B_b1": _B_in["b1"],
        "B_w2": _B_in["w2"],
        "B_b2": _B_in["b2"],
    }

def reference(A_x, A_wqkv, A_w_phi, A_wo, B_x, B_w1, B_b1, B_w2, B_b2):
    def _A_ref(x, wqkv, w_phi, wo):
        B, S, D = x.shape
        H = 32; Dh = D // H
        qkv = (lambda x, *d: x.permute(*d))((x @ wqkv).reshape(B, S, 3, H, Dh), 2, 0, 3, 1, 4)
        q, k, v = qkv[0], qkv[1], qkv[2]
        pq = torch.einsum("bhsd,hdf->bhsf", q, w_phi)
        pk = torch.einsum("bhsd,hdf->bhsf", k, w_phi)
        phi_q = torch.concatenate([_softmax(pq, axis=-1), _softmax(-pq, axis=-1)], axis=-1)
        phi_k = torch.concatenate([_softmax(pk, axis=-1), _softmax(-pk, axis=-1)], axis=-1)
        kv = torch.einsum("bhsf,bhsd->bhfd", phi_k, v)
        z  = torch.einsum("bhsf->bhf", phi_k)
        num = torch.einsum("bhqf,bhfd->bhqd", phi_q, kv)
        den = torch.einsum("bhqf,bhf->bhq", phi_q, z)[..., None] + 1e-6
        o = num / den
        return (lambda x, *d: x.permute(*d))(o, 0, 2, 1, 3).reshape(B, S, D) @ wo

    def _B_ref(x, w1, b1, w2, b2):
        B, S, D = x.shape
        h = _layernorm(x, axis=-1)
        u = torch.einsum("bsd,sf->bdf", h, w1) + b1
        u = _gelu(u)
        y = torch.einsum("bdf,fs->bds", u, w2) + b2
        return (lambda x, *d: x.permute(*d))(y, 0, 2, 1)

    x = A_x
    h = x + _A_ref(_layernorm(x, axis=-1), A_wqkv, A_w_phi, A_wo)
    h2 = h + _B_ref(_layernorm(h, axis=-1), B_w1, B_b1, B_w2, B_b2)
    return h2
```

```asm
; @launch grid=(256,1,1) block=(512,1,1) lds=163840
.amdgcn_target "amdgcn-amd-amdhsa--gfx950"
.text
.globl sequential_preLN__linear_kernel_hedgehog__mixer_token_mlp__prompt_kernel
.type sequential_preLN__linear_kernel_hedgehog__mixer_token_mlp__prompt_kernel,@function
.p2align 8
sequential_preLN__linear_kernel_hedgehog__mixer_token_mlp__prompt_kernel:
    s_cmp_ge_u32 s2, 256
    s_cbranch_scc1 g4_end
    s_load_dwordx4 s[4:7], s[0:1], 0
    s_load_dwordx2 s[14:15], s[0:1], 16
    s_load_dwordx4 s[16:19], s[0:1], 80
    v_lshrrev_b32 v1, 6, v0
    s_nop 0
    v_readfirstlane_b32 s13, v1
    s_lshr_b32 s46, s2, 3
    s_lshl_b32 s46, s46, 13
    s_cmp_ge_u32 s46, mega_end-sequential_preLN__linear_kernel_hedgehog__mixer_token_mlp__prompt_kernel
    s_cbranch_scc1 p1_ncp_1
    s_cmp_lg_u32 s13, 7
    s_cbranch_scc1 p1_ncp_1
    s_getpc_b64 s[44:45]
p1_pc:
    s_sub_u32 s44, s44, p1_pc-sequential_preLN__linear_kernel_hedgehog__mixer_token_mlp__prompt_kernel
    s_subb_u32 s45, s45, 0
    v_and_b32 v2, 63, v0
    v_lshl_add_u32 v2, v2, 7, s46
    v_min_u32 v2, mega_end-sequential_preLN__linear_kernel_hedgehog__mixer_token_mlp__prompt_kernel-4, v2
    v_mov_b32 v5, s45
    v_add_co_u32 v4, vcc, s44, v2
    s_nop 1
    v_addc_co_u32 v5, vcc, 0, v5, vcc
    global_load_dword v214, v[4:5], off
p1_ncp_1:
    s_and_b32 s44, s2, 7
    s_lshr_b32 s45, s2, 3
    s_lshr_b32 s46, s44, 1
    s_and_b32 s44, s44, 1
    s_waitcnt lgkmcnt(0)
    s_mov_b64 s[8:9], s[18:19]
    s_mov_b32 s20, s4
    s_and_b32 s21, s5, 0xffff
    s_mov_b32 s22, 0x240000
    s_mov_b32 s23, 0x00020000
    s_mov_b32 s24, s6
    s_and_b32 s25, s7, 0xffff
    s_mov_b32 s26, 0x1e6000
    s_mov_b32 s27, 0x00020000
    s_mov_b64 s[54:55], s[14:15]
    s_mov_b64 s[40:41], s[16:17]
    s_and_b32 s14, s13, 3
    s_lshr_b32 s15, s13, 2
    s_cmp_lt_u32 s45, 16
    s_cbranch_scc1 p1_q
    s_sub_u32 s45, s45, 16
    s_lshl_b32 s10, s46, 2
    s_and_b32 s19, s45, 3
    s_add_u32 s10, s10, s19
    s_lshl_b32 s11, s44, 2
    s_lshr_b32 s19, s45, 2
    s_add_u32 s11, s11, s19
    s_cmp_lt_u32 s13, 4
    s_cbranch_scc1 p1_kc
    v_and_b32 v1, 63, v0
    v_lshrrev_b32 v2, 4, v1
    s_cmp_ge_u32 s14, 2
    s_cbranch_scc1 p1kv_helper
    s_lshl_b32 s12, s14, 6
    s_movk_i32 s17, 1152
    v_lshrrev_b32 v7, 3, v1
    v_and_b32 v8, 7, v1
    v_add_u32 v6, 0, v2
    v_xor_b32 v6, v6, v8
    v_lshlrev_b32 v6, 4, v6
    v_add3_u32 v9, v7, 0, s12
    v_mad_u32_u24 v120, v9, s17, v6
    v_add_u32 v6, 4, v2
    v_xor_b32 v6, v6, v8
    v_lshlrev_b32 v6, 4, v6
    v_add3_u32 v9, v7, 8, s12
    v_mad_u32_u24 v121, v9, s17, v6
    v_subrev_u32 v121, 1024, v121
    v_add_u32 v6, 0, v2
    v_xor_b32 v6, v6, v8
    v_lshlrev_b32 v6, 4, v6
    v_add3_u32 v9, v7, 16, s12
    v_mad_u32_u24 v122, v9, s17, v6
    v_subrev_u32 v122, 2048, v122
    v_add_u32 v6, 4, v2
    v_xor_b32 v6, v6, v8
    v_lshlrev_b32 v6, 4, v6
    v_add3_u32 v9, v7, 24, s12
    v_mad_u32_u24 v123, v9, s17, v6
    v_subrev_u32 v123, 3072, v123
    s_mul_i32 s44, s10, 147456
    s_lshl_b32 s46, s14, 13
    s_mov_b32 m0, s46
    s_nop 0
    buffer_load_dwordx4 v120, s[20:23], s44 offen offset:0 lds
    buffer_load_dwordx4 v121, s[20:23], s44 offen offset:1024 lds
    buffer_load_dwordx4 v122, s[20:23], s44 offen offset:2048 lds
    buffer_load_dwordx4 v123, s[20:23], s44 offen offset:3072 lds
    s_add_u32 m0, s46, 4096
    s_add_u32 s16, s44, 36864
    buffer_load_dwordx4 v120, s[20:23], s16 offen offset:0 lds
    buffer_load_dwordx4 v121, s[20:23], s16 offen offset:1024 lds
    buffer_load_dwordx4 v122, s[20:23], s16 offen offset:2048 lds
    buffer_load_dwordx4 v123, s[20:23], s16 offen offset:3072 lds
    s_mul_i32 s47, s14, 10240
    s_add_u32 s47, s47, 16384
    s_mul_i32 s45, s14, 110592
    s_add_u32 s48, s45, 55296
    s_movk_i32 s18, 3456
    s_mul_i32 s19, s11, 144
    s_add_u32 s19, s19, 1152
    v_mov_b32 v6, 0x40000000
    v_add_u32 v8, 0, v1
    v_mul_u32_u24 v9, 57, v8
    v_lshrrev_b32 v9, 10, v9
    v_mul_u32_u24 v124, 18, v9
    v_sub_u32 v8, v8, v124
    v_mad_u32_u24 v124, v9, s18, 0
    v_lshl_add_u32 v124, v8, 4, v124
    s_add_u32 s12, s19, 0x0
    v_add_u32 v124, s12, v124
    v_cmp_lt_u32 vcc, 8, v8
    v_add_u32 v7, 1008, v124
    s_nop 0
    v_cndmask_b32 v124, v124, v7, vcc
    s_add_u32 m0, s47, 0
    s_nop 0
    buffer_load_dwordx4 v124, s[24:27], s45 offen offset:0 lds
    s_add_u32 m0, s47, 5120
    s_nop 0
    buffer_load_dwordx4 v124, s[24:27], s48 offen offset:0 lds
    s_mov_b32 m0, s47
    v_add_u32 v8, 64, v1
    v_mul_u32_u24 v9, 57, v8
    v_lshrrev_b32 v9, 10, v9
    v_mul_u32_u24 v125, 18, v9
    v_sub_u32 v8, v8, v125
    v_mad_u32_u24 v125, v9, s18, 0
    v_lshl_add_u32 v125, v8, 4, v125
    s_add_u32 s12, s19, 0xfffffc00
    v_add_u32 v125, s12, v125
    v_cmp_lt_u32 vcc, 8, v8
    v_add_u32 v7, 1008, v125
    s_nop 0
    v_cndmask_b32 v125, v125, v7, vcc
    buffer_load_dwordx4 v125, s[24:27], s45 offen offset:1024 lds
    s_add_u32 m0, s47, 5120
    s_nop 0
    buffer_load_dwordx4 v125, s[24:27], s48 offen offset:1024 lds
    s_mov_b32 m0, s47
    v_cmp_lt_u32 s[16:17], 23, v1
    v_add_u32 v8, 128, v1
    v_subrev_u32 v7, 24, v1
    v_cndmask_b32 v8, v8, v7, s[16:17]
    v_mul_u32_u24 v9, 57, v8
    v_lshrrev_b32 v9, 10, v9
    v_mul_u32_u24 v126, 18, v9
    v_sub_u32 v8, v8, v126
    v_mad_u32_u24 v126, v9, s18, 0
    v_lshl_add_u32 v126, v8, 4, v126
    s_add_u32 s12, s19, 0xfffff800
    v_add_u32 v126, s12, v126
    v_add_u32 v7, 27648, v126
    v_cndmask_b32 v126, v126, v7, s[16:17]
    v_cmp_lt_u32 vcc, 8, v8
    v_add_u32 v7, 1008, v126
    s_nop 0
    v_cndmask_b32 v126, v126, v7, vcc
    v_cmp_lt_u32 vcc, 7, v9
    s_nop 1
    v_cndmask_b32 v126, v126, v6, vcc
    buffer_load_dwordx4 v126, s[24:27], s45 offen offset:2048 lds
    s_add_u32 m0, s47, 5120
    s_nop 0
    buffer_load_dwordx4 v126, s[24:27], s48 offen offset:2048 lds
    s_mov_b32 m0, s47
    v_add_u32 v8, 40, v1
    v_mul_u32_u24 v9, 57, v8
    v_lshrrev_b32 v9, 10, v9
    v_mul_u32_u24 v127, 18, v9
    v_sub_u32 v8, v8, v127
    v_mad_u32_u24 v127, v9, s18, 0
    v_lshl_add_u32 v127, v8, 4, v127
    s_add_u32 s12, s19, 0x6000
    v_add_u32 v127, s12, v127
    v_cmp_lt_u32 vcc, 8, v8
    v_add_u32 v7, 1008, v127
    s_nop 0
    v_cndmask_b32 v127, v127, v7, vcc
    buffer_load_dwordx4 v127, s[24:27], s45 offen offset:3072 lds
    s_add_u32 m0, s47, 5120
    s_nop 0
    buffer_load_dwordx4 v127, s[24:27], s48 offen offset:3072 lds
    s_mov_b32 m0, s47
    v_add_u32 v8, 104, v1
    v_mul_u32_u24 v9, 57, v8
    v_lshrrev_b32 v9, 10, v9
    v_mul_u32_u24 v128, 18, v9
    v_sub_u32 v8, v8, v128
    v_mad_u32_u24 v128, v9, s18, 0
    v_lshl_add_u32 v128, v8, 4, v128
    s_add_u32 s12, s19, 0x6c00
    v_add_u32 v128, s12, v128
    v_cmp_lt_u32 vcc, 8, v8
    v_add_u32 v7, 1008, v128
    s_nop 0
    v_cndmask_b32 v128, v128, v7, vcc
    v_cmp_lt_u32 vcc, 7, v9
    s_nop 1
    v_cndmask_b32 v128, v128, v6, vcc
    s_add_u32 m0, s47, 4096
    s_nop 0
    buffer_load_dwordx4 v128, s[24:27], s45 offen offset:0 lds
    s_add_u32 m0, s47, 9216
    s_nop 0
    buffer_load_dwordx4 v128, s[24:27], s48 offen offset:0 lds
    s_mov_b32 m0, s47
    s_add_u32 s44, s44, 128
    s_add_u32 s45, s45, 221184
    s_add_u32 s48, s48, 221184
    s_add_u32 s46, s46, 0x9000
    s_add_u32 s47, s47, 0x9000
    s_mov_b32 m0, s46
    s_nop 0
    buffer_load_dwordx4 v120, s[20:23], s44 offen offset:0 lds
    buffer_load_dwordx4 v121, s[20:23], s44 offen offset:1024 lds
    buffer_load_dwordx4 v122, s[20:23], s44 offen offset:2048 lds
    buffer_load_dwordx4 v123, s[20:23], s44 offen offset:3072 lds
    s_add_u32 m0, s46, 4096
    s_add_u32 s16, s44, 36864
    buffer_load_dwordx4 v120, s[20:23], s16 offen offset:0 lds
    buffer_load_dwordx4 v121, s[20:23], s16 offen offset:1024 lds
    buffer_load_dwordx4 v122, s[20:23], s16 offen offset:2048 lds
    buffer_load_dwordx4 v123, s[20:23], s16 offen offset:3072 lds
    s_add_u32 m0, s47, 0
    s_nop 0
    buffer_load_dwordx4 v124, s[24:27], s45 offen offset:0 lds
    buffer_load_dwordx4 v125, s[24:27], s45 offen offset:1024 lds
    buffer_load_dwordx4 v126, s[24:27], s45 offen offset:2048 lds
    buffer_load_dwordx4 v127, s[24:27], s45 offen offset:3072 lds
    s_add_u32 m0, s47, 4096
    s_nop 0
    buffer_load_dwordx4 v128, s[24:27], s45 offen offset:0 lds
    s_add_u32 m0, s47, 5120
    s_nop 0
    buffer_load_dwordx4 v124, s[24:27], s48 offen offset:0 lds
    buffer_load_dwordx4 v125, s[24:27], s48 offen offset:1024 lds
    buffer_load_dwordx4 v126, s[24:27], s48 offen offset:2048 lds
    buffer_load_dwordx4 v127, s[24:27], s48 offen offset:3072 lds
    s_add_u32 m0, s47, 9216
    s_nop 0
    buffer_load_dwordx4 v128, s[24:27], s48 offen offset:0 lds
    s_add_u32 s44, s44, 128
    s_add_u32 s45, s45, 221184
    s_add_u32 s48, s48, 221184
    s_add_u32 s46, s46, 0x9000
    s_add_u32 s47, s47, 0x9000
    s_waitcnt vmcnt(18)
    s_barrier
    s_mov_b32 m0, s46
    s_nop 0
    buffer_load_dwordx4 v120, s[20:23], s44 offen offset:0 lds
    buffer_load_dwordx4 v121, s[20:23], s44 offen offset:1024 lds
    buffer_load_dwordx4 v122, s[20:23], s44 offen offset:2048 lds
    buffer_load_dwordx4 v123, s[20:23], s44 offen offset:3072 lds
    s_add_u32 m0, s46, 4096
    s_add_u32 s16, s44, 36864
    buffer_load_dwordx4 v120, s[20:23], s16 offen offset:0 lds
    buffer_load_dwordx4 v121, s[20:23], s16 offen offset:1024 lds
    buffer_load_dwordx4 v122, s[20:23], s16 offen offset:2048 lds
    buffer_load_dwordx4 v123, s[20:23], s16 offen offset:3072 lds
    s_add_u32 m0, s47, 0
    s_nop 0
    buffer_load_dwordx4 v124, s[24:27], s45 offen offset:0 lds
    buffer_load_dwordx4 v125, s[24:27], s45 offen offset:1024 lds
    buffer_load_dwordx4 v126, s[24:27], s45 offen offset:2048 lds
    buffer_load_dwordx4 v127, s[24:27], s45 offen offset:3072 lds
    s_add_u32 m0, s47, 4096
    s_nop 0
    buffer_load_dwordx4 v128, s[24:27], s45 offen offset:0 lds
    s_add_u32 m0, s47, 5120
    s_nop 0
    buffer_load_dwordx4 v124, s[24:27], s48 offen offset:0 lds
    buffer_load_dwordx4 v125, s[24:27], s48 offen offset:1024 lds
    buffer_load_dwordx4 v126, s[24:27], s48 offen offset:2048 lds
    buffer_load_dwordx4 v127, s[24:27], s48 offen offset:3072 lds
    s_add_u32 m0, s47, 9216
    s_nop 0
    buffer_load_dwordx4 v128, s[24:27], s48 offen offset:0 lds
    s_add_u32 s44, s44, 128
    s_add_u32 s45, s45, 221184
    s_add_u32 s48, s48, 221184
    s_add_u32 s46, s46, 0x9000
    s_add_u32 s47, s47, 0x9000
    s_waitcnt vmcnt(18)
    s_barrier
    s_mov_b32 m0, s46
    s_nop 0
    buffer_load_dwordx4 v120, s[20:23], s44 offen offset:0 lds
    buffer_load_dwordx4 v121, s[20:23], s44 offen offset:1024 lds
    buffer_load_dwordx4 v122, s[20:23], s44 offen offset:2048 lds
    buffer_load_dwordx4 v123, s[20:23], s44 offen offset:3072 lds
    s_add_u32 m0, s46, 4096
    s_add_u32 s16, s44, 36864
    buffer_load_dwordx4 v120, s[20:23], s16 offen offset:0 lds
    buffer_load_dwordx4 v121, s[20:23], s16 offen offset:1024 lds
    buffer_load_dwordx4 v122, s[20:23], s16 offen offset:2048 lds
    buffer_load_dwordx4 v123, s[20:23], s16 offen offset:3072 lds
    s_add_u32 m0, s47, 0
    s_nop 0
    buffer_load_dwordx4 v124, s[24:27], s45 offen offset:0 lds
    buffer_load_dwordx4 v125, s[24:27], s45 offen offset:1024 lds
    buffer_load_dwordx4 v126, s[24:27], s45 offen offset:2048 lds
    buffer_load_dwordx4 v127, s[24:27], s45 offen offset:3072 lds
    s_add_u32 m0, s47, 4096
    s_nop 0
    buffer_load_dwordx4 v128, s[24:27], s45 offen offset:0 lds
    s_add_u32 m0, s47, 5120
    s_nop 0
    buffer_load_dwordx4 v124, s[24:27], s48 offen offset:0 lds
    buffer_load_dwordx4 v125, s[24:27], s48 offen offset:1024 lds
    buffer_load_dwordx4 v126, s[24:27], s48 offen offset:2048 lds
    buffer_load_dwordx4 v127, s[24:27], s48 offen offset:3072 lds
    s_add_u32 m0, s47, 9216
    s_nop 0
    buffer_load_dwordx4 v128, s[24:27], s48 offen offset:0 lds
    s_add_u32 s44, s44, 128
    s_add_u32 s45, s45, 221184
    s_add_u32 s48, s48, 221184
    s_add_u32 s46, s46, 0xfffe5000
    s_add_u32 s47, s47, 0xfffe5000
    s_mov_b32 m0, s46
    s_nop 0
    buffer_load_dwordx4 v120, s[20:23], s44 offen offset:0 lds
    buffer_load_dwordx4 v121, s[20:23], s44 offen offset:1024 lds
    buffer_load_dwordx4 v122, s[20:23], s44 offen offset:2048 lds
    buffer_load_dwordx4 v123, s[20:23], s44 offen offset:3072 lds
    s_add_u32 m0, s46, 4096
    s_add_u32 s16, s44, 36864
    buffer_load_dwordx4 v120, s[20:23], s16 offen offset:0 lds
    buffer_load_dwordx4 v121, s[20:23], s16 offen offset:1024 lds
    buffer_load_dwordx4 v122, s[20:23], s16 offen offset:2048 lds
    buffer_load_dwordx4 v123, s[20:23], s16 offen offset:3072 lds
    s_add_u32 m0, s47, 0
    s_nop 0
    buffer_load_dwordx4 v124, s[24:27], s45 offen offset:0 lds
    buffer_load_dwordx4 v125, s[24:27], s45 offen offset:1024 lds
    buffer_load_dwordx4 v126, s[24:27], s45 offen offset:2048 lds
    buffer_load_dwordx4 v127, s[24:27], s45 offen offset:3072 lds
    s_add_u32 m0, s47, 4096
    s_nop 0
    buffer_load_dwordx4 v128, s[24:27], s45 offen offset:0 lds
    s_add_u32 m0, s47, 5120
    s_nop 0
    buffer_load_dwordx4 v124, s[24:27], s48 offen offset:0 lds
    buffer_load_dwordx4 v125, s[24:27], s48 offen offset:1024 lds
    buffer_load_dwordx4 v126, s[24:27], s48 offen offset:2048 lds
    buffer_load_dwordx4 v127, s[24:27], s48 offen offset:3072 lds
    s_add_u32 m0, s47, 9216
    s_nop 0
    buffer_load_dwordx4 v128, s[24:27], s48 offen offset:0 lds
    s_add_u32 s44, s44, 128
    s_add_u32 s45, s45, 221184
    s_add_u32 s48, s48, 221184
    s_add_u32 s46, s46, 0x9000
    s_add_u32 s47, s47, 0x9000
    s_waitcnt vmcnt(36)
    s_barrier
    s_mov_b32 m0, s46
    s_nop 0
    buffer_load_dwordx4 v120, s[20:23], s44 offen offset:0 lds
    buffer_load_dwordx4 v121, s[20:23], s44 offen offset:1024 lds
    buffer_load_dwordx4 v122, s[20:23], s44 offen offset:2048 lds
    buffer_load_dwordx4 v123, s[20:23], s44 offen offset:3072 lds
    s_add_u32 m0, s46, 4096
    s_add_u32 s16, s44, 36864
    buffer_load_dwordx4 v120, s[20:23], s16 offen offset:0 lds
    buffer_load_dwordx4 v121, s[20:23], s16 offen offset:1024 lds
    buffer_load_dwordx4 v122, s[20:23], s16 offen offset:2048 lds
    buffer_load_dwordx4 v123, s[20:23], s16 offen offset:3072 lds
    s_add_u32 m0, s47, 0
    s_nop 0
    buffer_load_dwordx4 v124, s[24:27], s45 offen offset:0 lds
    buffer_load_dwordx4 v125, s[24:27], s45 offen offset:1024 lds
    buffer_load_dwordx4 v126, s[24:27], s45 offen offset:2048 lds
    buffer_load_dwordx4 v127, s[24:27], s45 offen offset:3072 lds
    s_add_u32 m0, s47, 4096
    s_nop 0
    buffer_load_dwordx4 v128, s[24:27], s45 offen offset:0 lds
    s_add_u32 m0, s47, 5120
    s_nop 0
    buffer_load_dwordx4 v124, s[24:27], s48 offen offset:0 lds
    buffer_load_dwordx4 v125, s[24:27], s48 offen offset:1024 lds
    buffer_load_dwordx4 v126, s[24:27], s48 offen offset:2048 lds
    buffer_load_dwordx4 v127, s[24:27], s48 offen offset:3072 lds
    s_add_u32 m0, s47, 9216
    s_nop 0
    buffer_load_dwordx4 v128, s[24:27], s48 offen offset:0 lds
    s_add_u32 s44, s44, 128
    s_add_u32 s45, s45, 221184
    s_add_u32 s48, s48, 221184
    s_add_u32 s46, s46, 0x9000
    s_add_u32 s47, s47, 0x9000
    s_waitcnt vmcnt(36)
    s_barrier
    s_mov_b32 m0, s46
    s_nop 0
    buffer_load_dwordx4 v120, s[20:23], s44 offen offset:0 lds
    buffer_load_dwordx4 v121, s[20:23], s44 offen offset:1024 lds
    buffer_load_dwordx4 v122, s[20:23], s44 offen offset:2048 lds
    buffer_load_dwordx4 v123, s[20:23], s44 offen offset:3072 lds
    s_add_u32 m0, s46, 4096
    s_add_u32 s16, s44, 36864
    buffer_load_dwordx4 v120, s[20:23], s16 offen offset:0 lds
    buffer_load_dwordx4 v121, s[20:23], s16 offen offset:1024 lds
    buffer_load_dwordx4 v122, s[20:23], s16 offen offset:2048 lds
    buffer_load_dwordx4 v123, s[20:23], s16 offen offset:3072 lds
    s_add_u32 m0, s47, 0
    s_nop 0
    buffer_load_dwordx4 v124, s[24:27], s45 offen offset:0 lds
    buffer_load_dwordx4 v125, s[24:27], s45 offen offset:1024 lds
    buffer_load_dwordx4 v126, s[24:27], s45 offen offset:2048 lds
    buffer_load_dwordx4 v127, s[24:27], s45 offen offset:3072 lds
    s_add_u32 m0, s47, 4096
    s_nop 0
    buffer_load_dwordx4 v128, s[24:27], s45 offen offset:0 lds
    s_add_u32 m0, s47, 5120
    s_nop 0
    buffer_load_dwordx4 v124, s[24:27], s48 offen offset:0 lds
    buffer_load_dwordx4 v125, s[24:27], s48 offen offset:1024 lds
    buffer_load_dwordx4 v126, s[24:27], s48 offen offset:2048 lds
    buffer_load_dwordx4 v127, s[24:27], s48 offen offset:3072 lds
    s_add_u32 m0, s47, 9216
    s_nop 0
    buffer_load_dwordx4 v128, s[24:27], s48 offen offset:0 lds
    s_add_u32 s44, s44, 128
    s_add_u32 s45, s45, 221184
    s_add_u32 s48, s48, 221184
    s_add_u32 s46, s46, 0x9000
    s_add_u32 s47, s47, 0x9000
    s_waitcnt vmcnt(36)
    s_barrier
    s_mov_b32 m0, s46
    s_nop 0
    buffer_load_dwordx4 v120, s[20:23], s44 offen offset:0 lds
    buffer_load_dwordx4 v121, s[20:23], s44 offen offset:1024 lds
    buffer_load_dwordx4 v122, s[20:23], s44 offen offset:2048 lds
    buffer_load_dwordx4 v123, s[20:23], s44 offen offset:3072 lds
    s_add_u32 m0, s46, 4096
    s_add_u32 s16, s44, 36864
    buffer_load_dwordx4 v120, s[20:23], s16 offen offset:0 lds
    buffer_load_dwordx4 v121, s[20:23], s16 offen offset:1024 lds
    buffer_load_dwordx4 v122, s[20:23], s16 offen offset:2048 lds
    buffer_load_dwordx4 v123, s[20:23], s16 offen offset:3072 lds
    s_add_u32 m0, s47, 0
    s_nop 0
    buffer_load_dwordx4 v124, s[24:27], s45 offen offset:0 lds
    buffer_load_dwordx4 v125, s[24:27], s45 offen offset:1024 lds
    buffer_load_dwordx4 v126, s[24:27], s45 offen offset:2048 lds
    buffer_load_dwordx4 v127, s[24:27], s45 offen offset:3072 lds
    s_add_u32 m0, s47, 4096
    s_nop 0
    buffer_load_dwordx4 v128, s[24:27], s45 offen offset:0 lds
    s_add_u32 m0, s47, 5120
    s_nop 0
    buffer_load_dwordx4 v124, s[24:27], s48 offen offset:0 lds
    buffer_load_dwordx4 v125, s[24:27], s48 offen offset:1024 lds
    buffer_load_dwordx4 v126, s[24:27], s48 offen offset:2048 lds
    buffer_load_dwordx4 v127, s[24:27], s48 offen offset:3072 lds
    s_add_u32 m0, s47, 9216
    s_nop 0
    buffer_load_dwordx4 v128, s[24:27], s48 offen offset:0 lds
    s_add_u32 s44, s44, 128
    s_add_u32 s45, s45, 221184
    s_add_u32 s48, s48, 221184
    s_add_u32 s46, s46, 0xfffe5000
    s_add_u32 s47, s47, 0xfffe5000
    s_waitcnt vmcnt(36)
    s_barrier
    s_mov_b32 m0, s46
    s_nop 0
    buffer_load_dwordx4 v120, s[20:23], s44 offen offset:0 lds
    buffer_load_dwordx4 v121, s[20:23], s44 offen offset:1024 lds
    buffer_load_dwordx4 v122, s[20:23], s44 offen offset:2048 lds
    buffer_load_dwordx4 v123, s[20:23], s44 offen offset:3072 lds
    s_add_u32 m0, s46, 4096
    s_add_u32 s16, s44, 36864
    buffer_load_dwordx4 v120, s[20:23], s16 offen offset:0 lds
    buffer_load_dwordx4 v121, s[20:23], s16 offen offset:1024 lds
    buffer_load_dwordx4 v122, s[20:23], s16 offen offset:2048 lds
    buffer_load_dwordx4 v123, s[20:23], s16 offen offset:3072 lds
    s_add_u32 m0, s47, 0
    s_nop 0
    buffer_load_dwordx4 v124, s[24:27], s45 offen offset:0 lds
    buffer_load_dwordx4 v125, s[24:27], s45 offen offset:1024 lds
    buffer_load_dwordx4 v126, s[24:27], s45 offen offset:2048 lds
    buffer_load_dwordx4 v127, s[24:27], s45 offen offset:3072 lds
    s_add_u32 m0, s47, 4096
    s_nop 0
    buffer_load_dwordx4 v128, s[24:27], s45 offen offset:0 lds
    s_add_u32 m0, s47, 5120
    s_nop 0
    buffer_load_dwordx4 v124, s[24:27], s48 offen offset:0 lds
    buffer_load_dwordx4 v125, s[24:27], s48 offen offset:1024 lds
    buffer_load_dwordx4 v126, s[24:27], s48 offen offset:2048 lds
    buffer_load_dwordx4 v127, s[24:27], s48 offen offset:3072 lds
    s_add_u32 m0, s47, 9216
    s_nop 0
    buffer_load_dwordx4 v128, s[24:27], s48 offen offset:0 lds
    s_add_u32 s44, s44, 128
    s_add_u32 s45, s45, 221184
    s_add_u32 s48, s48, 221184
    s_add_u32 s46, s46, 0x9000
    s_add_u32 s47, s47, 0x9000
    s_waitcnt vmcnt(36)
    s_barrier
    s_mov_b32 s28, s54
    s_and_b32 s29, s55, 0xffff
    s_mov_b32 s30, 0x5100
    s_mov_b32 s31, 0x00020000
    s_add_u32 s32, s8, 0x1000000
    s_addc_u32 s33, s9, 0
    s_and_b32 s33, s33, 0xffff
    s_mov_b32 s34, 0x16000
    s_mov_b32 s35, 0x00020000
    s_add_u32 s36, s8, 0xa80000
    s_addc_u32 s37, s9, 0
    s_and_b32 s37, s37, 0xffff
    s_mov_b32 s38, 0x480000
    s_mov_b32 s39, 0x00020000
    s_mov_b32 s40, s40
    s_and_b32 s41, s41, 0xffff
    s_mov_b32 s42, 0x100
    s_mov_b32 s43, 0x00020000
    s_add_u32 s96, s8, 0x10e0000
    s_addc_u32 s97, s9, 0
    s_and_b32 s97, s97, 0xffff
    s_mov_b32 s98, 0x6000
    s_mov_b32 s99, 0x00020000
    v_bfe_u32 v3, v1, 2, 2
    v_and_b32 v4, 3, v1
    v_and_b32 v5, 15, v1
    v_mov_b32 v24, 154368
    v_add_u32 v14, 0, v3
    v_lshlrev_b32 v9, 1, v2
    v_mul_u32_u24 v14, 48, v14
    v_mul_u32_u24 v8, 1728, v2
    v_add3_u32 v14, v14, v8, 0
    v_add_u32 v14, 147456, v14
    v_cmp_eq_u32 vcc, v9, v4
    s_nop 1
    v_cndmask_b32 v14, v24, v14, vcc
    v_add_u32 v15, 4, v3
    v_lshlrev_b32 v9, 1, v2
    v_mul_u32_u24 v15, 48, v15
    v_mul_u32_u24 v8, 1728, v2
    v_add3_u32 v15, v15, v8, 0
    v_add_u32 v15, 147456, v15
    v_cmp_eq_u32 vcc, v9, v4
    s_nop 1
    v_cndmask_b32 v15, v24, v15, vcc
    v_add_u32 v16, 8, v3
    v_lshlrev_b32 v9, 1, v2
    v_mul_u32_u24 v16, 48, v16
    v_mul_u32_u24 v8, 1728, v2
    v_add3_u32 v16, v16, v8, 0
    v_add_u32 v16, 147456, v16
    v_cmp_eq_u32 vcc, v9, v4
    s_nop 1
    v_cndmask_b32 v16, v24, v16, vcc
    v_add_u32 v17, 12, v3
    v_lshlrev_b32 v9, 1, v2
    v_mul_u32_u24 v17, 48, v17
    v_mul_u32_u24 v8, 1728, v2
    v_add3_u32 v17, v17, v8, 0
    v_add_u32 v17, 147456, v17
    v_cmp_eq_u32 vcc, v9, v4
    s_nop 1
    v_cndmask_b32 v17, v24, v17, vcc
    v_add_u32 v18, 16, v3
    v_cmp_lt_u32 vcc, 17, v18
    s_nop 1
    v_cndmask_b32 v8, 0, 1, vcc
    v_lshl_add_u32 v9, v2, 1, v8
    v_mul_u32_u24 v18, 48, v18
    v_mul_u32_u24 v8, 1728, v2
    v_add3_u32 v18, v18, v8, 0
    v_add_u32 v18, 147456, v18
    v_cmp_eq_u32 vcc, v9, v4
    s_nop 1
    v_cndmask_b32 v18, v24, v18, vcc
    v_add_u32 v19, 20, v3
    v_lshl_add_u32 v9, v2, 1, 1
    v_mul_u32_u24 v19, 48, v19
    v_mul_u32_u24 v8, 1728, v2
    v_add3_u32 v19, v19, v8, 0
    v_add_u32 v19, 147456, v19
    v_cmp_eq_u32 vcc, v9, v4
    s_nop 1
    v_cndmask_b32 v19, v24, v19, vcc
    v_add_u32 v20, 24, v3
    v_lshl_add_u32 v9, v2, 1, 1
    v_mul_u32_u24 v20, 48, v20
    v_mul_u32_u24 v8, 1728, v2
    v_add3_u32 v20, v20, v8, 0
    v_add_u32 v20, 147456, v20
    v_cmp_eq_u32 vcc, v9, v4
    s_nop 1
    v_cndmask_b32 v20, v24, v20, vcc
    v_add_u32 v21, 28, v3
    v_lshl_add_u32 v9, v2, 1, 1
    v_mul_u32_u24 v21, 48, v21
    v_mul_u32_u24 v8, 1728, v2
    v_add3_u32 v21, v21, v8, 0
    v_add_u32 v21, 147456, v21
    v_cmp_eq_u32 vcc, v9, v4
    s_nop 1
    v_cndmask_b32 v21, v24, v21, vcc
    v_add_u32 v22, 32, v3
    v_lshl_add_u32 v9, v2, 1, 1
    v_mul_u32_u24 v22, 48, v22
    v_mul_u32_u24 v8, 1728, v2
    v_add3_u32 v22, v22, v8, 0
    v_add_u32 v22, 147456, v22
    v_cmp_eq_u32 vcc, v9, v4
    s_nop 1
    v_cndmask_b32 v22, v24, v22, vcc
    v_mov_b32 v23, 154368
    s_mul_i32 s16, s14, 10240
    s_add_u32 s16, s16, 81920
    v_lshlrev_b32 v211, 4, v1
    v_add_u32 v211, s16, v211
    s_waitcnt vmcnt(18)
    s_barrier
    s_mul_i32 s16, s14, 9
    s_and_b32 s17, s14, 1
    s_add_u32 s16, s16, s17
    s_lshl_b32 s16, s16, 2
    v_lshl_add_u32 v9, v2, 3, v3
    v_mul_u32_u24 v161, 160, v9
    v_add_u32 v161, 40960, v161
    v_lshl_add_u32 v160, v4, 3, v161
    v_add_u32 v160, s16, v160
    v_mul_u32_u24 v162, 72, v4
    v_add_u32 v162, 32, v162
    v_min_u32 v162, 144, v162
    v_add_u32 v161, v161, v162
    v_mul_u32_u24 v162, 80, v9
    v_lshl_add_u32 v162, v4, 3, v162
    s_mul_i32 s16, s14, 10240
    v_add_u32 v162, s16, v162
    s_lshl_b32 s18, s14, 12
    s_add_u32 s18, s18, 65536
    s_lshl_b32 s16, s17, 1
    v_add_u32 v6, s16, v5
    v_mov_b32 v164, v6
    v_cmp_gt_u32 s[56:57], 16, v6
    v_cmp_gt_u32 s[58:59], 18, v164
    v_subrev_u32 v164, 15, v164
    v_mul_u32_u24 v164, 144, v164
    v_lshl_add_u32 v164, v2, 4, v164
    v_add_u32 v164, 2304, v164
    v_and_b32 v163, 1, v2
    v_lshlrev_b32 v163, 10, v163
    v_lshrrev_b32 v165, 1, v2
    v_lshl_add_u32 v163, v165, 8, v163
    v_lshl_add_u32 v163, v6, 4, v163
    v_add_u32 v163, 0, v163
    v_add_u32 v165, 0, v164
    v_cndmask_b32 v163, v165, v163, s[56:57]
    v_mov_b32 v165, 3072
    v_cndmask_b32 v163, v165, v163, s[58:59]
    v_add_u32 v166, s18, v163
    v_and_b32 v163, 1, v2
    v_lshlrev_b32 v163, 10, v163
    v_lshrrev_b32 v165, 1, v2
    v_lshl_add_u32 v163, v165, 8, v163
    v_lshl_add_u32 v163, v6, 4, v163
    v_add_u32 v163, 512, v163
    v_add_u32 v165, 64, v164
    v_cndmask_b32 v163, v165, v163, s[56:57]
    v_mov_b32 v165, 3072
    v_cndmask_b32 v163, v165, v163, s[58:59]
    v_add_u32 v167, s18, v163
    v_lshlrev_b32 v163, 4, v6
    v_add_u32 v163, 2048, v163
    v_add_u32 v165, 128, v164
    v_cndmask_b32 v163, v165, v163, s[56:57]
    v_mov_b32 v165, 3072
    v_cndmask_b32 v163, v165, v163, s[58:59]
    v_cmp_eq_u32 vcc, 0, v2
    s_nop 1
    v_cndmask_b32 v163, v165, v163, vcc
    v_add_u32 v212, s18, v163
    s_xor_b32 s16, s17, 1
    s_lshl_b32 s16, s16, 4
    v_and_b32 v6, 1, v5
    v_add_u32 v6, s16, v6
    v_lshrrev_b32 v164, 1, v5
    v_cmp_eq_u32 vcc, s14, v164
    s_nop 1
    v_cndmask_b32 v6, 31, v6, vcc
    v_cmp_eq_u32 vcc, 8, v5
    v_mov_b32 v164, 15
    s_nop 0
    v_cndmask_b32 v164, v6, v164, vcc
    v_cmp_gt_u32 s[56:57], 15, v164
    v_cmp_gt_u32 s[58:59], 18, v164
    v_subrev_u32 v164, 15, v164
    v_mul_u32_u24 v164, 144, v164
    v_lshl_add_u32 v164, v2, 4, v164
    v_add_u32 v164, 2304, v164
    v_and_b32 v163, 1, v2
    v_lshlrev_b32 v163, 10, v163
    v_lshrrev_b32 v165, 1, v2
    v_lshl_add_u32 v163, v165, 8, v163
    v_lshl_add_u32 v163, v6, 4, v163
    v_add_u32 v163, 0, v163
    v_add_u32 v165, 0, v164
    v_cndmask_b32 v163, v165, v163, s[56:57]
    v_mov_b32 v165, 3072
    v_cndmask_b32 v163, v165, v163, s[58:59]
    v_add_u32 v213, s18, v163
    v_and_b32 v163, 1, v2
    v_lshlrev_b32 v163, 10, v163
    v_lshrrev_b32 v165, 1, v2
    v_lshl_add_u32 v163, v165, 8, v163
    v_lshl_add_u32 v163, v6, 4, v163
    v_add_u32 v163, 512, v163
    v_add_u32 v165, 64, v164
    v_cndmask_b32 v163, v165, v163, s[56:57]
    v_mov_b32 v165, 3072
    v_cndmask_b32 v163, v165, v163, s[58:59]
    v_add_u32 v214, s18, v163
    v_lshlrev_b32 v163, 4, v6
    v_add_u32 v163, 2048, v163
    v_add_u32 v165, 128, v164
    v_cndmask_b32 v163, v165, v163, s[56:57]
    v_mov_b32 v165, 3072
    v_cndmask_b32 v163, v165, v163, s[58:59]
    v_cmp_eq_u32 vcc, 0, v2
    s_nop 1
    v_cndmask_b32 v163, v165, v163, vcc
    v_add_u32 v215, s18, v163
    v_lshlrev_b32 v163, 2, v1
    v_add_u32 v164, s18, v163
    v_cmp_gt_u32 vcc, 44, v1
    v_mov_b32 v165, 0x40000000
    s_nop 0
    v_cndmask_b32 v165, v165, v163, vcc
    s_waitcnt vmcnt(0)
    s_barrier
p1kv_pjoin:
    ds_read_b64_tr_b16 v[216:217], v14 offset:0
    ds_read_b64_tr_b16 v[218:219], v15 offset:0
    ds_read_b64_tr_b16 v[220:221], v14 offset:8
    ds_read_b64_tr_b16 v[222:223], v15 offset:8
    ds_read_b64_tr_b16 v[224:225], v14 offset:16
    ds_read_b64_tr_b16 v[226:227], v15 offset:16
    ds_read_b64_tr_b16 v[228:229], v14 offset:24
    ds_read_b64_tr_b16 v[230:231], v15 offset:24
    ds_read_b64_tr_b16 v[232:233], v14 offset:32
    ds_read_b64_tr_b16 v[234:235], v15 offset:32
    ds_read_b64_tr_b16 v[236:237], v16 offset:0
    ds_read_b64_tr_b16 v[238:239], v17 offset:0
    ds_read_b64_tr_b16 v[240:241], v16 offset:8
    ds_read_b64_tr_b16 v[242:243], v17 offset:8
    ds_read_b64_tr_b16 v[244:245], v16 offset:16
    ds_read_b64_tr_b16 v[246:247], v17 offset:16
    ds_read_b64_tr_b16 v[248:249], v16 offset:24
    ds_read_b64_tr_b16 v[250:251], v17 offset:24
    ds_read_b64_tr_b16 v[252:253], v16 offset:32
    ds_read_b64_tr_b16 v[254:255], v17 offset:32
    ds_read_b64_tr_b16 v[168:169], v18 offset:0
    ds_read_b64_tr_b16 v[170:171], v19 offset:0
    ds_read_b64_tr_b16 v[172:173], v18 offset:8
    ds_read_b64_tr_b16 v[174:175], v19 offset:8
    ds_read_b64_tr_b16 v[176:177], v18 offset:16
    ds_read_b64_tr_b16 v[178:179], v19 offset:16
    ds_read_b64_tr_b16 v[180:181], v18 offset:24
    ds_read_b64_tr_b16 v[182:183], v19 offset:24
    ds_read_b64_tr_b16 v[184:185], v18 offset:32
    ds_read_b64_tr_b16 v[186:187], v19 offset:32
    ds_read_b64_tr_b16 v[188:189], v20 offset:0
    ds_read_b64_tr_b16 v[190:191], v21 offset:0
    ds_read_b64_tr_b16 v[192:193], v20 offset:8
    ds_read_b64_tr_b16 v[194:195], v21 offset:8
    ds_read_b64_tr_b16 v[196:197], v20 offset:16
    ds_read_b64_tr_b16 v[198:199], v21 offset:16
    ds_read_b64_tr_b16 v[200:201], v20 offset:24
    ds_read_b64_tr_b16 v[202:203], v21 offset:24
    ds_read_b64_tr_b16 v[204:205], v20 offset:32
    ds_read_b64_tr_b16 v[206:207], v21 offset:32
    ds_read_b64_tr_b16 v[100:101], v22 offset:0
    ds_read_b64_tr_b16 v[102:103], v23 offset:0
    ds_read_b64_tr_b16 v[104:105], v22 offset:8
    ds_read_b64_tr_b16 v[106:107], v23 offset:8
    ds_read_b64_tr_b16 v[108:109], v22 offset:16
    ds_read_b64_tr_b16 v[110:111], v23 offset:16
    ds_read_b64_tr_b16 v[112:113], v22 offset:24
    ds_read_b64_tr_b16 v[114:115], v23 offset:24
    ds_read_b64_tr_b16 v[116:117], v22 offset:32
    ds_read_b64_tr_b16 v[118:119], v23 offset:32
    s_waitcnt lgkmcnt(0)
    s_barrier
    ds_read_b64 v[12:13], v211 offset:9216
    ds_read_b128 v[28:31], v211 offset:0
    ds_read_b128 v[32:35], v211 offset:1024
    ds_read_b128 v[36:39], v211 offset:2048
    ds_read_b128 v[40:43], v211 offset:3072
    ds_read_b128 v[44:47], v211 offset:4096
    ds_read_b128 v[48:51], v211 offset:5120
    ds_read_b128 v[52:55], v211 offset:6144
    ds_read_b128 v[56:59], v211 offset:7168
    ds_read_b128 v[60:63], v211 offset:8192
    s_waitcnt lgkmcnt(9)
    v_mov_b32 v8, v13
    s_nop 1
    v_permlane32_swap_b32 v13, v8
    v_add_f32 v13, v13, v8
    v_mov_b32 v8, v13
    s_nop 1
    v_permlane16_swap_b32 v13, v8
    v_add_f32 v13, v13, v8
    v_mul_f32 v12, 0x3ae38e39, v12
    v_mul_f32 v13, 0x3ae38e39, v13
    v_fma_f32 v13, -v12, v12, v13
    v_max_f32 v13, 0, v13
    v_add_f32 v13, 0x3727c5ac, v13
    v_rsq_f32 v13, v13
    s_nop 0
    v_mul_f32 v12, v12, v13
    s_mov_b32 s53, 0
    s_branch p1kv_post
p1_kc:
    v_and_b32 v1, 63, v0
    v_lshrrev_b32 v2, 4, v1
    v_bfe_u32 v3, v1, 2, 2
    v_and_b32 v4, 3, v1
    v_and_b32 v5, 15, v1
    s_mov_b32 s28, s54
    s_and_b32 s29, s55, 0xffff
    s_mov_b32 s30, 0x5100
    s_mov_b32 s31, 0x00020000
    s_add_u32 s32, s8, 0x1000000
    s_addc_u32 s33, s9, 0
    s_and_b32 s33, s33, 0xffff
    s_mov_b32 s34, 0x16000
    s_mov_b32 s35, 0x00020000
    s_add_u32 s36, s8, 0xa80000
    s_addc_u32 s37, s9, 0
    s_and_b32 s37, s37, 0xffff
    s_mov_b32 s38, 0x480000
    s_mov_b32 s39, 0x00020000
    s_mov_b32 s40, s40
    s_and_b32 s41, s41, 0xffff
    s_mov_b32 s42, 0x100
    s_mov_b32 s43, 0x00020000
    s_add_u32 s96, s8, 0x10e0000
    s_addc_u32 s97, s9, 0
    s_and_b32 s97, s97, 0xffff
    s_mov_b32 s98, 0x6000
    s_mov_b32 s99, 0x00020000
    v_and_b32 v6, 1, v2
    v_mul_u32_u24 v208, 2432, v6
    v_lshrrev_b32 v6, 1, v2
    v_mul_u32_u24 v6, 5120, v6
    v_add_u32 v208, v208, v6
    v_mul_u32_u24 v6, 288, v3
    v_mul_u32_u24 v7, 72, v4
    v_add3_u32 v208, v208, v6, v7
    v_add_u32 v208, 16384, v208
    v_lshrrev_b32 v6, 1, v5
    v_xor_b32 v6, v6, v2
    v_lshlrev_b32 v6, 4, v6
    v_lshl_add_u32 v6, v5, 7, v6
    s_lshl_b32 s16, s14, 12
    v_add_u32 v209, s16, v6
    v_xor_b32 v210, 64, v209
    s_mul_i32 s16, s14, 10240
    s_add_u32 s16, s16, 81920
    v_lshlrev_b32 v211, 4, v1
    v_add_u32 v211, s16, v211
    v_mov_b32 v28, 0
    v_mov_b32 v29, 0
    v_mov_b32 v30, 0
    v_mov_b32 v31, 0
    v_mov_b32 v32, 0
    v_mov_b32 v33, 0
    v_mov_b32 v34, 0
    v_mov_b32 v35, 0
    v_mov_b32 v36, 0
    v_mov_b32 v37, 0
    v_mov_b32 v38, 0
    v_mov_b32 v39, 0
    v_mov_b32 v40, 0
    v_mov_b32 v41, 0
    v_mov_b32 v42, 0
    v_mov_b32 v43, 0
    v_mov_b32 v44, 0
    v_mov_b32 v45, 0
    v_mov_b32 v46, 0
    v_mov_b32 v47, 0
    v_mov_b32 v48, 0
    v_mov_b32 v49, 0
    v_mov_b32 v50, 0
    v_mov_b32 v51, 0
    v_mov_b32 v52, 0
    v_mov_b32 v53, 0
    v_mov_b32 v54, 0
    v_mov_b32 v55, 0
    v_mov_b32 v56, 0
    v_mov_b32 v57, 0
    v_mov_b32 v58, 0
    v_mov_b32 v59, 0
    v_mov_b32 v60, 0
    v_mov_b32 v61, 0
    v_mov_b32 v62, 0
    v_mov_b32 v63, 0
    v_mov_b32 v64, 0
    v_mov_b32 v65, 0
    v_mov_b32 v66, 0
    v_mov_b32 v67, 0
    v_mov_b32 v68, 0
    v_mov_b32 v69, 0
    v_mov_b32 v70, 0
    v_mov_b32 v71, 0
    v_mov_b32 v72, 0
    v_mov_b32 v73, 0
    v_mov_b32 v74, 0
    v_mov_b32 v75, 0
    v_mov_b32 v76, 0
    v_mov_b32 v77, 0
    v_mov_b32 v78, 0
    v_mov_b32 v79, 0
    v_mov_b32 v80, 0
    v_mov_b32 v81, 0
    v_mov_b32 v82, 0
    v_mov_b32 v83, 0
    v_mov_b32 v84, 0
    v_mov_b32 v85, 0
    v_mov_b32 v86, 0
    v_mov_b32 v87, 0
    v_mov_b32 v88, 0
    v_mov_b32 v89, 0
    v_mov_b32 v90, 0
    v_mov_b32 v91, 0
    v_mov_b32 v92, 0
    v_mov_b32 v93, 0
    v_mov_b32 v94, 0
    v_mov_b32 v95, 0
    v_mov_b32 v96, 0
    v_mov_b32 v97, 0
    v_mov_b32 v98, 0
    v_mov_b32 v99, 0
    v_mov_b32 v100, 0
    v_mov_b32 v101, 0
    v_mov_b32 v102, 0
    v_mov_b32 v103, 0
    v_mov_b32 v104, 0
    v_mov_b32 v105, 0
    v_mov_b32 v106, 0
    v_mov_b32 v107, 0
    v_mov_b32 v108, 0
    v_mov_b32 v109, 0
    v_mov_b32 v110, 0
    v_mov_b32 v111, 0
    v_mov_b32 v112, 0
    v_mov_b32 v113, 0
    v_mov_b32 v114, 0
    v_mov_b32 v115, 0
    v_mov_b32 v116, 0x3f803f80
    v_mov_b32 v117, 0x3f803f80
    v_mov_b32 v118, 0x3f803f80
    v_mov_b32 v119, 0x3f803f80
    v_mov_b32 v24, 154368
    v_add_u32 v14, 0, v3
    v_lshlrev_b32 v9, 1, v2
    v_mul_u32_u24 v14, 48, v14
    v_mul_u32_u24 v8, 1728, v2
    v_add3_u32 v14, v14, v8, 0
    v_add_u32 v14, 147456, v14
    v_cmp_eq_u32 vcc, v9, v4
    s_nop 1
    v_cndmask_b32 v14, v24, v14, vcc
    v_add_u32 v15, 4, v3
    v_lshlrev_b32 v9, 1, v2
    v_mul_u32_u24 v15, 48, v15
    v_mul_u32_u24 v8, 1728, v2
    v_add3_u32 v15, v15, v8, 0
    v_add_u32 v15, 147456, v15
    v_cmp_eq_u32 vcc, v9, v4
    s_nop 1
    v_cndmask_b32 v15, v24, v15, vcc
    v_add_u32 v16, 8, v3
    v_lshlrev_b32 v9, 1, v2
    v_mul_u32_u24 v16, 48, v16
    v_mul_u32_u24 v8, 1728, v2
    v_add3_u32 v16, v16, v8, 0
    v_add_u32 v16, 147456, v16
    v_cmp_eq_u32 vcc, v9, v4
    s_nop 1
    v_cndmask_b32 v16, v24, v16, vcc
    v_add_u32 v17, 12, v3
    v_lshlrev_b32 v9, 1, v2
    v_mul_u32_u24 v17, 48, v17
    v_mul_u32_u24 v8, 1728, v2
    v_add3_u32 v17, v17, v8, 0
    v_add_u32 v17, 147456, v17
    v_cmp_eq_u32 vcc, v9, v4
    s_nop 1
    v_cndmask_b32 v17, v24, v17, vcc
    v_add_u32 v18, 16, v3
    v_cmp_lt_u32 vcc, 17, v18
    s_nop 1
    v_cndmask_b32 v8, 0, 1, vcc
    v_lshl_add_u32 v9, v2, 1, v8
    v_mul_u32_u24 v18, 48, v18
    v_mul_u32_u24 v8, 1728, v2
    v_add3_u32 v18, v18, v8, 0
    v_add_u32 v18, 147456, v18
    v_cmp_eq_u32 vcc, v9, v4
    s_nop 1
    v_cndmask_b32 v18, v24, v18, vcc
    v_add_u32 v19, 20, v3
    v_lshl_add_u32 v9, v2, 1, 1
    v_mul_u32_u24 v19, 48, v19
    v_mul_u32_u24 v8, 1728, v2
    v_add3_u32 v19, v19, v8, 0
    v_add_u32 v19, 147456, v19
    v_cmp_eq_u32 vcc, v9, v4
    s_nop 1
    v_cndmask_b32 v19, v24, v19, vcc
    v_add_u32 v20, 24, v3
    v_lshl_add_u32 v9, v2, 1, 1
    v_mul_u32_u24 v20, 48, v20
    v_mul_u32_u24 v8, 1728, v2
    v_add3_u32 v20, v20, v8, 0
    v_add_u32 v20, 147456, v20
    v_cmp_eq_u32 vcc, v9, v4
    s_nop 1
    v_cndmask_b32 v20, v24, v20, vcc
    v_add_u32 v21, 28, v3
    v_lshl_add_u32 v9, v2, 1, 1
    v_mul_u32_u24 v21, 48, v21
    v_mul_u32_u24 v8, 1728, v2
    v_add3_u32 v21, v21, v8, 0
    v_add_u32 v21, 147456, v21
    v_cmp_eq_u32 vcc, v9, v4
    s_nop 1
    v_cndmask_b32 v21, v24, v21, vcc
    v_add_u32 v22, 32, v3
    v_lshl_add_u32 v9, v2, 1, 1
    v_mul_u32_u24 v22, 48, v22
    v_mul_u32_u24 v8, 1728, v2
    v_add3_u32 v22, v22, v8, 0
    v_add_u32 v22, 147456, v22
    v_cmp_eq_u32 vcc, v9, v4
    s_nop 1
    v_cndmask_b32 v22, v24, v22, vcc
    v_mov_b32 v23, 154368
    v_cmp_eq_u32 s[16:17], 1, v4
    v_cmp_eq_u32 s[18:19], 2, v4
    v_cmp_eq_u32 s[56:57], 3, v4
    v_cmp_eq_u32 s[58:59], v2, v3
    s_setprio 2
    s_mov_b32 s49, 0
    s_mov_b32 s52, 36864
    s_mov_b32 s50, 0
    s_barrier
    ds_read_b128 v[156:159], v209 offset:0
    ds_read_b128 v[160:163], v209 offset:2048
    ds_read_b64_tr_b16 v[120:121], v208 offset:0
    ds_read_b64_tr_b16 v[122:123], v208 offset:1152
    ds_read_b64_tr_b16 v[124:125], v208 offset:8
    ds_read_b64_tr_b16 v[126:127], v208 offset:1160
    ds_read_b64_tr_b16 v[128:129], v208 offset:16
    ds_read_b64_tr_b16 v[130:131], v208 offset:1168
    ds_read_b64_tr_b16 v[132:133], v208 offset:24
    ds_read_b64_tr_b16 v[134:135], v208 offset:1176
    ds_read_b64_tr_b16 v[136:137], v208 offset:32
    ds_read_b64_tr_b16 v[138:139], v208 offset:1184
    ds_read_b64_tr_b16 v[140:141], v208 offset:40
    ds_read_b64_tr_b16 v[142:143], v208 offset:1192
    ds_read_b64_tr_b16 v[144:145], v208 offset:48
    ds_read_b64_tr_b16 v[146:147], v208 offset:1200
    ds_read_b64_tr_b16 v[148:149], v208 offset:56
    ds_read_b64_tr_b16 v[150:151], v208 offset:1208
    ds_read_b64_tr_b16 v[152:153], v208 offset:64
    ds_read_b64_tr_b16 v[154:155], v208 offset:1216
p1kv_cloop:
    s_waitcnt lgkmcnt(0)
    v_mfma_f32_16x16x32_bf16 v[100:103], v[116:119], v[156:159], v[100:103]
    ds_read_b128 v[200:203], v210 offset:0
    ds_read_b128 v[204:207], v210 offset:2048
    v_mfma_f32_16x16x32_bf16 v[104:107], v[156:159], v[156:159], v[104:107]
    ds_read_b64_tr_b16 v[164:165], v208 offset:10240
    ds_read_b64_tr_b16 v[166:167], v208 offset:11392
    v_mfma_f32_16x16x32_bf16 v[108:111], v[116:119], v[160:163], v[108:111]
    ds_read_b64_tr_b16 v[168:169], v208 offset:10248
    ds_read_b64_tr_b16 v[170:171], v208 offset:11400
    v_mfma_f32_16x16x32_bf16 v[112:115], v[160:163], v[160:163], v[112:115]
    ds_read_b64_tr_b16 v[172:173], v208 offset:10256
    ds_read_b64_tr_b16 v[174:175], v208 offset:11408
    v_mfma_f32_16x16x32_bf16 v[28:31], v[120:123], v[156:159], v[28:31]
    ds_read_b64_tr_b16 v[176:177], v208 offset:10264
    ds_read_b64_tr_b16 v[178:179], v208 offset:11416
    v_mfma_f32_16x16x32_bf16 v[64:67], v[120:123], v[160:163], v[64:67]
    ds_read_b64_tr_b16 v[180:181], v208 offset:10272
    ds_read_b64_tr_b16 v[182:183], v208 offset:11424
    v_mfma_f32_16x16x32_bf16 v[32:35], v[124:127], v[156:159], v[32:35]
    ds_read_b64_tr_b16 v[184:185], v208 offset:10280
    ds_read_b64_tr_b16 v[186:187], v208 offset:11432
    v_mfma_f32_16x16x32_bf16 v[68:71], v[124:127], v[160:163], v[68:71]
    ds_read_b64_tr_b16 v[188:189], v208 offset:10288
    ds_read_b64_tr_b16 v[190:191], v208 offset:11440
    v_mfma_f32_16x16x32_bf16 v[36:39], v[128:131], v[156:159], v[36:39]
    ds_read_b64_tr_b16 v[192:193], v208 offset:10296
    ds_read_b64_tr_b16 v[194:195], v208 offset:11448
    v_mfma_f32_16x16x32_bf16 v[72:75], v[128:131], v[160:163], v[72:75]
    ds_read_b64_tr_b16 v[196:197], v208 offset:10304
    ds_read_b64_tr_b16 v[198:199], v208 offset:11456
    v_mfma_f32_16x16x32_bf16 v[40:43], v[132:135], v[156:159], v[40:43]
    s_add_u32 s49, s49, 1
    s_cmp_eq_u32 s49, 4
    v_mfma_f32_16x16x32_bf16 v[76:79], v[132:135], v[160:163], v[76:79]
    s_cselect_b32 s51, 0xfffe5000, s52
    s_cselect_b32 s49, 0, s49
    v_mfma_f32_16x16x32_bf16 v[44:47], v[136:139], v[156:159], v[44:47]
    v_add_u32 v208, s51, v208
    v_add_u32 v209, s51, v209
    v_mfma_f32_16x16x32_bf16 v[80:83], v[136:139], v[160:163], v[80:83]
    v_add_u32 v210, s51, v210
    s_add_u32 s50, s50, 1
    v_mfma_f32_16x16x32_bf16 v[48:51], v[140:143], v[156:159], v[48:51]
    s_cmp_lt_u32 s50, 9
    v_mfma_f32_16x16x32_bf16 v[84:87], v[140:143], v[160:163], v[84:87]
    v_mfma_f32_16x16x32_bf16 v[52:55], v[144:147], v[156:159], v[52:55]
    v_mfma_f32_16x16x32_bf16 v[88:91], v[144:147], v[160:163], v[88:91]
    v_mfma_f32_16x16x32_bf16 v[56:59], v[148:151], v[156:159], v[56:59]
    v_mfma_f32_16x16x32_bf16 v[92:95], v[148:151], v[160:163], v[92:95]
    v_mfma_f32_16x16x32_bf16 v[60:63], v[152:155], v[156:159], v[60:63]
    v_mfma_f32_16x16x32_bf16 v[96:99], v[152:155], v[160:163], v[96:99]
    s_waitcnt lgkmcnt(0)
    v_mfma_f32_16x16x32_bf16 v[100:103], v[116:119], v[200:203], v[100:103]
    v_mfma_f32_16x16x32_bf16 v[104:107], v[200:203], v[200:203], v[104:107]
    v_mfma_f32_16x16x32_bf16 v[108:111], v[116:119], v[204:207], v[108:111]
    s_cbranch_scc0 p1kv_clast
    s_barrier
    v_mfma_f32_16x16x32_bf16 v[112:115], v[204:207], v[204:207], v[112:115]
    ds_read_b128 v[156:159], v209 offset:0
    ds_read_b128 v[160:163], v209 offset:2048
    v_mfma_f32_16x16x32_bf16 v[28:31], v[164:167], v[200:203], v[28:31]
    ds_read_b64_tr_b16 v[120:121], v208 offset:0
    ds_read_b64_tr_b16 v[122:123], v208 offset:1152
    v_mfma_f32_16x16x32_bf16 v[64:67], v[164:167], v[204:207], v[64:67]
    ds_read_b64_tr_b16 v[124:125], v208 offset:8
    ds_read_b64_tr_b16 v[126:127], v208 offset:1160
    v_mfma_f32_16x16x32_bf16 v[32:35], v[168:171], v[200:203], v[32:35]
    ds_read_b64_tr_b16 v[128:129], v208 offset:16
    ds_read_b64_tr_b16 v[130:131], v208 offset:1168
    v_mfma_f32_16x16x32_bf16 v[68:71], v[168:171], v[204:207], v[68:71]
    ds_read_b64_tr_b16 v[132:133], v208 offset:24
    ds_read_b64_tr_b16 v[134:135], v208 offset:1176
    v_mfma_f32_16x16x32_bf16 v[36:39], v[172:175], v[200:203], v[36:39]
    ds_read_b64_tr_b16 v[136:137], v208 offset:32
    ds_read_b64_tr_b16 v[138:139], v208 offset:1184
    v_mfma_f32_16x16x32_bf16 v[72:75], v[172:175], v[204:207], v[72:75]
    ds_read_b64_tr_b16 v[140:141], v208 offset:40
    ds_read_b64_tr_b16 v[142:143], v208 offset:1192
    v_mfma_f32_16x16x32_bf16 v[40:43], v[176:179], v[200:203], v[40:43]
    ds_read_b64_tr_b16 v[144:145], v208 offset:48
    ds_read_b64_tr_b16 v[146:147], v208 offset:1200
    v_mfma_f32_16x16x32_bf16 v[76:79], v[176:179], v[204:207], v[76:79]
    ds_read_b64_tr_b16 v[148:149], v208 offset:56
    ds_read_b64_tr_b16 v[150:151], v208 offset:1208
    v_mfma_f32_16x16x32_bf16 v[44:47], v[180:183], v[200:203], v[44:47]
    ds_read_b64_tr_b16 v[152:153], v208 offset:64
    ds_read_b64_tr_b16 v[154:155], v208 offset:1216
    v_mfma_f32_16x16x32_bf16 v[80:83], v[180:183], v[204:207], v[80:83]
    v_mfma_f32_16x16x32_bf16 v[48:51], v[184:187], v[200:203], v[48:51]
    v_mfma_f32_16x16x32_bf16 v[84:87], v[184:187], v[204:207], v[84:87]
    v_mfma_f32_16x16x32_bf16 v[52:55], v[188:191], v[200:203], v[52:55]
    v_mfma_f32_16x16x32_bf16 v[88:91], v[188:191], v[204:207], v[88:91]
    v_mfma_f32_16x16x32_bf16 v[56:59], v[192:195], v[200:203], v[56:59]
    v_mfma_f32_16x16x32_bf16 v[92:95], v[192:195], v[204:207], v[92:95]
    v_mfma_f32_16x16x32_bf16 v[60:63], v[196:199], v[200:203], v[60:63]
    v_mfma_f32_16x16x32_bf16 v[96:99], v[196:199], v[204:207], v[96:99]
    s_branch p1kv_cloop
p1kv_clast:
    v_mfma_f32_16x16x32_bf16 v[112:115], v[204:207], v[204:207], v[112:115]
    v_mfma_f32_16x16x32_bf16 v[28:31], v[164:167], v[200:203], v[28:31]
    v_mfma_f32_16x16x32_bf16 v[64:67], v[164:167], v[204:207], v[64:67]
    v_mfma_f32_16x16x32_bf16 v[32:35], v[168:171], v[200:203], v[32:35]
    v_mfma_f32_16x16x32_bf16 v[68:71], v[168:171], v[204:207], v[68:71]
    v_mfma_f32_16x16x32_bf16 v[36:39], v[172:175], v[200:203], v[36:39]
    v_mfma_f32_16x16x32_bf16 v[72:75], v[172:175], v[204:207], v[72:75]
    v_mfma_f32_16x16x32_bf16 v[40:43], v[176:179], v[200:203], v[40:43]
    v_mfma_f32_16x16x32_bf16 v[76:79], v[176:179], v[204:207], v[76:79]
    v_mfma_f32_16x16x32_bf16 v[44:47], v[180:183], v[200:203], v[44:47]
    v_mfma_f32_16x16x32_bf16 v[80:83], v[180:183], v[204:207], v[80:83]
    v_mfma_f32_16x16x32_bf16 v[48:51], v[184:187], v[200:203], v[48:51]
    v_mfma_f32_16x16x32_bf16 v[84:87], v[184:187], v[204:207], v[84:87]
    v_mfma_f32_16x16x32_bf16 v[52:55], v[188:191], v[200:203], v[52:55]
    v_mfma_f32_16x16x32_bf16 v[88:91], v[188:191], v[204:207], v[88:91]
    v_mfma_f32_16x16x32_bf16 v[56:59], v[192:195], v[200:203], v[56:59]
    v_mfma_f32_16x16x32_bf16 v[92:95], v[192:195], v[204:207], v[92:95]
    v_mfma_f32_16x16x32_bf16 v[60:63], v[196:199], v[200:203], v[60:63]
    v_mfma_f32_16x16x32_bf16 v[96:99], v[196:199], v[204:207], v[96:99]
    s_setprio 0
    v_cndmask_b32 v7, v112, v113, s[16:17]
    v_cndmask_b32 v7, v7, v114, s[18:19]
    v_cndmask_b32 v7, v7, v115, s[56:57]
    v_cndmask_b32 v109, 0, v7, s[58:59]
    ds_write_b64 v211, v[108:109] offset:9216
    ds_write_b128 v211, v[64:67] offset:0
    ds_write_b128 v211, v[68:71] offset:1024
    ds_write_b128 v211, v[72:75] offset:2048
    ds_write_b128 v211, v[76:79] offset:3072
    ds_write_b128 v211, v[80:83] offset:4096
    ds_write_b128 v211, v[84:87] offset:5120
    ds_write_b128 v211, v[88:91] offset:6144
    ds_write_b128 v211, v[92:95] offset:7168
    ds_write_b128 v211, v[96:99] offset:8192
    v_cndmask_b32 v7, v104, v105, s[16:17]
    v_cndmask_b32 v7, v7, v106, s[18:19]
    v_cndmask_b32 v7, v7, v107, s[56:57]
    v_cndmask_b32 v101, 0, v7, s[58:59]
    v_mov_b32 v12, v100
    v_mov_b32 v13, v101
    v_mov_b32 v8, v13
    s_nop 1
    v_permlane32_swap_b32 v13, v8
    v_add_f32 v13, v13, v8
    v_mov_b32 v8, v13
    s_nop 1
    v_permlane16_swap_b32 v13, v8
    v_add_f32 v13, v13, v8
    v_mul_f32 v12, 0x3ae38e39, v12
    v_mul_f32 v13, 0x3ae38e39, v13
    v_fma_f32 v13, -v12, v12, v13
    v_max_f32 v13, 0, v13
    v_add_f32 v13, 0x3727c5ac, v13
    v_rsq_f32 v13, v13
    s_nop 0
    v_mul_f32 v12, v12, v13
    s_waitcnt lgkmcnt(0)
    s_barrier
    s_mov_b32 s53, 1
    s_branch p1kv_post
p1kv_helper:
    s_mov_b32 s28, s54
    s_and_b32 s29, s55, 0xffff
    s_mov_b32 s30, 0x5100
    s_mov_b32 s31, 0x00020000
    s_add_u32 s32, s8, 0x1000000
    s_addc_u32 s33, s9, 0
    s_and_b32 s33, s33, 0xffff
    s_mov_b32 s34, 0x16000
    s_mov_b32 s35, 0x00020000
    s_add_u32 s36, s8, 0xa80000
    s_addc_u32 s37, s9, 0
    s_and_b32 s37, s37, 0xffff
    s_mov_b32 s38, 0x480000
    s_mov_b32 s39, 0x00020000
    s_mov_b32 s40, s40
    s_and_b32 s41, s41, 0xffff
    s_mov_b32 s42, 0x100
    s_mov_b32 s43, 0x00020000
    s_add_u32 s96, s8, 0x10e0000
    s_addc_u32 s97, s9, 0
    s_and_b32 s97, s97, 0xffff
    s_mov_b32 s98, 0x6000
    s_mov_b32 s99, 0x00020000
    s_and_b32 s48, s13, 1
    s_lshl_b32 s12, s2, 1
    s_add_u32 s12, s12, s48
    s_mul_i32 s16, s11, 2592
    s_movk_i32 s17, 7282
    v_and_b32 v24, 127, v0
    v_add_u32 v6, 0, v24
    v_mul_lo_u32 v7, v6, s17
    v_lshrrev_b32 v7, 16, v7
    v_mul_u32_u24 v7, 12, v7
    v_lshlrev_b32 v8, 2, v6
    v_add3_u32 v148, v7, v8, 0
    v_add_u32 v148, 147456, v148
    buffer_load_dword v136, v8, s[28:31], s16 offen
    v_add_u32 v6, 128, v24
    v_mul_lo_u32 v7, v6, s17
    v_lshrrev_b32 v7, 16, v7
    v_mul_u32_u24 v7, 12, v7
    v_lshlrev_b32 v8, 2, v6
    v_add3_u32 v149, v7, v8, 0
    v_add_u32 v149, 147456, v149
    buffer_load_dword v137, v8, s[28:31], s16 offen
    v_add_u32 v6, 256, v24
    v_mul_lo_u32 v7, v6, s17
    v_lshrrev_b32 v7, 16, v7
    v_mul_u32_u24 v7, 12, v7
    v_lshlrev_b32 v8, 2, v6
    v_add3_u32 v150, v7, v8, 0
    v_add_u32 v150, 147456, v150
    buffer_load_dword v138, v8, s[28:31], s16 offen
    v_add_u32 v6, 384, v24
    v_mul_lo_u32 v7, v6, s17
    v_lshrrev_b32 v7, 16, v7
    v_mul_u32_u24 v7, 12, v7
    v_lshlrev_b32 v8, 2, v6
    v_add3_u32 v151, v7, v8, 0
    v_add_u32 v151, 147456, v151
    buffer_load_dword v139, v8, s[28:31], s16 offen
    v_add_u32 v6, 512, v24
    v_mul_lo_u32 v7, v6, s17
    v_lshrrev_b32 v7, 16, v7
    v_mul_u32_u24 v7, 12, v7
    v_lshlrev_b32 v8, 2, v6
    v_add3_u32 v152, v7, v8, 0
    v_add_u32 v152, 147456, v152
    buffer_load_dword v140, v8, s[28:31], s16 offen
    v_add_u32 v6, 640, v24
    v_mul_lo_u32 v7, v6, s17
    v_lshrrev_b32 v7, 16, v7
    v_mul_u32_u24 v7, 12, v7
    v_lshlrev_b32 v8, 2, v6
    v_add3_u32 v153, v7, v8, 0
    v_add_u32 v153, 147456, v153
    v_cmp_gt_u32 vcc, 648, v6
    v_mov_b32 v9, 0x40000000
    s_nop 0
    v_cndmask_b32 v8, v9, v8, vcc
    v_mov_b32 v9, 155584
    v_cndmask_b32 v153, v9, v153, vcc
    buffer_load_dword v141, v8, s[28:31], s16 offen
    v_mov_b32 v9, 0
    v_add_u32 v6, 0, v24
    v_min_u32 v6, 143, v6
    v_mul_u32_u24 v6, 48, v6
    v_add_u32 v6, 147456, v6
    ds_write2_b32 v6, v9, v9 offset0:9 offset1:10
    ds_write_b32 v6, v9 offset:44
    v_add_u32 v6, 128, v24
    v_min_u32 v6, 143, v6
    v_mul_u32_u24 v6, 48, v6
    v_add_u32 v6, 147456, v6
    ds_write2_b32 v6, v9, v9 offset0:9 offset1:10
    ds_write_b32 v6, v9 offset:44
    v_and_b32 v6, 15, v24
    v_lshlrev_b32 v6, 2, v6
    v_add_u32 v6, 154368, v6
    ds_write_b32 v6, v9
    v_bfe_u32 v3, v1, 2, 2
    v_and_b32 v4, 3, v1
    v_and_b32 v5, 15, v1
    v_and_b32 v6, 1, v2
    v_mul_u32_u24 v208, 2432, v6
    v_lshrrev_b32 v6, 1, v2
    v_mul_u32_u24 v6, 5120, v6
    v_add_u32 v208, v208, v6
    v_mul_u32_u24 v6, 288, v3
    v_mul_u32_u24 v7, 72, v4
    v_add3_u32 v208, v208, v6, v7
    v_add_u32 v208, 16384, v208
    s_mul_i32 s16, s48, 10240
    v_add_u32 v208, s16, v208
    v_mov_b32 v9, 0x3f803f80
    v_cmp_eq_u32 vcc, 0, v5
    s_nop 1
    v_cndmask_b32 v28, 0, v9, vcc
    v_mov_b32 v29, v28
    v_mov_b32 v30, v28
    v_mov_b32 v31, v28
    v_cmp_eq_u32 vcc, 1, v5
    s_nop 1
    v_cndmask_b32 v32, 0, v9, vcc
    v_mov_b32 v33, v32
    v_mov_b32 v34, v32
    v_mov_b32 v35, v32
    v_cmp_eq_u32 vcc, 2, v5
    s_nop 1
    v_cndmask_b32 v36, 0, v9, vcc
    v_mov_b32 v37, v36
    v_mov_b32 v38, v36
    v_mov_b32 v39, v36
    v_cmp_eq_u32 vcc, 3, v5
    s_nop 1
    v_cndmask_b32 v40, 0, v9, vcc
    v_mov_b32 v41, v40
    v_mov_b32 v42, v40
    v_mov_b32 v43, v40
    v_cmp_eq_u32 vcc, 4, v5
    s_nop 1
    v_cndmask_b32 v44, 0, v9, vcc
    v_mov_b32 v45, v44
    v_mov_b32 v46, v44
    v_mov_b32 v47, v44
    v_cmp_eq_u32 vcc, 5, v5
    s_nop 1
    v_cndmask_b32 v48, 0, v9, vcc
    v_mov_b32 v49, v48
    v_mov_b32 v50, v48
    v_mov_b32 v51, v48
    v_cmp_eq_u32 vcc, 6, v5
    s_nop 1
    v_cndmask_b32 v52, 0, v9, vcc
    v_mov_b32 v53, v52
    v_mov_b32 v54, v52
    v_mov_b32 v55, v52
    v_cmp_eq_u32 vcc, 7, v5
    s_nop 1
    v_cndmask_b32 v56, 0, v9, vcc
    v_mov_b32 v57, v56
    v_mov_b32 v58, v56
    v_mov_b32 v59, v56
    v_cmp_eq_u32 vcc, 8, v5
    s_nop 1
    v_cndmask_b32 v60, 0, v9, vcc
    v_mov_b32 v61, v60
    v_mov_b32 v62, v60
    v_mov_b32 v63, v60
    v_mov_b32 v100, 0
    v_mov_b32 v101, 0
    v_mov_b32 v102, 0
    v_mov_b32 v103, 0
    s_waitcnt vmcnt(0)
    ds_write_b32 v148, v136
    ds_write_b32 v149, v137
    ds_write_b32 v150, v138
    ds_write_b32 v151, v139
    ds_write_b32 v152, v140
    ds_write_b32 v153, v141
    s_waitcnt lgkmcnt(0)
    s_barrier
    ds_read_b64_tr_b16 v[64:65], v208 offset:0
    ds_read_b64_tr_b16 v[66:67], v208 offset:1152
    ds_read_b64_tr_b16 v[68:69], v208 offset:8
    ds_read_b64_tr_b16 v[70:71], v208 offset:1160
    ds_read_b64_tr_b16 v[72:73], v208 offset:16
    ds_read_b64_tr_b16 v[74:75], v208 offset:1168
    ds_read_b64_tr_b16 v[76:77], v208 offset:24
    ds_read_b64_tr_b16 v[78:79], v208 offset:1176
    ds_read_b64_tr_b16 v[80:81], v208 offset:32
    ds_read_b64_tr_b16 v[82:83], v208 offset:1184
    ds_read_b64_tr_b16 v[84:85], v208 offset:40
    ds_read_b64_tr_b16 v[86:87], v208 offset:1192
    ds_read_b64_tr_b16 v[88:89], v208 offset:48
    ds_read_b64_tr_b16 v[90:91], v208 offset:1200
    ds_read_b64_tr_b16 v[92:93], v208 offset:56
    ds_read_b64_tr_b16 v[94:95], v208 offset:1208
    ds_read_b64_tr_b16 v[96:97], v208 offset:64
    ds_read_b64_tr_b16 v[98:99], v208 offset:1216
    v_add_u32 v208, 0x9000, v208
    s_waitcnt lgkmcnt(15)
    v_mfma_f32_16x16x32_bf16 v[100:103], v[64:67], v[28:31], v[100:103]
    s_waitcnt lgkmcnt(14)
    v_mfma_f32_16x16x32_bf16 v[100:103], v[68:71], v[32:35], v[100:103]
    s_waitcnt lgkmcnt(12)
    v_mfma_f32_16x16x32_bf16 v[100:103], v[72:75], v[36:39], v[100:103]
    s_waitcnt lgkmcnt(10)
    v_mfma_f32_16x16x32_bf16 v[100:103], v[76:79], v[40:43], v[100:103]
    s_waitcnt lgkmcnt(8)
    v_mfma_f32_16x16x32_bf16 v[100:103], v[80:83], v[44:47], v[100:103]
    s_waitcnt lgkmcnt(6)
    v_mfma_f32_16x16x32_bf16 v[100:103], v[84:87], v[48:51], v[100:103]
    s_waitcnt lgkmcnt(4)
    v_mfma_f32_16x16x32_bf16 v[100:103], v[88:91], v[52:55], v[100:103]
    s_waitcnt lgkmcnt(2)
    v_mfma_f32_16x16x32_bf16 v[100:103], v[92:95], v[56:59], v[100:103]
    s_waitcnt lgkmcnt(0)
    v_mfma_f32_16x16x32_bf16 v[100:103], v[96:99], v[60:63], v[100:103]
    s_barrier
    ds_read_b64_tr_b16 v[64:65], v208 offset:0
    ds_read_b64_tr_b16 v[66:67], v208 offset:1152
    ds_read_b64_tr_b16 v[68:69], v208 offset:8
    ds_read_b64_tr_b16 v[70:71], v208 offset:1160
    ds_read_b64_tr_b16 v[72:73], v208 offset:16
    ds_read_b64_tr_b16 v[74:75], v208 offset:1168
    ds_read_b64_tr_b16 v[76:77], v208 offset:24
    ds_read_b64_tr_b16 v[78:79], v208 offset:1176
    ds_read_b64_tr_b16 v[80:81], v208 offset:32
    ds_read_b64_tr_b16 v[82:83], v208 offset:1184
    ds_read_b64_tr_b16 v[84:85], v208 offset:40
    ds_read_b64_tr_b16 v[86:87], v208 offset:1192
    ds_read_b64_tr_b16 v[88:89], v208 offset:48
    ds_read_b64_tr_b16 v[90:91], v208 offset:1200
    ds_read_b64_tr_b16 v[92:93], v208 offset:56
    ds_read_b64_tr_b16 v[94:95], v208 offset:1208
    ds_read_b64_tr_b16 v[96:97], v208 offset:64
    ds_read_b64_tr_b16 v[98:99], v208 offset:1216
    v_add_u32 v208, 0x9000, v208
    s_waitcnt lgkmcnt(15)
    v_mfma_f32_16x16x32_bf16 v[100:103], v[64:67], v[28:31], v[100:103]
    s_waitcnt lgkmcnt(14)
    v_mfma_f32_16x16x32_bf16 v[100:103], v[68:71], v[32:35], v[100:103]
    s_waitcnt lgkmcnt(12)
    v_mfma_f32_16x16x32_bf16 v[100:103], v[72:75], v[36:39], v[100:103]
    s_waitcnt lgkmcnt(10)
    v_mfma_f32_16x16x32_bf16 v[100:103], v[76:79], v[40:43], v[100:103]
    s_waitcnt lgkmcnt(8)
    v_mfma_f32_16x16x32_bf16 v[100:103], v[80:83], v[44:47], v[100:103]
    s_waitcnt lgkmcnt(6)
    v_mfma_f32_16x16x32_bf16 v[100:103], v[84:87], v[48:51], v[100:103]
    s_waitcnt lgkmcnt(4)
    v_mfma_f32_16x16x32_bf16 v[100:103], v[88:91], v[52:55], v[100:103]
    s_waitcnt lgkmcnt(2)
    v_mfma_f32_16x16x32_bf16 v[100:103], v[92:95], v[56:59], v[100:103]
    s_waitcnt lgkmcnt(0)
    v_mfma_f32_16x16x32_bf16 v[100:103], v[96:99], v[60:63], v[100:103]
    v_mov_b32 v24, 154368
    v_add_u32 v14, 0, v3
    v_lshlrev_b32 v9, 1, v2
    v_mul_u32_u24 v14, 48, v14
    v_mul_u32_u24 v8, 1728, v2
    v_add3_u32 v14, v14, v8, 0
    v_add_u32 v14, 147456, v14
    v_cmp_eq_u32 vcc, v9, v4
    s_nop 1
    v_cndmask_b32 v14, v24, v14, vcc
    v_add_u32 v15, 4, v3
    v_lshlrev_b32 v9, 1, v2
    v_mul_u32_u24 v15, 48, v15
    v_mul_u32_u24 v8, 1728, v2
    v_add3_u32 v15, v15, v8, 0
    v_add_u32 v15, 147456, v15
    v_cmp_eq_u32 vcc, v9, v4
    s_nop 1
    v_cndmask_b32 v15, v24, v15, vcc
    v_add_u32 v16, 8, v3
    v_lshlrev_b32 v9, 1, v2
    v_mul_u32_u24 v16, 48, v16
    v_mul_u32_u24 v8, 1728, v2
    v_add3_u32 v16, v16, v8, 0
    v_add_u32 v16, 147456, v16
    v_cmp_eq_u32 vcc, v9, v4
    s_nop 1
    v_cndmask_b32 v16, v24, v16, vcc
    v_add_u32 v17, 12, v3
    v_lshlrev_b32 v9, 1, v2
    v_mul_u32_u24 v17, 48, v17
    v_mul_u32_u24 v8, 1728, v2
    v_add3_u32 v17, v17, v8, 0
    v_add_u32 v17, 147456, v17
    v_cmp_eq_u32 vcc, v9, v4
    s_nop 1
    v_cndmask_b32 v17, v24, v17, vcc
    v_add_u32 v18, 16, v3
    v_cmp_lt_u32 vcc, 17, v18
    s_nop 1
    v_cndmask_b32 v8, 0, 1, vcc
    v_lshl_add_u32 v9, v2, 1, v8
    v_mul_u32_u24 v18, 48, v18
    v_mul_u32_u24 v8, 1728, v2
    v_add3_u32 v18, v18, v8, 0
    v_add_u32 v18, 147456, v18
    v_cmp_eq_u32 vcc, v9, v4
    s_nop 1
    v_cndmask_b32 v18, v24, v18, vcc
    v_add_u32 v19, 20, v3
    v_lshl_add_u32 v9, v2, 1, 1
    v_mul_u32_u24 v19, 48, v19
    v_mul_u32_u24 v8, 1728, v2
    v_add3_u32 v19, v19, v8, 0
    v_add_u32 v19, 147456, v19
    v_cmp_eq_u32 vcc, v9, v4
    s_nop 1
    v_cndmask_b32 v19, v24, v19, vcc
    v_add_u32 v20, 24, v3
    v_lshl_add_u32 v9, v2, 1, 1
    v_mul_u32_u24 v20, 48, v20
    v_mul_u32_u24 v8, 1728, v2
    v_add3_u32 v20, v20, v8, 0
    v_add_u32 v20, 147456, v20
    v_cmp_eq_u32 vcc, v9, v4
    s_nop 1
    v_cndmask_b32 v20, v24, v20, vcc
    v_add_u32 v21, 28, v3
    v_lshl_add_u32 v9, v2, 1, 1
    v_mul_u32_u24 v21, 48, v21
    v_mul_u32_u24 v8, 1728, v2
    v_add3_u32 v21, v21, v8, 0
    v_add_u32 v21, 147456, v21
    v_cmp_eq_u32 vcc, v9, v4
    s_nop 1
    v_cndmask_b32 v21, v24, v21, vcc
    v_add_u32 v22, 32, v3
    v_lshl_add_u32 v9, v2, 1, 1
    v_mul_u32_u24 v22, 48, v22
    v_mul_u32_u24 v8, 1728, v2
    v_add3_u32 v22, v22, v8, 0
    v_add_u32 v22, 147456, v22
    v_cmp_eq_u32 vcc, v9, v4
    s_nop 1
    v_cndmask_b32 v22, v24, v22, vcc
    v_mov_b32 v23, 154368
    s_mul_i32 s16, s14, 10240
    s_add_u32 s16, s16, 81920
    v_lshlrev_b32 v211, 4, v1
    v_add_u32 v211, s16, v211
    s_barrier
    ds_read_b64_tr_b16 v[64:65], v208 offset:0
    ds_read_b64_tr_b16 v[66:67], v208 offset:1152
    ds_read_b64_tr_b16 v[68:69], v208 offset:8
    ds_read_b64_tr_b16 v[70:71], v208 offset:1160
    ds_read_b64_tr_b16 v[72:73], v208 offset:16
    ds_read_b64_tr_b16 v[74:75], v208 offset:1168
    ds_read_b64_tr_b16 v[76:77], v208 offset:24
    ds_read_b64_tr_b16 v[78:79], v208 offset:1176
    ds_read_b64_tr_b16 v[80:81], v208 offset:32
    ds_read_b64_tr_b16 v[82:83], v208 offset:1184
    ds_read_b64_tr_b16 v[84:85], v208 offset:40
    ds_read_b64_tr_b16 v[86:87], v208 offset:1192
    ds_read_b64_tr_b16 v[88:89], v208 offset:48
    ds_read_b64_tr_b16 v[90:91], v208 offset:1200
    ds_read_b64_tr_b16 v[92:93], v208 offset:56
    ds_read_b64_tr_b16 v[94:95], v208 offset:1208
    ds_read_b64_tr_b16 v[96:97], v208 offset:64
    ds_read_b64_tr_b16 v[98:99], v208 offset:1216
    v_add_u32 v208, 0x9000, v208
    s_waitcnt lgkmcnt(15)
    v_mfma_f32_16x16x32_bf16 v[100:103], v[64:67], v[28:31], v[100:103]
    s_waitcnt lgkmcnt(14)
    v_mfma_f32_16x16x32_bf16 v[100:103], v[68:71], v[32:35], v[100:103]
    s_waitcnt lgkmcnt(12)
    v_mfma_f32_16x16x32_bf16 v[100:103], v[72:75], v[36:39], v[100:103]
    s_waitcnt lgkmcnt(10)
    v_mfma_f32_16x16x32_bf16 v[100:103], v[76:79], v[40:43], v[100:103]
    s_waitcnt lgkmcnt(8)
    v_mfma_f32_16x16x32_bf16 v[100:103], v[80:83], v[44:47], v[100:103]
    s_waitcnt lgkmcnt(6)
    v_mfma_f32_16x16x32_bf16 v[100:103], v[84:87], v[48:51], v[100:103]
    s_waitcnt lgkmcnt(4)
    v_mfma_f32_16x16x32_bf16 v[100:103], v[88:91], v[52:55], v[100:103]
    s_waitcnt lgkmcnt(2)
    v_mfma_f32_16x16x32_bf16 v[100:103], v[92:95], v[56:59], v[100:103]
    s_waitcnt lgkmcnt(0)
    v_mfma_f32_16x16x32_bf16 v[100:103], v[96:99], v[60:63], v[100:103]
    s_mul_i32 s16, s14, 9
    s_and_b32 s17, s14, 1
    s_add_u32 s16, s16, s17
    s_lshl_b32 s16, s16, 2
    v_lshl_add_u32 v9, v2, 3, v3
    v_mul_u32_u24 v161, 160, v9
    v_add_u32 v161, 40960, v161
    v_lshl_add_u32 v160, v4, 3, v161
    v_add_u32 v160, s16, v160
    v_mul_u32_u24 v162, 72, v4
    v_add_u32 v162, 32, v162
    v_min_u32 v162, 144, v162
    v_add_u32 v161, v161, v162
    v_mul_u32_u24 v162, 80, v9
    v_lshl_add_u32 v162, v4, 3, v162
    s_mul_i32 s16, s14, 10240
    v_add_u32 v162, s16, v162
    s_lshl_b32 s18, s14, 12
    s_add_u32 s18, s18, 65536
    s_lshl_b32 s16, s17, 1
    v_add_u32 v6, s16, v5
    v_mov_b32 v164, v6
    v_cmp_gt_u32 s[56:57], 16, v6
    v_cmp_gt_u32 s[58:59], 18, v164
    v_subrev_u32 v164, 15, v164
    v_mul_u32_u24 v164, 144, v164
    v_lshl_add_u32 v164, v2, 4, v164
    v_add_u32 v164, 2304, v164
    v_and_b32 v163, 1, v2
    v_lshlrev_b32 v163, 10, v163
    v_lshrrev_b32 v165, 1, v2
    v_lshl_add_u32 v163, v165, 8, v163
    v_lshl_add_u32 v163, v6, 4, v163
    v_add_u32 v163, 0, v163
    v_add_u32 v165, 0, v164
    v_cndmask_b32 v163, v165, v163, s[56:57]
    v_mov_b32 v165, 3072
    v_cndmask_b32 v163, v165, v163, s[58:59]
    v_add_u32 v166, s18, v163
    v_and_b32 v163, 1, v2
    v_lshlrev_b32 v163, 10, v163
    v_lshrrev_b32 v165, 1, v2
    v_lshl_add_u32 v163, v165, 8, v163
    v_lshl_add_u32 v163, v6, 4, v163
    v_add_u32 v163, 512, v163
    v_add_u32 v165, 64, v164
    v_cndmask_b32 v163, v165, v163, s[56:57]
    v_mov_b32 v165, 3072
    v_cndmask_b32 v163, v165, v163, s[58:59]
    v_add_u32 v167, s18, v163
    v_lshlrev_b32 v163, 4, v6
    v_add_u32 v163, 2048, v163
    v_add_u32 v165, 128, v164
    v_cndmask_b32 v163, v165, v163, s[56:57]
    v_mov_b32 v165, 3072
    v_cndmask_b32 v163, v165, v163, s[58:59]
    v_cmp_eq_u32 vcc, 0, v2
    s_nop 1
    v_cndmask_b32 v163, v165, v163, vcc
    v_add_u32 v212, s18, v163
    s_xor_b32 s16, s17, 1
    s_lshl_b32 s16, s16, 4
    v_and_b32 v6, 1, v5
    v_add_u32 v6, s16, v6
    v_lshrrev_b32 v164, 1, v5
    v_cmp_eq_u32 vcc, s14, v164
    s_nop 1
    v_cndmask_b32 v6, 31, v6, vcc
    v_cmp_eq_u32 vcc, 8, v5
    v_mov_b32 v164, 15
    s_nop 0
    v_cndmask_b32 v164, v6, v164, vcc
    v_cmp_gt_u32 s[56:57], 15, v164
    v_cmp_gt_u32 s[58:59], 18, v164
    v_subrev_u32 v164, 15, v164
    v_mul_u32_u24 v164, 144, v164
    v_lshl_add_u32 v164, v2, 4, v164
    v_add_u32 v164, 2304, v164
    v_and_b32 v163, 1, v2
    v_lshlrev_b32 v163, 10, v163
    v_lshrrev_b32 v165, 1, v2
    v_lshl_add_u32 v163, v165, 8, v163
    v_lshl_add_u32 v163, v6, 4, v163
    v_add_u32 v163, 0, v163
    v_add_u32 v165, 0, v164
    v_cndmask_b32 v163, v165, v163, s[56:57]
    v_mov_b32 v165, 3072
    v_cndmask_b32 v163, v165, v163, s[58:59]
    v_add_u32 v213, s18, v163
    v_and_b32 v163, 1, v2
    v_lshlrev_b32 v163, 10, v163
    v_lshrrev_b32 v165, 1, v2
    v_lshl_add_u32 v163, v165, 8, v163
    v_lshl_add_u32 v163, v6, 4, v163
    v_add_u32 v163, 512, v163
    v_add_u32 v165, 64, v164
    v_cndmask_b32 v163, v165, v163, s[56:57]
    v_mov_b32 v165, 3072
    v_cndmask_b32 v163, v165, v163, s[58:59]
    v_add_u32 v214, s18, v163
    v_lshlrev_b32 v163, 4, v6
    v_add_u32 v163, 2048, v163
    v_add_u32 v165, 128, v164
    v_cndmask_b32 v163, v165, v163, s[56:57]
    v_mov_b32 v165, 3072
    v_cndmask_b32 v163, v165, v163, s[58:59]
    v_cmp_eq_u32 vcc, 0, v2
    s_nop 1
    v_cndmask_b32 v163, v165, v163, vcc
    v_add_u32 v215, s18, v163
    v_lshlrev_b32 v163, 2, v1
    v_add_u32 v164, s18, v163
    v_cmp_gt_u32 vcc, 44, v1
    v_mov_b32 v165, 0x40000000
    s_nop 0
    v_cndmask_b32 v165, v165, v163, vcc
    s_barrier
    ds_read_b64_tr_b16 v[64:65], v208 offset:0
    ds_read_b64_tr_b16 v[66:67], v208 offset:1152
    ds_read_b64_tr_b16 v[68:69], v208 offset:8
    ds_read_b64_tr_b16 v[70:71], v208 offset:1160
    ds_read_b64_tr_b16 v[72:73], v208 offset:16
    ds_read_b64_tr_b16 v[74:75], v208 offset:1168
    ds_read_b64_tr_b16 v[76:77], v208 offset:24
    ds_read_b64_tr_b16 v[78:79], v208 offset:1176
    ds_read_b64_tr_b16 v[80:81], v208 offset:32
    ds_read_b64_tr_b16 v[82:83], v208 offset:1184
    ds_read_b64_tr_b16 v[84:85], v208 offset:40
    ds_read_b64_tr_b16 v[86:87], v208 offset:1192
    ds_read_b64_tr_b16 v[88:89], v208 offset:48
    ds_read_b64_tr_b16 v[90:91], v208 offset:1200
    ds_read_b64_tr_b16 v[92:93], v208 offset:56
    ds_read_b64_tr_b16 v[94:95], v208 offset:1208
    ds_read_b64_tr_b16 v[96:97], v208 offset:64
    ds_read_b64_tr_b16 v[98:99], v208 offset:1216
    v_add_u32 v208, 0xfffe5000, v208
    s_waitcnt lgkmcnt(15)
    v_mfma_f32_16x16x32_bf16 v[100:103], v[64:67], v[28:31], v[100:103]
    s_waitcnt lgkmcnt(14)
    v_mfma_f32_16x16x32_bf16 v[100:103], v[68:71], v[32:35], v[100:103]
    s_waitcnt lgkmcnt(12)
    v_mfma_f32_16x16x32_bf16 v[100:103], v[72:75], v[36:39], v[100:103]
    s_waitcnt lgkmcnt(10)
    v_mfma_f32_16x16x32_bf16 v[100:103], v[76:79], v[40:43], v[100:103]
    s_waitcnt lgkmcnt(8)
    v_mfma_f32_16x16x32_bf16 v[100:103], v[80:83], v[44:47], v[100:103]
    s_waitcnt lgkmcnt(6)
    v_mfma_f32_16x16x32_bf16 v[100:103], v[84:87], v[48:51], v[100:103]
    s_waitcnt lgkmcnt(4)
    v_mfma_f32_16x16x32_bf16 v[100:103], v[88:91], v[52:55], v[100:103]
    s_waitcnt lgkmcnt(2)
    v_mfma_f32_16x16x32_bf16 v[100:103], v[92:95], v[56:59], v[100:103]
    s_waitcnt lgkmcnt(0)
    v_mfma_f32_16x16x32_bf16 v[100:103], v[96:99], v[60:63], v[100:103]
    s_barrier
    ds_read_b64_tr_b16 v[64:65], v208 offset:0
    ds_read_b64_tr_b16 v[66:67], v208 offset:1152
    ds_read_b64_tr_b16 v[68:69], v208 offset:8
    ds_read_b64_tr_b16 v[70:71], v208 offset:1160
    ds_read_b64_tr_b16 v[72:73], v208 offset:16
    ds_read_b64_tr_b16 v[74:75], v208 offset:1168
    ds_read_b64_tr_b16 v[76:77], v208 offset:24
    ds_read_b64_tr_b16 v[78:79], v208 offset:1176
    ds_read_b64_tr_b16 v[80:81], v208 offset:32
    ds_read_b64_tr_b16 v[82:83], v208 offset:1184
    ds_read_b64_tr_b16 v[84:85], v208 offset:40
    ds_read_b64_tr_b16 v[86:87], v208 offset:1192
    ds_read_b64_tr_b16 v[88:89], v208 offset:48
    ds_read_b64_tr_b16 v[90:91], v208 offset:1200
    ds_read_b64_tr_b16 v[92:93], v208 offset:56
    ds_read_b64_tr_b16 v[94:95], v208 offset:1208
    ds_read_b64_tr_b16 v[96:97], v208 offset:64
    ds_read_b64_tr_b16 v[98:99], v208 offset:1216
    v_add_u32 v208, 0x9000, v208
    s_waitcnt lgkmcnt(15)
    v_mfma_f32_16x16x32_bf16 v[100:103], v[64:67], v[28:31], v[100:103]
    s_waitcnt lgkmcnt(14)
    v_mfma_f32_16x16x32_bf16 v[100:103], v[68:71], v[32:35], v[100:103]
    s_waitcnt lgkmcnt(12)
    v_mfma_f32_16x16x32_bf16 v[100:103], v[72:75], v[36:39], v[100:103]
    s_waitcnt lgkmcnt(10)
    v_mfma_f32_16x16x32_bf16 v[100:103], v[76:79], v[40:43], v[100:103]
    s_waitcnt lgkmcnt(8)
    v_mfma_f32_16x16x32_bf16 v[100:103], v[80:83], v[44:47], v[100:103]
    s_waitcnt lgkmcnt(6)
    v_mfma_f32_16x16x32_bf16 v[100:103], v[84:87], v[48:51], v[100:103]
    s_waitcnt lgkmcnt(4)
    v_mfma_f32_16x16x32_bf16 v[100:103], v[88:91], v[52:55], v[100:103]
    s_waitcnt lgkmcnt(2)
    v_mfma_f32_16x16x32_bf16 v[100:103], v[92:95], v[56:59], v[100:103]
    s_waitcnt lgkmcnt(0)
    v_mfma_f32_16x16x32_bf16 v[100:103], v[96:99], v[60:63], v[100:103]
    s_barrier
    ds_read_b64_tr_b16 v[64:65], v208 offset:0
    ds_read_b64_tr_b16 v[66:67], v208 offset:1152
    ds_read_b64_tr_b16 v[68:69], v208 offset:8
    ds_read_b64_tr_b16 v[70:71], v208 offset:1160
    ds_read_b64_tr_b16 v[72:73], v208 offset:16
    ds_read_b64_tr_b16 v[74:75], v208 offset:1168
    ds_read_b64_tr_b16 v[76:77], v208 offset:24
    ds_read_b64_tr_b16 v[78:79], v208 offset:1176
    ds_read_b64_tr_b16 v[80:81], v208 offset:32
    ds_read_b64_tr_b16 v[82:83], v208 offset:1184
    ds_read_b64_tr_b16 v[84:85], v208 offset:40
    ds_read_b64_tr_b16 v[86:87], v208 offset:1192
    ds_read_b64_tr_b16 v[88:89], v208 offset:48
    ds_read_b64_tr_b16 v[90:91], v208 offset:1200
    ds_read_b64_tr_b16 v[92:93], v208 offset:56
    ds_read_b64_tr_b16 v[94:95], v208 offset:1208
    ds_read_b64_tr_b16 v[96:97], v208 offset:64
    ds_read_b64_tr_b16 v[98:99], v208 offset:1216
    v_add_u32 v208, 0x9000, v208
    s_waitcnt lgkmcnt(15)
    v_mfma_f32_16x16x32_bf16 v[100:103], v[64:67], v[28:31], v[100:103]
    s_waitcnt lgkmcnt(14)
    v_mfma_f32_16x16x32_bf16 v[100:103], v[68:71], v[32:35], v[100:103]
    s_waitcnt lgkmcnt(12)
    v_mfma_f32_16x16x32_bf16 v[100:103], v[72:75], v[36:39], v[100:103]
    s_waitcnt lgkmcnt(10)
    v_mfma_f32_16x16x32_bf16 v[100:103], v[76:79], v[40:43], v[100:103]
    s_waitcnt lgkmcnt(8)
    v_mfma_f32_16x16x32_bf16 v[100:103], v[80:83], v[44:47], v[100:103]
    s_waitcnt lgkmcnt(6)
    v_mfma_f32_16x16x32_bf16 v[100:103], v[84:87], v[48:51], v[100:103]
    s_waitcnt lgkmcnt(4)
    v_mfma_f32_16x16x32_bf16 v[100:103], v[88:91], v[52:55], v[100:103]
    s_waitcnt lgkmcnt(2)
    v_mfma_f32_16x16x32_bf16 v[100:103], v[92:95], v[56:59], v[100:103]
    s_waitcnt lgkmcnt(0)
    v_mfma_f32_16x16x32_bf16 v[100:103], v[96:99], v[60:63], v[100:103]
    s_barrier
    ds_read_b64_tr_b16 v[64:65], v208 offset:0
    ds_read_b64_tr_b16 v[66:67], v208 offset:1152
    ds_read_b64_tr_b16 v[68:69], v208 offset:8
    ds_read_b64_tr_b16 v[70:71], v208 offset:1160
    ds_read_b64_tr_b16 v[72:73], v208 offset:16
    ds_read_b64_tr_b16 v[74:75], v208 offset:1168
    ds_read_b64_tr_b16 v[76:77], v208 offset:24
    ds_read_b64_tr_b16 v[78:79], v208 offset:1176
    ds_read_b64_tr_b16 v[80:81], v208 offset:32
    ds_read_b64_tr_b16 v[82:83], v208 offset:1184
    ds_read_b64_tr_b16 v[84:85], v208 offset:40
    ds_read_b64_tr_b16 v[86:87], v208 offset:1192
    ds_read_b64_tr_b16 v[88:89], v208 offset:48
    ds_read_b64_tr_b16 v[90:91], v208 offset:1200
    ds_read_b64_tr_b16 v[92:93], v208 offset:56
    ds_read_b64_tr_b16 v[94:95], v208 offset:1208
    ds_read_b64_tr_b16 v[96:97], v208 offset:64
    ds_read_b64_tr_b16 v[98:99], v208 offset:1216
    v_add_u32 v208, 0x9000, v208
    s_waitcnt lgkmcnt(15)
    v_mfma_f32_16x16x32_bf16 v[100:103], v[64:67], v[28:31], v[100:103]
    s_waitcnt lgkmcnt(14)
    v_mfma_f32_16x16x32_bf16 v[100:103], v[68:71], v[32:35], v[100:103]
    s_waitcnt lgkmcnt(12)
    v_mfma_f32_16x16x32_bf16 v[100:103], v[72:75], v[36:39], v[100:103]
    s_waitcnt lgkmcnt(10)
    v_mfma_f32_16x16x32_bf16 v[100:103], v[76:79], v[40:43], v[100:103]
    s_waitcnt lgkmcnt(8)
    v_mfma_f32_16x16x32_bf16 v[100:103], v[80:83], v[44:47], v[100:103]
    s_waitcnt lgkmcnt(6)
    v_mfma_f32_16x16x32_bf16 v[100:103], v[84:87], v[48:51], v[100:103]
    s_waitcnt lgkmcnt(4)
    v_mfma_f32_16x16x32_bf16 v[100:103], v[88:91], v[52:55], v[100:103]
    s_waitcnt lgkmcnt(2)
    v_mfma_f32_16x16x32_bf16 v[100:103], v[92:95], v[56:59], v[100:103]
    s_waitcnt lgkmcnt(0)
    v_mfma_f32_16x16x32_bf16 v[100:103], v[96:99], v[60:63], v[100:103]
    s_barrier
    ds_read_b64_tr_b16 v[64:65], v208 offset:0
    ds_read_b64_tr_b16 v[66:67], v208 offset:1152
    ds_read_b64_tr_b16 v[68:69], v208 offset:8
    ds_read_b64_tr_b16 v[70:71], v208 offset:1160
    ds_read_b64_tr_b16 v[72:73], v208 offset:16
    ds_read_b64_tr_b16 v[74:75], v208 offset:1168
    ds_read_b64_tr_b16 v[76:77], v208 offset:24
    ds_read_b64_tr_b16 v[78:79], v208 offset:1176
    ds_read_b64_tr_b16 v[80:81], v208 offset:32
    ds_read_b64_tr_b16 v[82:83], v208 offset:1184
    ds_read_b64_tr_b16 v[84:85], v208 offset:40
    ds_read_b64_tr_b16 v[86:87], v208 offset:1192
    ds_read_b64_tr_b16 v[88:89], v208 offset:48
    ds_read_b64_tr_b16 v[90:91], v208 offset:1200
    ds_read_b64_tr_b16 v[92:93], v208 offset:56
    ds_read_b64_tr_b16 v[94:95], v208 offset:1208
    ds_read_b64_tr_b16 v[96:97], v208 offset:64
    ds_read_b64_tr_b16 v[98:99], v208 offset:1216
    v_add_u32 v208, 0xfffe5000, v208
    s_waitcnt lgkmcnt(15)
    v_mfma_f32_16x16x32_bf16 v[100:103], v[64:67], v[28:31], v[100:103]
    s_waitcnt lgkmcnt(14)
    v_mfma_f32_16x16x32_bf16 v[100:103], v[68:71], v[32:35], v[100:103]
    s_waitcnt lgkmcnt(12)
    v_mfma_f32_16x16x32_bf16 v[100:103], v[72:75], v[36:39], v[100:103]
    s_waitcnt lgkmcnt(10)
    v_mfma_f32_16x16x32_bf16 v[100:103], v[76:79], v[40:43], v[100:103]
    s_waitcnt lgkmcnt(8)
    v_mfma_f32_16x16x32_bf16 v[100:103], v[80:83], v[44:47], v[100:103]
    s_waitcnt lgkmcnt(6)
    v_mfma_f32_16x16x32_bf16 v[100:103], v[84:87], v[48:51], v[100:103]
    s_waitcnt lgkmcnt(4)
    v_mfma_f32_16x16x32_bf16 v[100:103], v[88:91], v[52:55], v[100:103]
    s_waitcnt lgkmcnt(2)
    v_mfma_f32_16x16x32_bf16 v[100:103], v[92:95], v[56:59], v[100:103]
    s_waitcnt lgkmcnt(0)
    v_mfma_f32_16x16x32_bf16 v[100:103], v[96:99], v[60:63], v[100:103]
    s_barrier
    ds_read_b64_tr_b16 v[64:65], v208 offset:0
    ds_read_b64_tr_b16 v[66:67], v208 offset:1152
    ds_read_b64_tr_b16 v[68:69], v208 offset:8
    ds_read_b64_tr_b16 v[70:71], v208 offset:1160
    ds_read_b64_tr_b16 v[72:73], v208 offset:16
    ds_read_b64_tr_b16 v[74:75], v208 offset:1168
    ds_read_b64_tr_b16 v[76:77], v208 offset:24
    ds_read_b64_tr_b16 v[78:79], v208 offset:1176
    ds_read_b64_tr_b16 v[80:81], v208 offset:32
    ds_read_b64_tr_b16 v[82:83], v208 offset:1184
    ds_read_b64_tr_b16 v[84:85], v208 offset:40
    ds_read_b64_tr_b16 v[86:87], v208 offset:1192
    ds_read_b64_tr_b16 v[88:89], v208 offset:48
    ds_read_b64_tr_b16 v[90:91], v208 offset:1200
    ds_read_b64_tr_b16 v[92:93], v208 offset:56
    ds_read_b64_tr_b16 v[94:95], v208 offset:1208
    ds_read_b64_tr_b16 v[96:97], v208 offset:64
    ds_read_b64_tr_b16 v[98:99], v208 offset:1216
    v_add_u32 v208, 0x9000, v208
    s_waitcnt lgkmcnt(15)
    v_mfma_f32_16x16x32_bf16 v[100:103], v[64:67], v[28:31], v[100:103]
    s_waitcnt lgkmcnt(14)
    v_mfma_f32_16x16x32_bf16 v[100:103], v[68:71], v[32:35], v[100:103]
    s_waitcnt lgkmcnt(12)
    v_mfma_f32_16x16x32_bf16 v[100:103], v[72:75], v[36:39], v[100:103]
    s_waitcnt lgkmcnt(10)
    v_mfma_f32_16x16x32_bf16 v[100:103], v[76:79], v[40:43], v[100:103]
    s_waitcnt lgkmcnt(8)
    v_mfma_f32_16x16x32_bf16 v[100:103], v[80:83], v[44:47], v[100:103]
    s_waitcnt lgkmcnt(6)
    v_mfma_f32_16x16x32_bf16 v[100:103], v[84:87], v[48:51], v[100:103]
    s_waitcnt lgkmcnt(4)
    v_mfma_f32_16x16x32_bf16 v[100:103], v[88:91], v[52:55], v[100:103]
    s_waitcnt lgkmcnt(2)
    v_mfma_f32_16x16x32_bf16 v[100:103], v[92:95], v[56:59], v[100:103]
    s_waitcnt lgkmcnt(0)
    v_mfma_f32_16x16x32_bf16 v[100:103], v[96:99], v[60:63], v[100:103]
    v_lshlrev_b32 v6, 4, v2
    v_lshl_add_u32 v7, v5, 6, v6
    s_mul_i32 s16, s48, 576
    s_add_u32 s16, s16, 154432
    v_add_u32 v7, s16, v7
    s_mov_b32 s16, 0x01ff01ff
    s_mov_b32 s17, 0x01ff01ff
    s_nop 3
    s_mov_b64 exec, s[16:17]
    ds_write_b128 v7, v[100:103]
    s_mov_b64 exec, -1
    s_waitcnt lgkmcnt(0)
    s_branch p1kv_pjoin
p1kv_post:
    v_lshlrev_b32 v6, 4, v2
    v_and_b32 v27, 7, v1
    v_lshlrev_b32 v27, 2, v27
    v_add_u32 v6, 154432, v6
    buffer_load_dword v10, v27, s[40:43], 0 offen sc1
    ds_read_b128 v[64:67], v6 offset:0
    ds_read_b128 v[120:123], v6 offset:576
    ds_read_b128 v[68:71], v6 offset:64
    ds_read_b128 v[124:127], v6 offset:640
    ds_read_b128 v[72:75], v6 offset:128
    ds_read_b128 v[128:131], v6 offset:704
    ds_read_b128 v[76:79], v6 offset:192
    ds_read_b128 v[132:135], v6 offset:768
    ds_read_b128 v[80:83], v6 offset:256
    ds_read_b128 v[136:139], v6 offset:832
    ds_read_b128 v[84:87], v6 offset:320
    ds_read_b128 v[140:143], v6 offset:896
    ds_read_b128 v[88:91], v6 offset:384
    ds_read_b128 v[144:147], v6 offset:960
    ds_read_b128 v[92:95], v6 offset:448
    ds_read_b128 v[148:151], v6 offset:1024
    ds_read_b128 v[96:99], v6 offset:512
    ds_read_b128 v[152:155], v6 offset:1088
    s_waitcnt lgkmcnt(0)
    v_pk_add_f32 v[64:65], v[64:65], v[120:121]
    v_pk_add_f32 v[66:67], v[66:67], v[122:123]
    v_pk_add_f32 v[68:69], v[68:69], v[124:125]
    v_pk_add_f32 v[70:71], v[70:71], v[126:127]
    v_pk_add_f32 v[72:73], v[72:73], v[128:129]
    v_pk_add_f32 v[74:75], v[74:75], v[130:131]
    v_pk_add_f32 v[76:77], v[76:77], v[132:133]
    v_pk_add_f32 v[78:79], v[78:79], v[134:135]
    v_pk_add_f32 v[80:81], v[80:81], v[136:137]
    v_pk_add_f32 v[82:83], v[82:83], v[138:139]
    v_pk_add_f32 v[84:85], v[84:85], v[140:141]
    v_pk_add_f32 v[86:87], v[86:87], v[142:143]
    v_pk_add_f32 v[88:89], v[88:89], v[144:145]
    v_pk_add_f32 v[90:91], v[90:91], v[146:147]
    v_pk_add_f32 v[92:93], v[92:93], v[148:149]
    v_pk_add_f32 v[94:95], v[94:95], v[150:151]
    v_pk_add_f32 v[96:97], v[96:97], v[152:153]
    v_pk_add_f32 v[98:99], v[98:99], v[154:155]
    s_cmp_eq_u32 s53, 0
    s_cbranch_scc1 p1kv_np_2
    ds_read_b64_tr_b16 v[216:217], v14 offset:0
    ds_read_b64_tr_b16 v[218:219], v15 offset:0
    ds_read_b64_tr_b16 v[220:221], v14 offset:8
    ds_read_b64_tr_b16 v[222:223], v15 offset:8
    ds_read_b64_tr_b16 v[224:225], v14 offset:16
    ds_read_b64_tr_b16 v[226:227], v15 offset:16
    ds_read_b64_tr_b16 v[228:229], v14 offset:24
    ds_read_b64_tr_b16 v[230:231], v15 offset:24
    ds_read_b64_tr_b16 v[232:233], v14 offset:32
    ds_read_b64_tr_b16 v[234:235], v15 offset:32
    ds_read_b64_tr_b16 v[236:237], v16 offset:0
    ds_read_b64_tr_b16 v[238:239], v17 offset:0
    ds_read_b64_tr_b16 v[240:241], v16 offset:8
    ds_read_b64_tr_b16 v[242:243], v17 offset:8
    ds_read_b64_tr_b16 v[244:245], v16 offset:16
    ds_read_b64_tr_b16 v[246:247], v17 offset:16
    ds_read_b64_tr_b16 v[248:249], v16 offset:24
    ds_read_b64_tr_b16 v[250:251], v17 offset:24
    ds_read_b64_tr_b16 v[252:253], v16 offset:32
    ds_read_b64_tr_b16 v[254:255], v17 offset:32
    ds_read_b64_tr_b16 v[168:169], v18 offset:0
    ds_read_b64_tr_b16 v[170:171], v19 offset:0
    ds_read_b64_tr_b16 v[172:173], v18 offset:8
    ds_read_b64_tr_b16 v[174:175], v19 offset:8
    ds_read_b64_tr_b16 v[176:177], v18 offset:16
    ds_read_b64_tr_b16 v[178:179], v19 offset:16
    ds_read_b64_tr_b16 v[180:181], v18 offset:24
    ds_read_b64_tr_b16 v[182:183], v19 offset:24
    ds_read_b64_tr_b16 v[184:185], v18 offset:32
    ds_read_b64_tr_b16 v[186:187], v19 offset:32
    ds_read_b64_tr_b16 v[188:189], v20 offset:0
    ds_read_b64_tr_b16 v[190:191], v21 offset:0
    ds_read_b64_tr_b16 v[192:193], v20 offset:8
    ds_read_b64_tr_b16 v[194:195], v21 offset:8
    ds_read_b64_tr_b16 v[196:197], v20 offset:16
    ds_read_b64_tr_b16 v[198:199], v21 offset:16
    ds_read_b64_tr_b16 v[200:201], v20 offset:24
    ds_read_b64_tr_b16 v[202:203], v21 offset:24
    ds_read_b64_tr_b16 v[204:205], v20 offset:32
    ds_read_b64_tr_b16 v[206:207], v21 offset:32
    ds_read_b64_tr_b16 v[100:101], v22 offset:0
    ds_read_b64_tr_b16 v[102:103], v23 offset:0
    ds_read_b64_tr_b16 v[104:105], v22 offset:8
    ds_read_b64_tr_b16 v[106:107], v23 offset:8
    ds_read_b64_tr_b16 v[108:109], v22 offset:16
    ds_read_b64_tr_b16 v[110:111], v23 offset:16
    ds_read_b64_tr_b16 v[112:113], v22 offset:24
    ds_read_b64_tr_b16 v[114:115], v23 offset:24
    ds_read_b64_tr_b16 v[116:117], v22 offset:32
    ds_read_b64_tr_b16 v[118:119], v23 offset:32
p1kv_np_2:
    v_pk_mul_f32 v[28:29], v[28:29], v[12:13] op_sel:[0,1] op_sel_hi:[1,1]
    v_pk_mul_f32 v[30:31], v[30:31], v[12:13] op_sel:[0,1] op_sel_hi:[1,1]
    v_pk_mul_f32 v[32:33], v[32:33], v[12:13] op_sel:[0,1] op_sel_hi:[1,1]
    v_pk_mul_f32 v[34:35], v[34:35], v[12:13] op_sel:[0,1] op_sel_hi:[1,1]
    v_pk_mul_f32 v[36:37], v[36:37], v[12:13] op_sel:[0,1] op_sel_hi:[1,1]
    v_pk_mul_f32 v[38:39], v[38:39], v[12:13] op_sel:[0,1] op_sel_hi:[1,1]
    v_pk_mul_f32 v[40:41], v[40:41], v[12:13] op_sel:[0,1] op_sel_hi:[1,1]
    v_pk_mul_f32 v[42:43], v[42:43], v[12:13] op_sel:[0,1] op_sel_hi:[1,1]
    v_pk_mul_f32 v[44:45], v[44:45], v[12:13] op_sel:[0,1] op_sel_hi:[1,1]
    v_pk_mul_f32 v[46:47], v[46:47], v[12:13] op_sel:[0,1] op_sel_hi:[1,1]
    v_pk_mul_f32 v[48:49], v[48:49], v[12:13] op_sel:[0,1] op_sel_hi:[1,1]
    v_pk_mul_f32 v[50:51], v[50:51], v[12:13] op_sel:[0,1] op_sel_hi:[1,1]
    v_pk_mul_f32 v[52:53], v[52:53], v[12:13] op_sel:[0,1] op_sel_hi:[1,1]
    v_pk_mul_f32 v[54:55], v[54:55], v[12:13] op_sel:[0,1] op_sel_hi:[1,1]
    v_pk_mul_f32 v[56:57], v[56:57], v[12:13] op_sel:[0,1] op_sel_hi:[1,1]
    v_pk_mul_f32 v[58:59], v[58:59], v[12:13] op_sel:[0,1] op_sel_hi:[1,1]
    v_pk_mul_f32 v[60:61], v[60:61], v[12:13] op_sel:[0,1] op_sel_hi:[1,1]
    v_pk_mul_f32 v[62:63], v[62:63], v[12:13] op_sel:[0,1] op_sel_hi:[1,1]
    v_pk_fma_f32 v[28:29], v[64:65], v[12:13], v[28:29] op_sel_hi:[1,0,1] neg_lo:[0,1,0] neg_hi:[0,1,0]
    v_pk_fma_f32 v[30:31], v[66:67], v[12:13], v[30:31] op_sel_hi:[1,0,1] neg_lo:[0,1,0] neg_hi:[0,1,0]
    v_pk_fma_f32 v[32:33], v[68:69], v[12:13], v[32:33] op_sel_hi:[1,0,1] neg_lo:[0,1,0] neg_hi:[0,1,0]
    v_pk_fma_f32 v[34:35], v[70:71], v[12:13], v[34:35] op_sel_hi:[1,0,1] neg_lo:[0,1,0] neg_hi:[0,1,0]
    v_pk_fma_f32 v[36:37], v[72:73], v[12:13], v[36:37] op_sel_hi:[1,0,1] neg_lo:[0,1,0] neg_hi:[0,1,0]
    v_pk_fma_f32 v[38:39], v[74:75], v[12:13], v[38:39] op_sel_hi:[1,0,1] neg_lo:[0,1,0] neg_hi:[0,1,0]
    v_pk_fma_f32 v[40:41], v[76:77], v[12:13], v[40:41] op_sel_hi:[1,0,1] neg_lo:[0,1,0] neg_hi:[0,1,0]
    v_pk_fma_f32 v[42:43], v[78:79], v[12:13], v[42:43] op_sel_hi:[1,0,1] neg_lo:[0,1,0] neg_hi:[0,1,0]
    v_pk_fma_f32 v[44:45], v[80:81], v[12:13], v[44:45] op_sel_hi:[1,0,1] neg_lo:[0,1,0] neg_hi:[0,1,0]
    v_pk_fma_f32 v[46:47], v[82:83], v[12:13], v[46:47] op_sel_hi:[1,0,1] neg_lo:[0,1,0] neg_hi:[0,1,0]
    v_pk_fma_f32 v[48:49], v[84:85], v[12:13], v[48:49] op_sel_hi:[1,0,1] neg_lo:[0,1,0] neg_hi:[0,1,0]
    v_pk_fma_f32 v[50:51], v[86:87], v[12:13], v[50:51] op_sel_hi:[1,0,1] neg_lo:[0,1,0] neg_hi:[0,1,0]
    v_pk_fma_f32 v[52:53], v[88:89], v[12:13], v[52:53] op_sel_hi:[1,0,1] neg_lo:[0,1,0] neg_hi:[0,1,0]
    v_pk_fma_f32 v[54:55], v[90:91], v[12:13], v[54:55] op_sel_hi:[1,0,1] neg_lo:[0,1,0] neg_hi:[0,1,0]
    v_pk_fma_f32 v[56:57], v[92:93], v[12:13], v[56:57] op_sel_hi:[1,0,1] neg_lo:[0,1,0] neg_hi:[0,1,0]
    v_pk_fma_f32 v[58:59], v[94:95], v[12:13], v[58:59] op_sel_hi:[1,0,1] neg_lo:[0,1,0] neg_hi:[0,1,0]
    v_pk_fma_f32 v[60:61], v[96:97], v[12:13], v[60:61] op_sel_hi:[1,0,1] neg_lo:[0,1,0] neg_hi:[0,1,0]
    v_pk_fma_f32 v[62:63], v[98:99], v[12:13], v[62:63] op_sel_hi:[1,0,1] neg_lo:[0,1,0] neg_hi:[0,1,0]
    v_cvt_pk_bf16_f32 v120, v28, v29
    v_cvt_pk_bf16_f32 v121, v30, v31
    v_cvt_pk_bf16_f32 v122, v32, v33
    v_cvt_pk_bf16_f32 v123, v34, v35
    v_cvt_pk_bf16_f32 v124, v36, v37
    v_cvt_pk_bf16_f32 v125, v38, v39
    v_cvt_pk_bf16_f32 v126, v40, v41
    v_cvt_pk_bf16_f32 v127, v42, v43
    v_cvt_pk_bf16_f32 v128, v44, v45
    v_cvt_pk_bf16_f32 v129, v46, v47
    v_cvt_pk_bf16_f32 v130, v48, v49
    v_cvt_pk_bf16_f32 v131, v50, v51
    v_cvt_pk_bf16_f32 v132, v52, v53
    v_cvt_pk_bf16_f32 v133, v54, v55
    v_cvt_pk_bf16_f32 v134, v56, v57
    v_cvt_pk_bf16_f32 v135, v58, v59
    v_cvt_pk_bf16_f32 v136, v60, v61
    v_cvt_pk_bf16_f32 v137, v62, v63
    v_mov_b32 v138, 0
    v_mov_b32 v139, 0
    s_waitcnt lgkmcnt(0)
    v_mfma_f32_16x16x32_bf16 v[140:143], v[216:219], v[120:123], 0
    v_mfma_f32_16x16x32_bf16 v[144:147], v[220:223], v[120:123], 0
    v_mfma_f32_16x16x32_bf16 v[148:151], v[224:227], v[120:123], 0
    v_mfma_f32_16x16x32_bf16 v[152:155], v[228:231], v[120:123], 0
    v_mfma_f32_16x16x32_bf16 v[156:159], v[232:235], v[120:123], 0
    v_mfma_f32_16x16x32_bf16 v[140:143], v[236:239], v[124:127], v[140:143]
    v_mfma_f32_16x16x32_bf16 v[144:147], v[240:243], v[124:127], v[144:147]
    v_mfma_f32_16x16x32_bf16 v[148:151], v[244:247], v[124:127], v[148:151]
    v_mfma_f32_16x16x32_bf16 v[152:155], v[248:251], v[124:127], v[152:155]
    v_mfma_f32_16x16x32_bf16 v[156:159], v[252:255], v[124:127], v[156:159]
    v_mfma_f32_16x16x32_bf16 v[140:143], v[168:171], v[128:131], v[140:143]
    v_mfma_f32_16x16x32_bf16 v[144:147], v[172:175], v[128:131], v[144:147]
    v_mfma_f32_16x16x32_bf16 v[148:151], v[176:179], v[128:131], v[148:151]
    v_mfma_f32_16x16x32_bf16 v[152:155], v[180:183], v[128:131], v[152:155]
    v_mfma_f32_16x16x32_bf16 v[156:159], v[184:187], v[128:131], v[156:159]
    v_mfma_f32_16x16x32_bf16 v[140:143], v[188:191], v[132:135], v[140:143]
    v_mfma_f32_16x16x32_bf16 v[144:147], v[192:195], v[132:135], v[144:147]
    v_mfma_f32_16x16x32_bf16 v[148:151], v[196:199], v[132:135], v[148:151]
    v_mfma_f32_16x16x32_bf16 v[152:155], v[200:203], v[132:135], v[152:155]
    v_mfma_f32_16x16x32_bf16 v[156:159], v[204:207], v[132:135], v[156:159]
    v_mfma_f32_16x16x32_bf16 v[140:143], v[100:103], v[136:139], v[140:143]
    v_mfma_f32_16x16x32_bf16 v[144:147], v[104:107], v[136:139], v[144:147]
    v_mfma_f32_16x16x32_bf16 v[148:151], v[108:111], v[136:139], v[148:151]
    v_mfma_f32_16x16x32_bf16 v[152:155], v[112:115], v[136:139], v[152:155]
    v_mfma_f32_16x16x32_bf16 v[156:159], v[116:119], v[136:139], v[156:159]
    s_mov_b32 s54, 0x3fb8aa3b
    s_mov_b32 s55, 0x3fb8aa3b
    s_lshl_b32 s16, s14, 5
    s_lshl_b32 s17, s15, 4
    s_add_u32 s16, s16, s17
    v_add_u32 v9, s16, v5
    v_mul_u32_u24 v7, 160, v9
    v_mul_u32_u24 v8, 72, v2
    v_add3_u32 v8, v7, v8, 0
    v_add_u32 v8, 40816, v8
    v_mov_b32 v24, 0x3f80
    v_mov_b32 v25, 0
    s_mov_b32 s16, 0
    s_mov_b32 s17, -1
    s_mov_b64 exec, s[16:17]
    ds_write_b64 v8, v[120:121] offset:0
    ds_write_b64 v8, v[122:123] offset:8
    ds_write_b64 v8, v[124:125] offset:16
    ds_write_b64 v8, v[126:127] offset:24
    ds_write_b64 v8, v[128:129] offset:32
    ds_write_b64 v8, v[130:131] offset:40
    ds_write_b64 v8, v[132:133] offset:48
    ds_write_b64 v8, v[134:135] offset:56
    ds_write_b64 v8, v[136:137] offset:64
    ds_write_b64 v7, v[24:25] offset:41104
    s_mov_b64 exec, -1
    v_mul_u32_u24 v8, 10240, v2
    v_mul_u32_u24 v7, 80, v9
    v_add_u32 v8, v7, v8
    v_max3_f32 v64, v140, v141, v142
    v_min3_f32 v65, v140, v141, v142
    v_max3_f32 v64, v64, v143, v144
    v_min3_f32 v65, v65, v143, v144
    v_max3_f32 v64, v64, v145, v146
    v_min3_f32 v65, v65, v145, v146
    v_max3_f32 v64, v64, v147, v148
    v_min3_f32 v65, v65, v147, v148
    v_max3_f32 v64, v64, v149, v150
    v_min3_f32 v65, v65, v149, v150
    v_max3_f32 v64, v64, v151, v152
    v_min3_f32 v65, v65, v151, v152
    v_max3_f32 v64, v64, v153, v154
    v_min3_f32 v65, v65, v153, v154
    v_max3_f32 v64, v64, v155, v156
    v_min3_f32 v65, v65, v155, v156
    v_max_f32 v64, v64, v157
    v_min_f32 v65, v65, v157
    v_mul_f32 v64, s54, v64
    v_mul_f32 v65, s54, v65
    v_pk_fma_f32 v[28:29], v[140:141], s[54:55], v[64:65] op_sel_hi:[1,0,0] neg_lo:[0,0,1] neg_hi:[0,0,1]
    v_pk_fma_f32 v[46:47], v[140:141], s[54:55], v[64:65] op_sel:[0,0,1] op_sel_hi:[1,0,1] neg_lo:[1,0,0] neg_hi:[1,0,0]
    v_pk_fma_f32 v[30:31], v[142:143], s[54:55], v[64:65] op_sel_hi:[1,0,0] neg_lo:[0,0,1] neg_hi:[0,0,1]
    v_pk_fma_f32 v[48:49], v[142:143], s[54:55], v[64:65] op_sel:[0,0,1] op_sel_hi:[1,0,1] neg_lo:[1,0,0] neg_hi:[1,0,0]
    v_pk_fma_f32 v[32:33], v[144:145], s[54:55], v[64:65] op_sel_hi:[1,0,0] neg_lo:[0,0,1] neg_hi:[0,0,1]
    v_pk_fma_f32 v[50:51], v[144:145], s[54:55], v[64:65] op_sel:[0,0,1] op_sel_hi:[1,0,1] neg_lo:[1,0,0] neg_hi:[1,0,0]
    v_pk_fma_f32 v[34:35], v[146:147], s[54:55], v[64:65] op_sel_hi:[1,0,0] neg_lo:[0,0,1] neg_hi:[0,0,1]
    v_pk_fma_f32 v[52:53], v[146:147], s[54:55], v[64:65] op_sel:[0,0,1] op_sel_hi:[1,0,1] neg_lo:[1,0,0] neg_hi:[1,0,0]
    v_pk_fma_f32 v[36:37], v[148:149], s[54:55], v[64:65] op_sel_hi:[1,0,0] neg_lo:[0,0,1] neg_hi:[0,0,1]
    v_pk_fma_f32 v[54:55], v[148:149], s[54:55], v[64:65] op_sel:[0,0,1] op_sel_hi:[1,0,1] neg_lo:[1,0,0] neg_hi:[1,0,0]
    v_pk_fma_f32 v[38:39], v[150:151], s[54:55], v[64:65] op_sel_hi:[1,0,0] neg_lo:[0,0,1] neg_hi:[0,0,1]
    v_pk_fma_f32 v[56:57], v[150:151], s[54:55], v[64:65] op_sel:[0,0,1] op_sel_hi:[1,0,1] neg_lo:[1,0,0] neg_hi:[1,0,0]
    v_pk_fma_f32 v[40:41], v[152:153], s[54:55], v[64:65] op_sel_hi:[1,0,0] neg_lo:[0,0,1] neg_hi:[0,0,1]
    v_pk_fma_f32 v[58:59], v[152:153], s[54:55], v[64:65] op_sel:[0,0,1] op_sel_hi:[1,0,1] neg_lo:[1,0,0] neg_hi:[1,0,0]
    v_pk_fma_f32 v[42:43], v[154:155], s[54:55], v[64:65] op_sel_hi:[1,0,0] neg_lo:[0,0,1] neg_hi:[0,0,1]
    v_pk_fma_f32 v[60:61], v[154:155], s[54:55], v[64:65] op_sel:[0,0,1] op_sel_hi:[1,0,1] neg_lo:[1,0,0] neg_hi:[1,0,0]
    v_pk_fma_f32 v[44:45], v[156:157], s[54:55], v[64:65] op_sel_hi:[1,0,0] neg_lo:[0,0,1] neg_hi:[0,0,1]
    v_pk_fma_f32 v[62:63], v[156:157], s[54:55], v[64:65] op_sel:[0,0,1] op_sel_hi:[1,0,1] neg_lo:[1,0,0] neg_hi:[1,0,0]
    v_exp_f32 v28, v28
    v_exp_f32 v29, v29
    v_exp_f32 v30, v30
    v_exp_f32 v31, v31
    v_exp_f32 v32, v32
    v_exp_f32 v33, v33
    v_exp_f32 v34, v34
    v_exp_f32 v35, v35
    v_exp_f32 v36, v36
    v_exp_f32 v37, v37
    v_exp_f32 v38, v38
    v_exp_f32 v39, v39
    v_exp_f32 v40, v40
    v_exp_f32 v41, v41
    v_exp_f32 v42, v42
    v_exp_f32 v43, v43
    v_exp_f32 v44, v44
    v_exp_f32 v45, v45
    v_exp_f32 v46, v46
    v_exp_f32 v47, v47
    v_exp_f32 v48, v48
    v_exp_f32 v49, v49
    v_exp_f32 v50, v50
    v_exp_f32 v51, v51
    v_exp_f32 v52, v52
    v_exp_f32 v53, v53
    v_exp_f32 v54, v54
    v_exp_f32 v55, v55
    v_exp_f32 v56, v56
    v_exp_f32 v57, v57
    v_exp_f32 v58, v58
    v_exp_f32 v59, v59
    v_exp_f32 v60, v60
    v_exp_f32 v61, v61
    v_exp_f32 v62, v62
    v_exp_f32 v63, v63
    v_pk_add_f32 v[66:67], v[28:29], v[30:31]
    v_pk_add_f32 v[68:69], v[46:47], v[48:49]
    v_pk_add_f32 v[66:67], v[66:67], v[32:33]
    v_pk_add_f32 v[68:69], v[68:69], v[50:51]
    v_pk_add_f32 v[66:67], v[66:67], v[34:35]
    v_pk_add_f32 v[68:69], v[68:69], v[52:53]
    v_pk_add_f32 v[66:67], v[66:67], v[36:37]
    v_pk_add_f32 v[68:69], v[68:69], v[54:55]
    v_pk_add_f32 v[66:67], v[66:67], v[38:39]
    v_pk_add_f32 v[68:69], v[68:69], v[56:57]
    v_pk_add_f32 v[66:67], v[66:67], v[40:41]
    v_pk_add_f32 v[68:69], v[68:69], v[58:59]
    v_pk_add_f32 v[66:67], v[66:67], v[42:43]
    v_pk_add_f32 v[68:69], v[68:69], v[60:61]
    v_pk_add_f32 v[66:67], v[66:67], v[44:45]
    v_pk_add_f32 v[68:69], v[68:69], v[62:63]
    v_add_f32 v66, v66, v67
    v_add_f32 v68, v68, v69
    v_rcp_f32 v66, v66
    v_rcp_f32 v68, v68
    v_pk_mul_f32 v[28:29], v[28:29], v[66:67] op_sel_hi:[1,0]
    v_pk_mul_f32 v[46:47], v[46:47], v[68:69] op_sel_hi:[1,0]
    v_pk_mul_f32 v[30:31], v[30:31], v[66:67] op_sel_hi:[1,0]
    v_pk_mul_f32 v[48:49], v[48:49], v[68:69] op_sel_hi:[1,0]
    v_pk_mul_f32 v[32:33], v[32:33], v[66:67] op_sel_hi:[1,0]
    v_pk_mul_f32 v[50:51], v[50:51], v[68:69] op_sel_hi:[1,0]
    v_pk_mul_f32 v[34:35], v[34:35], v[66:67] op_sel_hi:[1,0]
    v_pk_mul_f32 v[52:53], v[52:53], v[68:69] op_sel_hi:[1,0]
    v_pk_mul_f32 v[36:37], v[36:37], v[66:67] op_sel_hi:[1,0]
    v_pk_mul_f32 v[54:55], v[54:55], v[68:69] op_sel_hi:[1,0]
    v_pk_mul_f32 v[38:39], v[38:39], v[66:67] op_sel_hi:[1,0]
    v_pk_mul_f32 v[56:57], v[56:57], v[68:69] op_sel_hi:[1,0]
    v_pk_mul_f32 v[40:41], v[40:41], v[66:67] op_sel_hi:[1,0]
    v_pk_mul_f32 v[58:59], v[58:59], v[68:69] op_sel_hi:[1,0]
    v_pk_mul_f32 v[42:43], v[42:43], v[66:67] op_sel_hi:[1,0]
    v_pk_mul_f32 v[60:61], v[60:61], v[68:69] op_sel_hi:[1,0]
    v_pk_mul_f32 v[44:45], v[44:45], v[66:67] op_sel_hi:[1,0]
    v_pk_mul_f32 v[62:63], v[62:63], v[68:69] op_sel_hi:[1,0]
    v_cvt_pk_bf16_f32 v72, v28, v29
    v_cvt_pk_bf16_f32 v73, v30, v31
    v_cvt_pk_bf16_f32 v74, v32, v33
    v_cvt_pk_bf16_f32 v75, v34, v35
    v_cvt_pk_bf16_f32 v76, v36, v37
    v_cvt_pk_bf16_f32 v77, v38, v39
    v_cvt_pk_bf16_f32 v78, v40, v41
    v_cvt_pk_bf16_f32 v79, v42, v43
    v_cvt_pk_bf16_f32 v80, v44, v45
    v_cvt_pk_bf16_f32 v81, v46, v47
    v_cvt_pk_bf16_f32 v82, v48, v49
    v_cvt_pk_bf16_f32 v83, v50, v51
    v_cvt_pk_bf16_f32 v84, v52, v53
    v_cvt_pk_bf16_f32 v85, v54, v55
    v_cvt_pk_bf16_f32 v86, v56, v57
    v_cvt_pk_bf16_f32 v87, v58, v59
    v_cvt_pk_bf16_f32 v88, v60, v61
    v_cvt_pk_bf16_f32 v89, v62, v63
    ds_write_b128 v8, v[72:75] offset:0
    ds_write_b128 v8, v[76:79] offset:16
    ds_write_b128 v8, v[80:83] offset:32
    ds_write_b128 v8, v[84:87] offset:48
    ds_write_b64 v8, v[88:89] offset:64
    s_cmp_lt_u32 s13, 4
    s_cbranch_scc1 p1kv_fin0
    s_lshl_b32 s16, s11, 2
    s_add_u32 s16, s16, s14
    s_mul_i32 s16, s16, 2816
    s_waitcnt lgkmcnt(0)
    s_barrier
    ds_read_b64_tr_b16 v[120:121], v160 offset:0
    ds_read_b64_tr_b16 v[124:125], v161 offset:0
    ds_read_b64_tr_b16 v[128:129], v162 offset:0
    ds_read_b64_tr_b16 v[132:133], v162 offset:32
    ds_read_b64_tr_b16 v[136:137], v162 offset:64
    ds_read_b64_tr_b16 v[122:123], v160 offset:640
    ds_read_b64_tr_b16 v[126:127], v161 offset:640
    ds_read_b64_tr_b16 v[130:131], v162 offset:320
    ds_read_b64_tr_b16 v[134:135], v162 offset:352
    ds_read_b64_tr_b16 v[138:139], v162 offset:384
    ds_read_b64_tr_b16 v[140:141], v160 offset:5120
    ds_read_b64_tr_b16 v[144:145], v161 offset:5120
    ds_read_b64_tr_b16 v[148:149], v162 offset:2560
    ds_read_b64_tr_b16 v[152:153], v162 offset:2592
    ds_read_b64_tr_b16 v[156:157], v162 offset:2624
    ds_read_b64_tr_b16 v[142:143], v160 offset:5760
    ds_read_b64_tr_b16 v[146:147], v161 offset:5760
    ds_read_b64_tr_b16 v[150:151], v162 offset:2880
    ds_read_b64_tr_b16 v[154:155], v162 offset:2912
    ds_read_b64_tr_b16 v[158:159], v162 offset:2944
    s_waitcnt lgkmcnt(10)
    v_mfma_f32_16x16x32_bf16 v[28:31], v[128:131], v[120:123], 0
    v_mfma_f32_16x16x32_bf16 v[32:35], v[132:135], v[120:123], 0
    v_mfma_f32_16x16x32_bf16 v[36:39], v[136:139], v[120:123], 0
    v_mfma_f32_16x16x32_bf16 v[40:43], v[128:131], v[124:127], 0
    v_mfma_f32_16x16x32_bf16 v[44:47], v[132:135], v[124:127], 0
    v_mfma_f32_16x16x32_bf16 v[48:51], v[136:139], v[124:127], 0
    ds_read_b64_tr_b16 v[168:169], v160 offset:10240
    ds_read_b64_tr_b16 v[172:173], v161 offset:10240
    ds_read_b64_tr_b16 v[176:177], v162 offset:5120
    ds_read_b64_tr_b16 v[180:181], v162 offset:5152
    ds_read_b64_tr_b16 v[184:185], v162 offset:5184
    ds_read_b64_tr_b16 v[170:171], v160 offset:10880
    ds_read_b64_tr_b16 v[174:175], v161 offset:10880
    ds_read_b64_tr_b16 v[178:179], v162 offset:5440
    ds_read_b64_tr_b16 v[182:183], v162 offset:5472
    ds_read_b64_tr_b16 v[186:187], v162 offset:5504
    s_waitcnt lgkmcnt(10)
    v_mfma_f32_16x16x32_bf16 v[28:31], v[148:151], v[140:143], v[28:31]
    v_mfma_f32_16x16x32_bf16 v[32:35], v[152:155], v[140:143], v[32:35]
    v_mfma_f32_16x16x32_bf16 v[36:39], v[156:159], v[140:143], v[36:39]
    v_mfma_f32_16x16x32_bf16 v[40:43], v[148:151], v[144:147], v[40:43]
    v_mfma_f32_16x16x32_bf16 v[44:47], v[152:155], v[144:147], v[44:47]
    v_mfma_f32_16x16x32_bf16 v[48:51], v[156:159], v[144:147], v[48:51]
    ds_read_b64_tr_b16 v[188:189], v160 offset:15360
    ds_read_b64_tr_b16 v[192:193], v161 offset:15360
    ds_read_b64_tr_b16 v[196:197], v162 offset:7680
    ds_read_b64_tr_b16 v[200:201], v162 offset:7712
    ds_read_b64_tr_b16 v[204:205], v162 offset:7744
    ds_read_b64_tr_b16 v[190:191], v160 offset:16000
    ds_read_b64_tr_b16 v[194:195], v161 offset:16000
    ds_read_b64_tr_b16 v[198:199], v162 offset:8000
    ds_read_b64_tr_b16 v[202:203], v162 offset:8032
    ds_read_b64_tr_b16 v[206:207], v162 offset:8064
    s_waitcnt lgkmcnt(10)
    v_mfma_f32_16x16x32_bf16 v[28:31], v[176:179], v[168:171], v[28:31]
    v_mfma_f32_16x16x32_bf16 v[32:35], v[180:183], v[168:171], v[32:35]
    v_mfma_f32_16x16x32_bf16 v[36:39], v[184:187], v[168:171], v[36:39]
    v_mfma_f32_16x16x32_bf16 v[40:43], v[176:179], v[172:175], v[40:43]
    v_mfma_f32_16x16x32_bf16 v[44:47], v[180:183], v[172:175], v[44:47]
    v_mfma_f32_16x16x32_bf16 v[48:51], v[184:187], v[172:175], v[48:51]
    s_waitcnt lgkmcnt(0)
    v_mfma_f32_16x16x32_bf16 v[28:31], v[196:199], v[188:191], v[28:31]
    v_mfma_f32_16x16x32_bf16 v[32:35], v[200:203], v[188:191], v[32:35]
    v_mfma_f32_16x16x32_bf16 v[36:39], v[204:207], v[188:191], v[36:39]
    v_mfma_f32_16x16x32_bf16 v[40:43], v[196:199], v[192:195], v[40:43]
    v_mfma_f32_16x16x32_bf16 v[44:47], v[200:203], v[192:195], v[44:47]
    v_mfma_f32_16x16x32_bf16 v[48:51], v[204:207], v[192:195], v[48:51]
    s_mov_b32 s18, 0
    s_waitcnt vmcnt(0)
    v_cmp_ne_u32 vcc, 1, v10
    ds_write_b128 v166, v[28:31]
    ds_write_b128 v167, v[32:35]
    ds_write_b128 v212, v[36:39]
    ds_write_b128 v213, v[40:43]
    ds_write_b128 v214, v[44:47]
    ds_write_b128 v215, v[48:51]
    s_cbranch_vccz p1_pd_4
p1_poll_3:
    buffer_load_dword v10, v27, s[40:43], 0 offen sc1
    s_add_u32 s18, s18, 1
    s_waitcnt vmcnt(0)
    v_cmp_ne_u32 vcc, 1, v10
    s_cmp_gt_u32 s18, 0x100000
    s_cbranch_scc1 p1_pd_4
    s_cbranch_vccnz p1_poll_3
p1_pd_4:
    s_waitcnt lgkmcnt(0)
    ds_read_b32 v120, v164 offset:0
    ds_read_b32 v121, v164 offset:256
    ds_read_b32 v122, v164 offset:512
    ds_read_b32 v123, v164 offset:768
    ds_read_b32 v124, v164 offset:1024
    ds_read_b32 v125, v164 offset:1280
    ds_read_b32 v126, v164 offset:1536
    ds_read_b32 v127, v164 offset:1792
    ds_read_b32 v128, v164 offset:2048
    ds_read_b32 v129, v164 offset:2304
    ds_read_b32 v130, v164 offset:2560
    s_waitcnt lgkmcnt(10)
    buffer_atomic_add_f32 v120, v163, s[32:35], s16 offen offset:0
    s_waitcnt lgkmcnt(9)
    buffer_atomic_add_f32 v121, v163, s[32:35], s16 offen offset:256
    s_waitcnt lgkmcnt(8)
    buffer_atomic_add_f32 v122, v163, s[32:35], s16 offen offset:512
    s_waitcnt lgkmcnt(7)
    buffer_atomic_add_f32 v123, v163, s[32:35], s16 offen offset:768
    s_waitcnt lgkmcnt(6)
    buffer_atomic_add_f32 v124, v163, s[32:35], s16 offen offset:1024
    s_waitcnt lgkmcnt(5)
    buffer_atomic_add_f32 v125, v163, s[32:35], s16 offen offset:1280
    s_waitcnt lgkmcnt(4)
    buffer_atomic_add_f32 v126, v163, s[32:35], s16 offen offset:1536
    s_waitcnt lgkmcnt(3)
    buffer_atomic_add_f32 v127, v163, s[32:35], s16 offen offset:1792
    s_waitcnt lgkmcnt(2)
    buffer_atomic_add_f32 v128, v163, s[32:35], s16 offen offset:2048
    s_waitcnt lgkmcnt(1)
    buffer_atomic_add_f32 v129, v163, s[32:35], s16 offen offset:2304
    s_waitcnt lgkmcnt(0)
    buffer_atomic_add_f32 v130, v165, s[32:35], s16 offen offset:2560
    s_and_b32 s16, s2, 31
    s_lshr_b32 s17, s2, 7
    s_lshl_b32 s17, s17, 5
    s_add_u32 s16, s16, s17
    s_lshl_b32 s16, s16, 7
    v_mov_b32 v6, 1
    v_mov_b32 v7, 0
    s_waitcnt vmcnt(0)
    s_mov_b64 exec, 1
    buffer_atomic_add v6, v7, s[96:99], s16 offen sc1
    s_mov_b64 exec, -1
    s_branch p1_late
    s_branch p1kv_fin
p1kv_fin0:
    s_waitcnt lgkmcnt(0)
    s_barrier
    s_mov_b32 s18, 0
    s_waitcnt vmcnt(0)
    v_cmp_ne_u32 vcc, 1, v10
    s_cbranch_vccz p1_fx_6
p1_fp_5:
    buffer_load_dword v10, v27, s[40:43], 0 offen sc1
    s_add_u32 s18, s18, 1
    s_cmp_gt_u32 s18, 0x80000
    s_cbranch_scc1 p1_fx_6
    s_waitcnt vmcnt(0)
    v_cmp_ne_u32 vcc, 1, v10
    s_cbranch_vccnz p1_fp_5
p1_fx_6:
    s_waitcnt vmcnt(0)
    s_branch p1_early
p1kv_fin:
    s_branch p1_done
p1_q:
    s_lshl_b32 s10, s46, 3
    s_and_b32 s19, s45, 7
    s_add_u32 s10, s10, s19
    s_lshl_b32 s11, s44, 1
    s_lshr_b32 s19, s45, 3
    s_add_u32 s11, s11, s19
    s_cmp_lt_u32 s13, 4
    s_cbranch_scc1 p1_qc
    v_and_b32 v1, 63, v0
    v_lshrrev_b32 v2, 4, v1
    s_cmp_ge_u32 s14, 2
    s_cbranch_scc1 p1q_helper
    s_lshl_b32 s12, s14, 5
    s_movk_i32 s17, 1152
    v_lshrrev_b32 v7, 3, v1
    v_and_b32 v8, 7, v1
    v_add_u32 v6, 0, v2
    v_xor_b32 v6, v6, v8
    v_lshlrev_b32 v6, 4, v6
    v_add3_u32 v9, v7, 0, s12
    v_mad_u32_u24 v120, v9, s17, v6
    v_add_u32 v6, 4, v2
    v_xor_b32 v6, v6, v8
    v_lshlrev_b32 v6, 4, v6
    v_add3_u32 v9, v7, 8, s12
    v_mad_u32_u24 v121, v9, s17, v6
    v_subrev_u32 v121, 1024, v121
    v_add_u32 v6, 0, v2
    v_xor_b32 v6, v6, v8
    v_lshlrev_b32 v6, 4, v6
    v_add3_u32 v9, v7, 16, s12
    v_mad_u32_u24 v122, v9, s17, v6
    v_subrev_u32 v122, 2048, v122
    v_add_u32 v6, 4, v2
    v_xor_b32 v6, v6, v8
    v_lshlrev_b32 v6, 4, v6
    v_add3_u32 v9, v7, 24, s12
    v_mad_u32_u24 v123, v9, s17, v6
    v_subrev_u32 v123, 3072, v123
    s_mul_i32 s44, s10, 73728
    s_lshl_b32 s46, s14, 12
    s_mov_b32 m0, s46
    s_nop 0
    buffer_load_dwordx4 v120, s[20:23], s44 offen offset:0 lds
    buffer_load_dwordx4 v121, s[20:23], s44 offen offset:1024 lds
    buffer_load_dwordx4 v122, s[20:23], s44 offen offset:2048 lds
    buffer_load_dwordx4 v123, s[20:23], s44 offen offset:3072 lds
    s_mul_i32 s47, s14, 10240
    s_add_u32 s47, s47, 16384
    s_mul_i32 s45, s14, 110592
    s_add_u32 s48, s45, 55296
    s_movk_i32 s18, 3456
    s_mul_i32 s19, s11, 288
    v_mov_b32 v6, 0x40000000
    v_add_u32 v8, 0, v1
    v_mul_u32_u24 v9, 57, v8
    v_lshrrev_b32 v9, 10, v9
    v_mul_u32_u24 v124, 18, v9
    v_sub_u32 v8, v8, v124
    v_mad_u32_u24 v124, v9, s18, 0
    v_lshl_add_u32 v124, v8, 4, v124
    s_add_u32 s12, s19, 0x0
    v_add_u32 v124, s12, v124
    s_add_u32 m0, s47, 0
    s_nop 0
    buffer_load_dwordx4 v124, s[24:27], s45 offen offset:0 lds
    s_add_u32 m0, s47, 5120
    s_nop 0
    buffer_load_dwordx4 v124, s[24:27], s48 offen offset:0 lds
    s_mov_b32 m0, s47
    v_add_u32 v8, 64, v1
    v_mul_u32_u24 v9, 57, v8
    v_lshrrev_b32 v9, 10, v9
    v_mul_u32_u24 v125, 18, v9
    v_sub_u32 v8, v8, v125
    v_mad_u32_u24 v125, v9, s18, 0
    v_lshl_add_u32 v125, v8, 4, v125
    s_add_u32 s12, s19, 0xfffffc00
    v_add_u32 v125, s12, v125
    buffer_load_dwordx4 v125, s[24:27], s45 offen offset:1024 lds
    s_add_u32 m0, s47, 5120
    s_nop 0
    buffer_load_dwordx4 v125, s[24:27], s48 offen offset:1024 lds
    s_mov_b32 m0, s47
    v_cmp_lt_u32 s[16:17], 23, v1
    v_add_u32 v8, 128, v1
    v_subrev_u32 v7, 24, v1
    v_cndmask_b32 v8, v8, v7, s[16:17]
    v_mul_u32_u24 v9, 57, v8
    v_lshrrev_b32 v9, 10, v9
    v_mul_u32_u24 v126, 18, v9
    v_sub_u32 v8, v8, v126
    v_mad_u32_u24 v126, v9, s18, 0
    v_lshl_add_u32 v126, v8, 4, v126
    s_add_u32 s12, s19, 0xfffff800
    v_add_u32 v126, s12, v126
    v_add_u32 v7, 27648, v126
    v_cndmask_b32 v126, v126, v7, s[16:17]
    v_cmp_lt_u32 vcc, 7, v9
    s_nop 1
    v_cndmask_b32 v126, v126, v6, vcc
    buffer_load_dwordx4 v126, s[24:27], s45 offen offset:2048 lds
    s_add_u32 m0, s47, 5120
    s_nop 0
    buffer_load_dwordx4 v126, s[24:27], s48 offen offset:2048 lds
    s_mov_b32 m0, s47
    v_add_u32 v8, 40, v1
    v_mul_u32_u24 v9, 57, v8
    v_lshrrev_b32 v9, 10, v9
    v_mul_u32_u24 v127, 18, v9
    v_sub_u32 v8, v8, v127
    v_mad_u32_u24 v127, v9, s18, 0
    v_lshl_add_u32 v127, v8, 4, v127
    s_add_u32 s12, s19, 0x6000
    v_add_u32 v127, s12, v127
    buffer_load_dwordx4 v127, s[24:27], s45 offen offset:3072 lds
    s_add_u32 m0, s47, 5120
    s_nop 0
    buffer_load_dwordx4 v127, s[24:27], s48 offen offset:3072 lds
    s_mov_b32 m0, s47
    v_add_u32 v8, 104, v1
    v_mul_u32_u24 v9, 57, v8
    v_lshrrev_b32 v9, 10, v9
    v_mul_u32_u24 v128, 18, v9
    v_sub_u32 v8, v8, v128
    v_mad_u32_u24 v128, v9, s18, 0
    v_lshl_add_u32 v128, v8, 4, v128
    s_add_u32 s12, s19, 0x6c00
    v_add_u32 v128, s12, v128
    v_cmp_lt_u32 vcc, 7, v9
    s_nop 1
    v_cndmask_b32 v128, v128, v6, vcc
    s_add_u32 m0, s47, 4096
    s_nop 0
    buffer_load_dwordx4 v128, s[24:27], s45 offen offset:0 lds
    s_add_u32 m0, s47, 9216
    s_nop 0
    buffer_load_dwordx4 v128, s[24:27], s48 offen offset:0 lds
    s_mov_b32 m0, s47
    s_add_u32 s44, s44, 128
    s_add_u32 s45, s45, 221184
    s_add_u32 s48, s48, 221184
    s_add_u32 s46, s46, 0x9000
    s_add_u32 s47, s47, 0x9000
    s_mov_b32 m0, s46
    s_nop 0
    buffer_load_dwordx4 v120, s[20:23], s44 offen offset:0 lds
    buffer_load_dwordx4 v121, s[20:23], s44 offen offset:1024 lds
    buffer_load_dwordx4 v122, s[20:23], s44 offen offset:2048 lds
    buffer_load_dwordx4 v123, s[20:23], s44 offen offset:3072 lds
    s_add_u32 m0, s47, 0
    s_nop 0
    buffer_load_dwordx4 v124, s[24:27], s45 offen offset:0 lds
    buffer_load_dwordx4 v125, s[24:27], s45 offen offset:1024 lds
    buffer_load_dwordx4 v126, s[24:27], s45 offen offset:2048 lds
    buffer_load_dwordx4 v127, s[24:27], s45 offen offset:3072 lds
    s_add_u32 m0, s47, 4096
    s_nop 0
    buffer_load_dwordx4 v128, s[24:27], s45 offen offset:0 lds
    s_add_u32 m0, s47, 5120
    s_nop 0
    buffer_load_dwordx4 v124, s[24:27], s48 offen offset:0 lds
    buffer_load_dwordx4 v125, s[24:27], s48 offen offset:1024 lds
    buffer_load_dwordx4 v126, s[24:27], s48 offen offset:2048 lds
    buffer_load_dwordx4 v127, s[24:27], s48 offen offset:3072 lds
    s_add_u32 m0, s47, 9216
    s_nop 0
    buffer_load_dwordx4 v128, s[24:27], s48 offen offset:0 lds
    s_add_u32 s44, s44, 128
    s_add_u32 s45, s45, 221184
    s_add_u32 s48, s48, 221184
    s_add_u32 s46, s46, 0x9000
    s_add_u32 s47, s47, 0x9000
    s_waitcnt vmcnt(14)
    s_barrier
    s_mov_b32 m0, s46
    s_nop 0
    buffer_load_dwordx4 v120, s[20:23], s44 offen offset:0 lds
    buffer_load_dwordx4 v121, s[20:23], s44 offen offset:1024 lds
    buffer_load_dwordx4 v122, s[20:23], s44 offen offset:2048 lds
    buffer_load_dwordx4 v123, s[20:23], s44 offen offset:3072 lds
    s_add_u32 m0, s47, 0
    s_nop 0
    buffer_load_dwordx4 v124, s[24:27], s45 offen offset:0 lds
    buffer_load_dwordx4 v125, s[24:27], s45 offen offset:1024 lds
    buffer_load_dwordx4 v126, s[24:27], s45 offen offset:2048 lds
    buffer_load_dwordx4 v127, s[24:27], s45 offen offset:3072 lds
    s_add_u32 m0, s47, 4096
    s_nop 0
    buffer_load_dwordx4 v128, s[24:27], s45 offen offset:0 lds
    s_add_u32 m0, s47, 5120
    s_nop 0
    buffer_load_dwordx4 v124, s[24:27], s48 offen offset:0 lds
    buffer_load_dwordx4 v125, s[24:27], s48 offen offset:1024 lds
    buffer_load_dwordx4 v126, s[24:27], s48 offen offset:2048 lds
    buffer_load_dwordx4 v127, s[24:27], s48 offen offset:3072 lds
    s_add_u32 m0, s47, 9216
    s_nop 0
    buffer_load_dwordx4 v128, s[24:27], s48 offen offset:0 lds
    s_add_u32 s44, s44, 128
    s_add_u32 s45, s45, 221184
    s_add_u32 s48, s48, 221184
    s_add_u32 s46, s46, 0x9000
    s_add_u32 s47, s47, 0x9000
    s_waitcnt vmcnt(14)
    s_barrier
    s_mov_b32 m0, s46
    s_nop 0
    buffer_load_dwordx4 v120, s[20:23], s44 offen offset:0 lds
    buffer_load_dwordx4 v121, s[20:23], s44 offen offset:1024 lds
    buffer_load_dwordx4 v122, s[20:23], s44 offen offset:2048 lds
    buffer_load_dwordx4 v123, s[20:23], s44 offen offset:3072 lds
    s_add_u32 m0, s47, 0
    s_nop 0
    buffer_load_dwordx4 v124, s[24:27], s45 offen offset:0 lds
    buffer_load_dwordx4 v125, s[24:27], s45 offen offset:1024 lds
    buffer_load_dwordx4 v126, s[24:27], s45 offen offset:2048 lds
    buffer_load_dwordx4 v127, s[24:27], s45 offen offset:3072 lds
    s_add_u32 m0, s47, 4096
    s_nop 0
    buffer_load_dwordx4 v128, s[24:27], s45 offen offset:0 lds
    s_add_u32 m0, s47, 5120
    s_nop 0
    buffer_load_dwordx4 v124, s[24:27], s48 offen offset:0 lds
    buffer_load_dwordx4 v125, s[24:27], s48 offen offset:1024 lds
    buffer_load_dwordx4 v126, s[24:27], s48 offen offset:2048 lds
    buffer_load_dwordx4 v127, s[24:27], s48 offen offset:3072 lds
    s_add_u32 m0, s47, 9216
    s_nop 0
    buffer_load_dwordx4 v128, s[24:27], s48 offen offset:0 lds
    s_add_u32 s44, s44, 128
    s_add_u32 s45, s45, 221184
    s_add_u32 s48, s48, 221184
    s_add_u32 s46, s46, 0xfffe5000
    s_add_u32 s47, s47, 0xfffe5000
    s_mov_b32 m0, s46
    s_nop 0
    buffer_load_dwordx4 v120, s[20:23], s44 offen offset:0 lds
    buffer_load_dwordx4 v121, s[20:23], s44 offen offset:1024 lds
    buffer_load_dwordx4 v122, s[20:23], s44 offen offset:2048 lds
    buffer_load_dwordx4 v123, s[20:23], s44 offen offset:3072 lds
    s_add_u32 m0, s47, 0
    s_nop 0
    buffer_load_dwordx4 v124, s[24:27], s45 offen offset:0 lds
    buffer_load_dwordx4 v125, s[24:27], s45 offen offset:1024 lds
    buffer_load_dwordx4 v126, s[24:27], s45 offen offset:2048 lds
    buffer_load_dwordx4 v127, s[24:27], s45 offen offset:3072 lds
    s_add_u32 m0, s47, 4096
    s_nop 0
    buffer_load_dwordx4 v128, s[24:27], s45 offen offset:0 lds
    s_add_u32 m0, s47, 5120
    s_nop 0
    buffer_load_dwordx4 v124, s[24:27], s48 offen offset:0 lds
    buffer_load_dwordx4 v125, s[24:27], s48 offen offset:1024 lds
    buffer_load_dwordx4 v126, s[24:27], s48 offen offset:2048 lds
    buffer_load_dwordx4 v127, s[24:27], s48 offen offset:3072 lds
    s_add_u32 m0, s47, 9216
    s_nop 0
    buffer_load_dwordx4 v128, s[24:27], s48 offen offset:0 lds
    s_add_u32 s44, s44, 128
    s_add_u32 s45, s45, 221184
    s_add_u32 s48, s48, 221184
    s_add_u32 s46, s46, 0x9000
    s_add_u32 s47, s47, 0x9000
    s_waitcnt vmcnt(28)
    s_barrier
    s_mov_b32 m0, s46
    s_nop 0
    buffer_load_dwordx4 v120, s[20:23], s44 offen offset:0 lds
    buffer_load_dwordx4 v121, s[20:23], s44 offen offset:1024 lds
    buffer_load_dwordx4 v122, s[20:23], s44 offen offset:2048 lds
    buffer_load_dwordx4 v123, s[20:23], s44 offen offset:3072 lds
    s_add_u32 m0, s47, 0
    s_nop 0
    buffer_load_dwordx4 v124, s[24:27], s45 offen offset:0 lds
    buffer_load_dwordx4 v125, s[24:27], s45 offen offset:1024 lds
    buffer_load_dwordx4 v126, s[24:27], s45 offen offset:2048 lds
    buffer_load_dwordx4 v127, s[24:27], s45 offen offset:3072 lds
    s_add_u32 m0, s47, 4096
    s_nop 0
    buffer_load_dwordx4 v128, s[24:27], s45 offen offset:0 lds
    s_add_u32 m0, s47, 5120
    s_nop 0
    buffer_load_dwordx4 v124, s[24:27], s48 offen offset:0 lds
    buffer_load_dwordx4 v125, s[24:27], s48 offen offset:1024 lds
    buffer_load_dwordx4 v126, s[24:27], s48 offen offset:2048 lds
    buffer_load_dwordx4 v127, s[24:27], s48 offen offset:3072 lds
    s_add_u32 m0, s47, 9216
    s_nop 0
    buffer_load_dwordx4 v128, s[24:27], s48 offen offset:0 lds
    s_add_u32 s44, s44, 128
    s_add_u32 s45, s45, 221184
    s_add_u32 s48, s48, 221184
    s_add_u32 s46, s46, 0x9000
    s_add_u32 s47, s47, 0x9000
    s_waitcnt vmcnt(28)
    s_barrier
    s_mov_b32 m0, s46
    s_nop 0
    buffer_load_dwordx4 v120, s[20:23], s44 offen offset:0 lds
    buffer_load_dwordx4 v121, s[20:23], s44 offen offset:1024 lds
    buffer_load_dwordx4 v122, s[20:23], s44 offen offset:2048 lds
    buffer_load_dwordx4 v123, s[20:23], s44 offen offset:3072 lds
    s_add_u32 m0, s47, 0
    s_nop 0
    buffer_load_dwordx4 v124, s[24:27], s45 offen offset:0 lds
    buffer_load_dwordx4 v125, s[24:27], s45 offen offset:1024 lds
    buffer_load_dwordx4 v126, s[24:27], s45 offen offset:2048 lds
    buffer_load_dwordx4 v127, s[24:27], s45 offen offset:3072 lds
    s_add_u32 m0, s47, 4096
    s_nop 0
    buffer_load_dwordx4 v128, s[24:27], s45 offen offset:0 lds
    s_add_u32 m0, s47, 5120
    s_nop 0
    buffer_load_dwordx4 v124, s[24:27], s48 offen offset:0 lds
    buffer_load_dwordx4 v125, s[24:27], s48 offen offset:1024 lds
    buffer_load_dwordx4 v126, s[24:27], s48 offen offset:2048 lds
    buffer_load_dwordx4 v127, s[24:27], s48 offen offset:3072 lds
    s_add_u32 m0, s47, 9216
    s_nop 0
    buffer_load_dwordx4 v128, s[24:27], s48 offen offset:0 lds
    s_add_u32 s44, s44, 128
    s_add_u32 s45, s45, 221184
    s_add_u32 s48, s48, 221184
    s_add_u32 s46, s46, 0x9000
    s_add_u32 s47, s47, 0x9000
    s_waitcnt vmcnt(28)
    s_barrier
    s_mov_b32 m0, s46
    s_nop 0
    buffer_load_dwordx4 v120, s[20:23], s44 offen offset:0 lds
    buffer_load_dwordx4 v121, s[20:23], s44 offen offset:1024 lds
    buffer_load_dwordx4 v122, s[20:23], s44 offen offset:2048 lds
    buffer_load_dwordx4 v123, s[20:23], s44 offen offset:3072 lds
    s_add_u32 m0, s47, 0
    s_nop 0
    buffer_load_dwordx4 v124, s[24:27], s45 offen offset:0 lds
    buffer_load_dwordx4 v125, s[24:27], s45 offen offset:1024 lds
    buffer_load_dwordx4 v126, s[24:27], s45 offen offset:2048 lds
    buffer_load_dwordx4 v127, s[24:27], s45 offen offset:3072 lds
    s_add_u32 m0, s47, 4096
    s_nop 0
    buffer_load_dwordx4 v128, s[24:27], s45 offen offset:0 lds
    s_add_u32 m0, s47, 5120
    s_nop 0
    buffer_load_dwordx4 v124, s[24:27], s48 offen offset:0 lds
    buffer_load_dwordx4 v125, s[24:27], s48 offen offset:1024 lds
    buffer_load_dwordx4 v126, s[24:27], s48 offen offset:2048 lds
    buffer_load_dwordx4 v127, s[24:27], s48 offen offset:3072 lds
    s_add_u32 m0, s47, 9216
    s_nop 0
    buffer_load_dwordx4 v128, s[24:27], s48 offen offset:0 lds
    s_add_u32 s44, s44, 128
    s_add_u32 s45, s45, 221184
    s_add_u32 s48, s48, 221184
    s_add_u32 s46, s46, 0xfffe5000
    s_add_u32 s47, s47, 0xfffe5000
    s_waitcnt vmcnt(28)
    s_barrier
    s_mov_b32 m0, s46
    s_nop 0
    buffer_load_dwordx4 v120, s[20:23], s44 offen offset:0 lds
    buffer_load_dwordx4 v121, s[20:23], s44 offen offset:1024 lds
    buffer_load_dwordx4 v122, s[20:23], s44 offen offset:2048 lds
    buffer_load_dwordx4 v123, s[20:23], s44 offen offset:3072 lds
    s_add_u32 m0, s47, 0
    s_nop 0
    buffer_load_dwordx4 v124, s[24:27], s45 offen offset:0 lds
    buffer_load_dwordx4 v125, s[24:27], s45 offen offset:1024 lds
    buffer_load_dwordx4 v126, s[24:27], s45 offen offset:2048 lds
    buffer_load_dwordx4 v127, s[24:27], s45 offen offset:3072 lds
    s_add_u32 m0, s47, 4096
    s_nop 0
    buffer_load_dwordx4 v128, s[24:27], s45 offen offset:0 lds
    s_add_u32 m0, s47, 5120
    s_nop 0
    buffer_load_dwordx4 v124, s[24:27], s48 offen offset:0 lds
    buffer_load_dwordx4 v125, s[24:27], s48 offen offset:1024 lds
    buffer_load_dwordx4 v126, s[24:27], s48 offen offset:2048 lds
    buffer_load_dwordx4 v127, s[24:27], s48 offen offset:3072 lds
    s_add_u32 m0, s47, 9216
    s_nop 0
    buffer_load_dwordx4 v128, s[24:27], s48 offen offset:0 lds
    s_add_u32 s44, s44, 128
    s_add_u32 s45, s45, 221184
    s_add_u32 s48, s48, 221184
    s_add_u32 s46, s46, 0x9000
    s_add_u32 s47, s47, 0x9000
    s_waitcnt vmcnt(28)
    s_barrier
    s_mov_b32 s28, s54
    s_and_b32 s29, s55, 0xffff
    s_mov_b32 s30, 0x5100
    s_mov_b32 s31, 0x00020000
    s_add_u32 s32, s8, 0x1000000
    s_addc_u32 s33, s9, 0
    s_and_b32 s33, s33, 0xffff
    s_mov_b32 s34, 0x16000
    s_mov_b32 s35, 0x00020000
    s_add_u32 s36, s8, 0xa80000
    s_addc_u32 s37, s9, 0
    s_and_b32 s37, s37, 0xffff
    s_mov_b32 s38, 0x480000
    s_mov_b32 s39, 0x00020000
    s_mov_b32 s40, s40
    s_and_b32 s41, s41, 0xffff
    s_mov_b32 s42, 0x100
    s_mov_b32 s43, 0x00020000
    s_add_u32 s96, s8, 0x10e0000
    s_addc_u32 s97, s9, 0
    s_and_b32 s97, s97, 0xffff
    s_mov_b32 s98, 0x6000
    s_mov_b32 s99, 0x00020000
    v_bfe_u32 v3, v1, 2, 2
    v_and_b32 v4, 3, v1
    v_and_b32 v5, 15, v1
    v_mov_b32 v24, 154368
    s_lshl_b32 s16, s15, 1
    s_mul_i32 s17, s15, 768
    s_add_u32 s17, s17, 147456
    v_mul_u32_u24 v8, 1728, v2
    v_add_u32 v8, s17, v8
    v_cmp_eq_u32 s[18:19], v2, v4
    v_add_u32 v9, 0, v3
    v_mad_u32_u24 v14, v9, 48, v8
    v_cndmask_b32 v14, v24, v14, s[18:19]
    v_subrev_u32 v9, s16, v9
    v_cmp_gt_u32 vcc, 18, v9
    s_nop 1
    v_cndmask_b32 v14, v24, v14, vcc
    v_add_u32 v9, 4, v3
    v_mad_u32_u24 v15, v9, 48, v8
    v_cndmask_b32 v15, v24, v15, s[18:19]
    v_add_u32 v9, 8, v3
    v_mad_u32_u24 v16, v9, 48, v8
    v_cndmask_b32 v16, v24, v16, s[18:19]
    v_add_u32 v9, 12, v3
    v_mad_u32_u24 v17, v9, 48, v8
    v_cndmask_b32 v17, v24, v17, s[18:19]
    v_add_u32 v9, 16, v3
    v_mad_u32_u24 v18, v9, 48, v8
    v_cndmask_b32 v18, v24, v18, s[18:19]
    v_subrev_u32 v9, s16, v9
    v_cmp_gt_u32 vcc, 18, v9
    s_nop 1
    v_cndmask_b32 v18, v24, v18, vcc
    v_add_u32 v9, 20, v3
    v_mad_u32_u24 v19, v9, 48, v8
    v_cndmask_b32 v19, v24, v19, s[18:19]
    v_subrev_u32 v9, s16, v9
    v_cmp_gt_u32 vcc, 18, v9
    s_nop 1
    v_cndmask_b32 v19, v24, v19, vcc
    s_mul_i32 s16, s14, 10240
    s_add_u32 s16, s16, 81920
    v_lshlrev_b32 v211, 4, v1
    v_add_u32 v211, s16, v211
    s_waitcnt vmcnt(14)
    s_barrier
    s_waitcnt vmcnt(0)
    s_barrier
p1q_pjoin:
    ds_read_b64_tr_b16 v[216:217], v14 offset:0
    ds_read_b64_tr_b16 v[218:219], v15 offset:0
    ds_read_b64_tr_b16 v[220:221], v14 offset:8
    ds_read_b64_tr_b16 v[222:223], v15 offset:8
    ds_read_b64_tr_b16 v[224:225], v14 offset:16
    ds_read_b64_tr_b16 v[226:227], v15 offset:16
    ds_read_b64_tr_b16 v[228:229], v14 offset:24
    ds_read_b64_tr_b16 v[230:231], v15 offset:24
    ds_read_b64_tr_b16 v[232:233], v14 offset:32
    ds_read_b64_tr_b16 v[234:235], v15 offset:32
    ds_read_b64_tr_b16 v[236:237], v16 offset:0
    ds_read_b64_tr_b16 v[238:239], v17 offset:0
    ds_read_b64_tr_b16 v[240:241], v16 offset:8
    ds_read_b64_tr_b16 v[242:243], v17 offset:8
    ds_read_b64_tr_b16 v[244:245], v16 offset:16
    ds_read_b64_tr_b16 v[246:247], v17 offset:16
    ds_read_b64_tr_b16 v[248:249], v16 offset:24
    ds_read_b64_tr_b16 v[250:251], v17 offset:24
    ds_read_b64_tr_b16 v[252:253], v16 offset:32
    ds_read_b64_tr_b16 v[254:255], v17 offset:32
    ds_read_b64_tr_b16 v[168:169], v18 offset:0
    ds_read_b64_tr_b16 v[170:171], v19 offset:0
    ds_read_b64_tr_b16 v[172:173], v18 offset:8
    ds_read_b64_tr_b16 v[174:175], v19 offset:8
    ds_read_b64_tr_b16 v[176:177], v18 offset:16
    ds_read_b64_tr_b16 v[178:179], v19 offset:16
    ds_read_b64_tr_b16 v[180:181], v18 offset:24
    ds_read_b64_tr_b16 v[182:183], v19 offset:24
    ds_read_b64_tr_b16 v[184:185], v18 offset:32
    ds_read_b64_tr_b16 v[186:187], v19 offset:32
    s_waitcnt lgkmcnt(0)
    s_barrier
    ds_read_b64 v[12:13], v211 offset:9216
    ds_read_b128 v[28:31], v211 offset:0
    ds_read_b128 v[32:35], v211 offset:1024
    ds_read_b128 v[36:39], v211 offset:2048
    ds_read_b128 v[40:43], v211 offset:3072
    ds_read_b128 v[44:47], v211 offset:4096
    s_waitcnt lgkmcnt(5)
    v_mov_b32 v8, v13
    s_nop 1
    v_permlane32_swap_b32 v13, v8
    v_add_f32 v13, v13, v8
    v_mov_b32 v8, v13
    s_nop 1
    v_permlane16_swap_b32 v13, v8
    v_add_f32 v13, v13, v8
    v_mul_f32 v12, 0x3ae38e39, v12
    v_mul_f32 v13, 0x3ae38e39, v13
    v_fma_f32 v13, -v12, v12, v13
    v_max_f32 v13, 0, v13
    v_add_f32 v13, 0x3727c5ac, v13
    v_rsq_f32 v13, v13
    s_nop 0
    v_mul_f32 v12, v12, v13
    s_mov_b32 s53, 0
    v_mov_b32 v48, 0
    v_mov_b32 v49, 0
    v_mov_b32 v50, 0
    v_mov_b32 v51, 0
    s_branch p1q_post
p1_qc:
    v_and_b32 v1, 63, v0
    v_lshrrev_b32 v2, 4, v1
    v_bfe_u32 v3, v1, 2, 2
    v_and_b32 v4, 3, v1
    v_and_b32 v5, 15, v1
    s_mov_b32 s28, s54
    s_and_b32 s29, s55, 0xffff
    s_mov_b32 s30, 0x5100
    s_mov_b32 s31, 0x00020000
    s_add_u32 s32, s8, 0x1000000
    s_addc_u32 s33, s9, 0
    s_and_b32 s33, s33, 0xffff
    s_mov_b32 s34, 0x16000
    s_mov_b32 s35, 0x00020000
    s_add_u32 s36, s8, 0xa80000
    s_addc_u32 s37, s9, 0
    s_and_b32 s37, s37, 0xffff
    s_mov_b32 s38, 0x480000
    s_mov_b32 s39, 0x00020000
    s_mov_b32 s40, s40
    s_and_b32 s41, s41, 0xffff
    s_mov_b32 s42, 0x100
    s_mov_b32 s43, 0x00020000
    s_add_u32 s96, s8, 0x10e0000
    s_addc_u32 s97, s9, 0
    s_and_b32 s97, s97, 0xffff
    s_mov_b32 s98, 0x6000
    s_mov_b32 s99, 0x00020000
    v_and_b32 v6, 1, v2
    v_mul_u32_u24 v208, 2432, v6
    v_lshrrev_b32 v6, 1, v2
    v_mul_u32_u24 v6, 5120, v6
    v_add_u32 v208, v208, v6
    v_mul_u32_u24 v6, 288, v3
    v_mul_u32_u24 v7, 72, v4
    v_add3_u32 v208, v208, v6, v7
    v_add_u32 v208, 16384, v208
    v_lshrrev_b32 v6, 1, v5
    v_xor_b32 v6, v6, v2
    v_lshlrev_b32 v6, 4, v6
    v_lshl_add_u32 v6, v5, 7, v6
    s_lshl_b32 s16, s14, 11
    v_add_u32 v209, s16, v6
    v_xor_b32 v210, 64, v209
    s_mul_i32 s16, s14, 10240
    s_add_u32 s16, s16, 81920
    v_lshlrev_b32 v211, 4, v1
    v_add_u32 v211, s16, v211
    v_mov_b32 v28, 0
    v_mov_b32 v29, 0
    v_mov_b32 v30, 0
    v_mov_b32 v31, 0
    v_mov_b32 v32, 0
    v_mov_b32 v33, 0
    v_mov_b32 v34, 0
    v_mov_b32 v35, 0
    v_mov_b32 v36, 0
    v_mov_b32 v37, 0
    v_mov_b32 v38, 0
    v_mov_b32 v39, 0
    v_mov_b32 v40, 0
    v_mov_b32 v41, 0
    v_mov_b32 v42, 0
    v_mov_b32 v43, 0
    v_mov_b32 v44, 0
    v_mov_b32 v45, 0
    v_mov_b32 v46, 0
    v_mov_b32 v47, 0
    v_mov_b32 v48, 0
    v_mov_b32 v49, 0
    v_mov_b32 v50, 0
    v_mov_b32 v51, 0
    v_mov_b32 v52, 0
    v_mov_b32 v53, 0
    v_mov_b32 v54, 0
    v_mov_b32 v55, 0
    v_mov_b32 v56, 0
    v_mov_b32 v57, 0
    v_mov_b32 v58, 0
    v_mov_b32 v59, 0
    v_mov_b32 v60, 0
    v_mov_b32 v61, 0
    v_mov_b32 v62, 0
    v_mov_b32 v63, 0
    v_mov_b32 v100, 0
    v_mov_b32 v101, 0
    v_mov_b32 v102, 0
    v_mov_b32 v103, 0
    v_mov_b32 v104, 0
    v_mov_b32 v105, 0
    v_mov_b32 v106, 0
    v_mov_b32 v107, 0
    v_mov_b32 v116, 0x3f803f80
    v_mov_b32 v117, 0x3f803f80
    v_mov_b32 v118, 0x3f803f80
    v_mov_b32 v119, 0x3f803f80
    v_mov_b32 v24, 154368
    s_lshl_b32 s16, s15, 1
    s_mul_i32 s17, s15, 768
    s_add_u32 s17, s17, 147456
    v_mul_u32_u24 v8, 1728, v2
    v_add_u32 v8, s17, v8
    v_cmp_eq_u32 s[18:19], v2, v4
    v_add_u32 v9, 0, v3
    v_mad_u32_u24 v14, v9, 48, v8
    v_cndmask_b32 v14, v24, v14, s[18:19]
    v_subrev_u32 v9, s16, v9
    v_cmp_gt_u32 vcc, 18, v9
    s_nop 1
    v_cndmask_b32 v14, v24, v14, vcc
    v_add_u32 v9, 4, v3
    v_mad_u32_u24 v15, v9, 48, v8
    v_cndmask_b32 v15, v24, v15, s[18:19]
    v_add_u32 v9, 8, v3
    v_mad_u32_u24 v16, v9, 48, v8
    v_cndmask_b32 v16, v24, v16, s[18:19]
    v_add_u32 v9, 12, v3
    v_mad_u32_u24 v17, v9, 48, v8
    v_cndmask_b32 v17, v24, v17, s[18:19]
    v_add_u32 v9, 16, v3
    v_mad_u32_u24 v18, v9, 48, v8
    v_cndmask_b32 v18, v24, v18, s[18:19]
    v_subrev_u32 v9, s16, v9
    v_cmp_gt_u32 vcc, 18, v9
    s_nop 1
    v_cndmask_b32 v18, v24, v18, vcc
    v_add_u32 v9, 20, v3
    v_mad_u32_u24 v19, v9, 48, v8
    v_cndmask_b32 v19, v24, v19, s[18:19]
    v_subrev_u32 v9, s16, v9
    v_cmp_gt_u32 vcc, 18, v9
    s_nop 1
    v_cndmask_b32 v19, v24, v19, vcc
    v_cmp_eq_u32 s[16:17], 1, v4
    v_cmp_eq_u32 s[18:19], 2, v4
    v_cmp_eq_u32 s[56:57], 3, v4
    v_cmp_eq_u32 s[58:59], v2, v3
    s_setprio 2
    s_mov_b32 s49, 0
    s_mov_b32 s52, 36864
    s_mov_b32 s50, 0
    s_barrier
    ds_read_b128 v[156:159], v209 offset:0
    ds_read_b64_tr_b16 v[120:121], v208 offset:0
    ds_read_b64_tr_b16 v[122:123], v208 offset:1152
    ds_read_b64_tr_b16 v[124:125], v208 offset:8
    ds_read_b64_tr_b16 v[126:127], v208 offset:1160
    ds_read_b64_tr_b16 v[128:129], v208 offset:16
    ds_read_b64_tr_b16 v[130:131], v208 offset:1168
    ds_read_b64_tr_b16 v[132:133], v208 offset:24
    ds_read_b64_tr_b16 v[134:135], v208 offset:1176
    ds_read_b64_tr_b16 v[136:137], v208 offset:32
    ds_read_b64_tr_b16 v[138:139], v208 offset:1184
    ds_read_b64_tr_b16 v[140:141], v208 offset:40
    ds_read_b64_tr_b16 v[142:143], v208 offset:1192
    ds_read_b64_tr_b16 v[144:145], v208 offset:48
    ds_read_b64_tr_b16 v[146:147], v208 offset:1200
    ds_read_b64_tr_b16 v[148:149], v208 offset:56
    ds_read_b64_tr_b16 v[150:151], v208 offset:1208
    ds_read_b64_tr_b16 v[152:153], v208 offset:64
    ds_read_b64_tr_b16 v[154:155], v208 offset:1216
p1q_cloop:
    s_waitcnt lgkmcnt(0)
    v_mfma_f32_16x16x32_bf16 v[100:103], v[116:119], v[156:159], v[100:103]
    ds_read_b128 v[200:203], v210 offset:0
    ds_read_b64_tr_b16 v[164:165], v208 offset:10240
    v_mfma_f32_16x16x32_bf16 v[104:107], v[156:159], v[156:159], v[104:107]
    ds_read_b64_tr_b16 v[166:167], v208 offset:11392
    ds_read_b64_tr_b16 v[168:169], v208 offset:10248
    v_mfma_f32_16x16x32_bf16 v[28:31], v[120:123], v[156:159], v[28:31]
    ds_read_b64_tr_b16 v[170:171], v208 offset:11400
    ds_read_b64_tr_b16 v[172:173], v208 offset:10256
    v_mfma_f32_16x16x32_bf16 v[32:35], v[124:127], v[156:159], v[32:35]
    ds_read_b64_tr_b16 v[174:175], v208 offset:11408
    ds_read_b64_tr_b16 v[176:177], v208 offset:10264
    v_mfma_f32_16x16x32_bf16 v[36:39], v[128:131], v[156:159], v[36:39]
    ds_read_b64_tr_b16 v[178:179], v208 offset:11416
    ds_read_b64_tr_b16 v[180:181], v208 offset:10272
    v_mfma_f32_16x16x32_bf16 v[40:43], v[132:135], v[156:159], v[40:43]
    ds_read_b64_tr_b16 v[182:183], v208 offset:11424
    ds_read_b64_tr_b16 v[184:185], v208 offset:10280
    v_mfma_f32_16x16x32_bf16 v[44:47], v[136:139], v[156:159], v[44:47]
    ds_read_b64_tr_b16 v[186:187], v208 offset:11432
    ds_read_b64_tr_b16 v[188:189], v208 offset:10288
    v_mfma_f32_16x16x32_bf16 v[48:51], v[140:143], v[156:159], v[48:51]
    ds_read_b64_tr_b16 v[190:191], v208 offset:11440
    ds_read_b64_tr_b16 v[192:193], v208 offset:10296
    v_mfma_f32_16x16x32_bf16 v[52:55], v[144:147], v[156:159], v[52:55]
    ds_read_b64_tr_b16 v[194:195], v208 offset:11448
    ds_read_b64_tr_b16 v[196:197], v208 offset:10304
    v_mfma_f32_16x16x32_bf16 v[56:59], v[148:151], v[156:159], v[56:59]
    ds_read_b64_tr_b16 v[198:199], v208 offset:11456
    s_add_u32 s49, s49, 1
    v_mfma_f32_16x16x32_bf16 v[60:63], v[152:155], v[156:159], v[60:63]
    s_cmp_eq_u32 s49, 4
    s_cselect_b32 s51, 0xfffe5000, s52
    s_cselect_b32 s49, 0, s49
    v_add_u32 v208, s51, v208
    v_add_u32 v209, s51, v209
    v_add_u32 v210, s51, v210
    s_add_u32 s50, s50, 1
    s_cmp_lt_u32 s50, 9
    s_waitcnt lgkmcnt(0)
    v_mfma_f32_16x16x32_bf16 v[100:103], v[116:119], v[200:203], v[100:103]
    v_mfma_f32_16x16x32_bf16 v[104:107], v[200:203], v[200:203], v[104:107]
    v_mfma_f32_16x16x32_bf16 v[28:31], v[164:167], v[200:203], v[28:31]
    s_cbranch_scc0 p1q_clast
    s_barrier
    v_mfma_f32_16x16x32_bf16 v[32:35], v[168:171], v[200:203], v[32:35]
    ds_read_b128 v[156:159], v209 offset:0
    ds_read_b64_tr_b16 v[120:121], v208 offset:0
    v_mfma_f32_16x16x32_bf16 v[36:39], v[172:175], v[200:203], v[36:39]
    ds_read_b64_tr_b16 v[122:123], v208 offset:1152
    ds_read_b64_tr_b16 v[124:125], v208 offset:8
    v_mfma_f32_16x16x32_bf16 v[40:43], v[176:179], v[200:203], v[40:43]
    ds_read_b64_tr_b16 v[126:127], v208 offset:1160
    ds_read_b64_tr_b16 v[128:129], v208 offset:16
    v_mfma_f32_16x16x32_bf16 v[44:47], v[180:183], v[200:203], v[44:47]
    ds_read_b64_tr_b16 v[130:131], v208 offset:1168
    ds_read_b64_tr_b16 v[132:133], v208 offset:24
    v_mfma_f32_16x16x32_bf16 v[48:51], v[184:187], v[200:203], v[48:51]
    ds_read_b64_tr_b16 v[134:135], v208 offset:1176
    ds_read_b64_tr_b16 v[136:137], v208 offset:32
    v_mfma_f32_16x16x32_bf16 v[52:55], v[188:191], v[200:203], v[52:55]
    ds_read_b64_tr_b16 v[138:139], v208 offset:1184
    ds_read_b64_tr_b16 v[140:141], v208 offset:40
    v_mfma_f32_16x16x32_bf16 v[56:59], v[192:195], v[200:203], v[56:59]
    ds_read_b64_tr_b16 v[142:143], v208 offset:1192
    ds_read_b64_tr_b16 v[144:145], v208 offset:48
    v_mfma_f32_16x16x32_bf16 v[60:63], v[196:199], v[200:203], v[60:63]
    ds_read_b64_tr_b16 v[146:147], v208 offset:1200
    ds_read_b64_tr_b16 v[148:149], v208 offset:56
    ds_read_b64_tr_b16 v[150:151], v208 offset:1208
    ds_read_b64_tr_b16 v[152:153], v208 offset:64
    ds_read_b64_tr_b16 v[154:155], v208 offset:1216
    s_branch p1q_cloop
p1q_clast:
    v_mfma_f32_16x16x32_bf16 v[32:35], v[168:171], v[200:203], v[32:35]
    v_mfma_f32_16x16x32_bf16 v[36:39], v[172:175], v[200:203], v[36:39]
    v_mfma_f32_16x16x32_bf16 v[40:43], v[176:179], v[200:203], v[40:43]
    v_mfma_f32_16x16x32_bf16 v[44:47], v[180:183], v[200:203], v[44:47]
    v_mfma_f32_16x16x32_bf16 v[48:51], v[184:187], v[200:203], v[48:51]
    v_mfma_f32_16x16x32_bf16 v[52:55], v[188:191], v[200:203], v[52:55]
    v_mfma_f32_16x16x32_bf16 v[56:59], v[192:195], v[200:203], v[56:59]
    v_mfma_f32_16x16x32_bf16 v[60:63], v[196:199], v[200:203], v[60:63]
    s_setprio 0
    v_cndmask_b32 v7, v104, v105, s[16:17]
    v_cndmask_b32 v7, v7, v106, s[18:19]
    v_cndmask_b32 v7, v7, v107, s[56:57]
    v_cndmask_b32 v101, 0, v7, s[58:59]
    ds_write_b64 v211, v[100:101] offset:9216
    ds_write_b128 v211, v[44:47] offset:0
    ds_write_b128 v211, v[48:51] offset:1024
    ds_write_b128 v211, v[52:55] offset:2048
    ds_write_b128 v211, v[56:59] offset:3072
    ds_write_b128 v211, v[60:63] offset:4096
    v_mov_b32 v12, v100
    v_mov_b32 v13, v101
    v_mov_b32 v8, v13
    s_nop 1
    v_permlane32_swap_b32 v13, v8
    v_add_f32 v13, v13, v8
    v_mov_b32 v8, v13
    s_nop 1
    v_permlane16_swap_b32 v13, v8
    v_add_f32 v13, v13, v8
    v_mul_f32 v12, 0x3ae38e39, v12
    v_mul_f32 v13, 0x3ae38e39, v13
    v_fma_f32 v13, -v12, v12, v13
    v_max_f32 v13, 0, v13
    v_add_f32 v13, 0x3727c5ac, v13
    v_rsq_f32 v13, v13
    s_nop 0
    v_mul_f32 v12, v12, v13
    s_waitcnt lgkmcnt(0)
    s_barrier
    s_mov_b32 s53, 1
    s_branch p1q_post
p1q_helper:
    s_mov_b32 s28, s54
    s_and_b32 s29, s55, 0xffff
    s_mov_b32 s30, 0x5100
    s_mov_b32 s31, 0x00020000
    s_add_u32 s32, s8, 0x1000000
    s_addc_u32 s33, s9, 0
    s_and_b32 s33, s33, 0xffff
    s_mov_b32 s34, 0x16000
    s_mov_b32 s35, 0x00020000
    s_add_u32 s36, s8, 0xa80000
    s_addc_u32 s37, s9, 0
    s_and_b32 s37, s37, 0xffff
    s_mov_b32 s38, 0x480000
    s_mov_b32 s39, 0x00020000
    s_mov_b32 s40, s40
    s_and_b32 s41, s41, 0xffff
    s_mov_b32 s42, 0x100
    s_mov_b32 s43, 0x00020000
    s_add_u32 s96, s8, 0x10e0000
    s_addc_u32 s97, s9, 0
    s_and_b32 s97, s97, 0xffff
    s_mov_b32 s98, 0x6000
    s_mov_b32 s99, 0x00020000
    s_and_b32 s48, s13, 1
    s_lshl_b32 s12, s2, 1
    s_add_u32 s12, s12, s48
    s_mul_i32 s16, s11, 5184
    s_movk_i32 s17, 7282
    v_and_b32 v24, 127, v0
    v_add_u32 v6, 0, v24
    v_mul_lo_u32 v7, v6, s17
    v_lshrrev_b32 v7, 16, v7
    v_mul_u32_u24 v7, 12, v7
    v_lshlrev_b32 v8, 2, v6
    v_add3_u32 v148, v7, v8, 0
    v_add_u32 v148, 147456, v148
    buffer_load_dword v136, v8, s[28:31], s16 offen
    v_add_u32 v6, 128, v24
    v_mul_lo_u32 v7, v6, s17
    v_lshrrev_b32 v7, 16, v7
    v_mul_u32_u24 v7, 12, v7
    v_lshlrev_b32 v8, 2, v6
    v_add3_u32 v149, v7, v8, 0
    v_add_u32 v149, 147456, v149
    buffer_load_dword v137, v8, s[28:31], s16 offen
    v_add_u32 v6, 256, v24
    v_mul_lo_u32 v7, v6, s17
    v_lshrrev_b32 v7, 16, v7
    v_mul_u32_u24 v7, 12, v7
    v_lshlrev_b32 v8, 2, v6
    v_add3_u32 v150, v7, v8, 0
    v_add_u32 v150, 147456, v150
    buffer_load_dword v138, v8, s[28:31], s16 offen
    v_add_u32 v6, 384, v24
    v_mul_lo_u32 v7, v6, s17
    v_lshrrev_b32 v7, 16, v7
    v_mul_u32_u24 v7, 12, v7
    v_lshlrev_b32 v8, 2, v6
    v_add3_u32 v151, v7, v8, 0
    v_add_u32 v151, 147456, v151
    buffer_load_dword v139, v8, s[28:31], s16 offen
    v_add_u32 v6, 512, v24
    v_mul_lo_u32 v7, v6, s17
    v_lshrrev_b32 v7, 16, v7
    v_mul_u32_u24 v7, 12, v7
    v_lshlrev_b32 v8, 2, v6
    v_add3_u32 v152, v7, v8, 0
    v_add_u32 v152, 147456, v152
    buffer_load_dword v140, v8, s[28:31], s16 offen
    v_add_u32 v6, 640, v24
    v_mul_lo_u32 v7, v6, s17
    v_lshrrev_b32 v7, 16, v7
    v_mul_u32_u24 v7, 12, v7
    v_lshlrev_b32 v8, 2, v6
    v_add3_u32 v153, v7, v8, 0
    v_add_u32 v153, 147456, v153
    buffer_load_dword v141, v8, s[28:31], s16 offen
    v_add_u32 v6, 768, v24
    v_mul_lo_u32 v7, v6, s17
    v_lshrrev_b32 v7, 16, v7
    v_mul_u32_u24 v7, 12, v7
    v_lshlrev_b32 v8, 2, v6
    v_add3_u32 v154, v7, v8, 0
    v_add_u32 v154, 147456, v154
    buffer_load_dword v142, v8, s[28:31], s16 offen
    v_add_u32 v6, 896, v24
    v_mul_lo_u32 v7, v6, s17
    v_lshrrev_b32 v7, 16, v7
    v_mul_u32_u24 v7, 12, v7
    v_lshlrev_b32 v8, 2, v6
    v_add3_u32 v155, v7, v8, 0
    v_add_u32 v155, 147456, v155
    buffer_load_dword v143, v8, s[28:31], s16 offen
    v_add_u32 v6, 1024, v24
    v_mul_lo_u32 v7, v6, s17
    v_lshrrev_b32 v7, 16, v7
    v_mul_u32_u24 v7, 12, v7
    v_lshlrev_b32 v8, 2, v6
    v_add3_u32 v156, v7, v8, 0
    v_add_u32 v156, 147456, v156
    buffer_load_dword v144, v8, s[28:31], s16 offen
    v_add_u32 v6, 1152, v24
    v_mul_lo_u32 v7, v6, s17
    v_lshrrev_b32 v7, 16, v7
    v_mul_u32_u24 v7, 12, v7
    v_lshlrev_b32 v8, 2, v6
    v_add3_u32 v157, v7, v8, 0
    v_add_u32 v157, 147456, v157
    buffer_load_dword v145, v8, s[28:31], s16 offen
    v_add_u32 v6, 1280, v24
    v_mul_lo_u32 v7, v6, s17
    v_lshrrev_b32 v7, 16, v7
    v_mul_u32_u24 v7, 12, v7
    v_lshlrev_b32 v8, 2, v6
    v_add3_u32 v158, v7, v8, 0
    v_add_u32 v158, 147456, v158
    v_cmp_gt_u32 vcc, 1296, v6
    v_mov_b32 v9, 0x40000000
    s_nop 0
    v_cndmask_b32 v8, v9, v8, vcc
    v_mov_b32 v9, 155584
    v_cndmask_b32 v158, v9, v158, vcc
    buffer_load_dword v146, v8, s[28:31], s16 offen
    v_mov_b32 v9, 0
    v_add_u32 v6, 0, v24
    v_min_u32 v6, 143, v6
    v_mul_u32_u24 v6, 48, v6
    v_add_u32 v6, 147456, v6
    ds_write2_b32 v6, v9, v9 offset0:9 offset1:10
    ds_write_b32 v6, v9 offset:44
    v_add_u32 v6, 128, v24
    v_min_u32 v6, 143, v6
    v_mul_u32_u24 v6, 48, v6
    v_add_u32 v6, 147456, v6
    ds_write2_b32 v6, v9, v9 offset0:9 offset1:10
    ds_write_b32 v6, v9 offset:44
    v_and_b32 v6, 15, v24
    v_lshlrev_b32 v6, 2, v6
    v_add_u32 v6, 154368, v6
    ds_write_b32 v6, v9
    v_lshlrev_b32 v6, 7, v1
    s_lshl_b32 s16, s12, 13
    buffer_load_dword v212, v6, s[24:27], s16 offen
    buffer_load_dword v213, v6, s[20:23], s16 offen
    s_add_u32 s16, s16, 2097152
    buffer_load_dword v214, v6, s[20:23], s16 offen
    s_load_dwordx2 s[44:45], s[0:1], 40
    s_load_dwordx2 s[46:47], s[0:1], 24
    v_bfe_u32 v3, v1, 2, 2
    v_and_b32 v4, 3, v1
    v_and_b32 v5, 15, v1
    v_and_b32 v6, 1, v2
    v_mul_u32_u24 v208, 2432, v6
    v_lshrrev_b32 v6, 1, v2
    v_mul_u32_u24 v6, 5120, v6
    v_add_u32 v208, v208, v6
    v_mul_u32_u24 v6, 288, v3
    v_mul_u32_u24 v7, 72, v4
    v_add3_u32 v208, v208, v6, v7
    v_add_u32 v208, 16384, v208
    s_mul_i32 s16, s48, 10240
    v_add_u32 v208, s16, v208
    v_mov_b32 v9, 0x3f803f80
    v_cmp_eq_u32 vcc, 0, v5
    s_nop 1
    v_cndmask_b32 v28, 0, v9, vcc
    v_mov_b32 v29, v28
    v_mov_b32 v30, v28
    v_mov_b32 v31, v28
    v_cmp_eq_u32 vcc, 1, v5
    s_nop 1
    v_cndmask_b32 v32, 0, v9, vcc
    v_mov_b32 v33, v32
    v_mov_b32 v34, v32
    v_mov_b32 v35, v32
    v_cmp_eq_u32 vcc, 2, v5
    s_nop 1
    v_cndmask_b32 v36, 0, v9, vcc
    v_mov_b32 v37, v36
    v_mov_b32 v38, v36
    v_mov_b32 v39, v36
    v_cmp_eq_u32 vcc, 3, v5
    s_nop 1
    v_cndmask_b32 v40, 0, v9, vcc
    v_mov_b32 v41, v40
    v_mov_b32 v42, v40
    v_mov_b32 v43, v40
    v_cmp_eq_u32 vcc, 4, v5
    s_nop 1
    v_cndmask_b32 v44, 0, v9, vcc
    v_mov_b32 v45, v44
    v_mov_b32 v46, v44
    v_mov_b32 v47, v44
    v_cmp_eq_u32 vcc, 5, v5
    s_nop 1
    v_cndmask_b32 v48, 0, v9, vcc
    v_mov_b32 v49, v48
    v_mov_b32 v50, v48
    v_mov_b32 v51, v48
    v_cmp_eq_u32 vcc, 6, v5
    s_nop 1
    v_cndmask_b32 v52, 0, v9, vcc
    v_mov_b32 v53, v52
    v_mov_b32 v54, v52
    v_mov_b32 v55, v52
    v_cmp_eq_u32 vcc, 7, v5
    s_nop 1
    v_cndmask_b32 v56, 0, v9, vcc
    v_mov_b32 v57, v56
    v_mov_b32 v58, v56
    v_mov_b32 v59, v56
    v_cmp_eq_u32 vcc, 8, v5
    s_nop 1
    v_cndmask_b32 v60, 0, v9, vcc
    v_mov_b32 v61, v60
    v_mov_b32 v62, v60
    v_mov_b32 v63, v60
    v_mov_b32 v100, 0
    v_mov_b32 v101, 0
    v_mov_b32 v102, 0
    v_mov_b32 v103, 0
    s_waitcnt vmcnt(3)
    ds_write_b32 v148, v136
    ds_write_b32 v149, v137
    ds_write_b32 v150, v138
    ds_write_b32 v151, v139
    ds_write_b32 v152, v140
    ds_write_b32 v153, v141
    ds_write_b32 v154, v142
    ds_write_b32 v155, v143
    ds_write_b32 v156, v144
    ds_write_b32 v157, v145
    ds_write_b32 v158, v146
    s_add_u32 s56, s8, 0x1080000
    s_addc_u32 s57, s9, 0
    s_and_b32 s57, s57, 0xffff
    s_mov_b32 s58, 0x48000
    s_mov_b32 s59, 0x00020000
    v_mov_b32 v24, 0
    v_mov_b32 v25, 0
    v_mov_b32 v26, 0
    v_mov_b32 v27, 0
    v_lshlrev_b32 v6, 4, v1
    s_cmp_ge_u32 s12, 8
    s_cbranch_scc1 p1_hk_7
    s_mul_i32 s16, s12, 11264
    buffer_store_dwordx4 v[24:27], v6, s[32:35], s16 offen offset:0 sc1
    buffer_store_dwordx4 v[24:27], v6, s[32:35], s16 offen offset:1024 sc1
    buffer_store_dwordx4 v[24:27], v6, s[32:35], s16 offen offset:2048 sc1
    buffer_store_dwordx4 v[24:27], v6, s[32:35], s16 offen offset:3072 sc1
    s_add_u32 s16, s16, 4096
    buffer_store_dwordx4 v[24:27], v6, s[32:35], s16 offen offset:0 sc1
    buffer_store_dwordx4 v[24:27], v6, s[32:35], s16 offen offset:1024 sc1
    buffer_store_dwordx4 v[24:27], v6, s[32:35], s16 offen offset:2048 sc1
    buffer_store_dwordx4 v[24:27], v6, s[32:35], s16 offen offset:3072 sc1
    s_add_u32 s16, s16, 4096
    buffer_store_dwordx4 v[24:27], v6, s[32:35], s16 offen offset:0 sc1
    buffer_store_dwordx4 v[24:27], v6, s[32:35], s16 offen offset:1024 sc1
    buffer_store_dwordx4 v[24:27], v6, s[32:35], s16 offen offset:2048 sc1
    s_mul_i32 s16, s12, 3072
    buffer_store_dwordx4 v[24:27], v6, s[96:99], s16 offen offset:0 sc1
    buffer_store_dwordx4 v[24:27], v6, s[96:99], s16 offen offset:1024 sc1
    buffer_store_dwordx4 v[24:27], v6, s[96:99], s16 offen offset:2048 sc1
    s_waitcnt vmcnt(0)
    s_lshl_b32 s16, s12, 2
    v_mov_b32 v6, 1
    v_mov_b32 v7, 0
    s_mov_b64 exec, 1
    buffer_store_dword v6, v7, s[40:43], s16 offen sc1
    s_mov_b64 exec, -1
    s_branch p1_hkd_8
p1_hk_7:
    s_sub_u32 s16, s12, 8
    s_lshl_b32 s16, s16, 10
    s_cmp_lt_u32 s12, 72
    s_cselect_b32 s16, s16, 0x40000000
    s_sub_u32 s17, s12, 72
    s_lshl_b32 s18, s17, 10
    s_add_u32 s18, s18, 262144
    s_cmp_lt_u32 s17, 32
    s_cselect_b32 s18, s18, 0x40000000
    buffer_store_dwordx4 v[24:27], v6, s[56:59], s18 offen sc1
    s_nop 1
    v_mov_b32 v24, -1
    v_mov_b32 v25, -1
    v_mov_b32 v26, -1
    v_mov_b32 v27, -1
    buffer_store_dwordx4 v[24:27], v6, s[56:59], s16 offen sc1
p1_hkd_8:
    s_nop 1
    s_waitcnt lgkmcnt(0)
    s_mov_b32 s88, s46
    s_and_b32 s89, s47, 0xffff
    s_mov_b32 s90, 0xa2000
    s_mov_b32 s91, 0x00020000
    v_lshlrev_b32 v6, 7, v1
    s_lshl_b32 s16, s12, 13
    buffer_load_dword v215, v6, s[88:91], s16 offen
    s_and_b32 s46, s2, 7
    s_mul_i32 s46, s46, 1152
    s_lshr_b32 s17, s2, 3
    s_lshl_b32 s17, s17, 1
    s_add_u32 s17, s17, s48
    s_mul_i32 s17, s17, 9216
    s_add_u32 s46, s46, s17
    s_movk_i32 s17, 7282
    v_mul_lo_u32 v209, v1, s17
    v_lshrrev_b32 v209, 16, v209
    v_mul_u32_u24 v7, 9, v209
    v_sub_u32 v7, v1, v7
    s_mov_b32 s17, 294912
    v_mul_lo_u32 v209, v209, s17
    v_lshl_add_u32 v209, v7, 7, v209
    v_cmp_gt_u32 vcc, 63, v1
    v_mov_b32 v7, 0x40000000
    s_nop 0
    v_cndmask_b32 v209, v7, v209, vcc
    s_waitcnt lgkmcnt(0)
    s_mov_b32 s88, s44
    s_and_b32 s89, s45, 0xffff
    s_mov_b32 s90, 0x1200000
    s_mov_b32 s91, 0x00020000
    s_waitcnt lgkmcnt(0)
    s_barrier
    ds_read_b64_tr_b16 v[64:65], v208 offset:0
    ds_read_b64_tr_b16 v[66:67], v208 offset:1152
    ds_read_b64_tr_b16 v[68:69], v208 offset:8
    ds_read_b64_tr_b16 v[70:71], v208 offset:1160
    ds_read_b64_tr_b16 v[72:73], v208 offset:16
    ds_read_b64_tr_b16 v[74:75], v208 offset:1168
    ds_read_b64_tr_b16 v[76:77], v208 offset:24
    ds_read_b64_tr_b16 v[78:79], v208 offset:1176
    ds_read_b64_tr_b16 v[80:81], v208 offset:32
    ds_read_b64_tr_b16 v[82:83], v208 offset:1184
    ds_read_b64_tr_b16 v[84:85], v208 offset:40
    ds_read_b64_tr_b16 v[86:87], v208 offset:1192
    ds_read_b64_tr_b16 v[88:89], v208 offset:48
    ds_read_b64_tr_b16 v[90:91], v208 offset:1200
    ds_read_b64_tr_b16 v[92:93], v208 offset:56
    ds_read_b64_tr_b16 v[94:95], v208 offset:1208
    ds_read_b64_tr_b16 v[96:97], v208 offset:64
    ds_read_b64_tr_b16 v[98:99], v208 offset:1216
    v_add_u32 v208, 0x9000, v208
    s_waitcnt lgkmcnt(15)
    v_mfma_f32_16x16x32_bf16 v[100:103], v[64:67], v[28:31], v[100:103]
    s_waitcnt lgkmcnt(14)
    v_mfma_f32_16x16x32_bf16 v[100:103], v[68:71], v[32:35], v[100:103]
    s_waitcnt lgkmcnt(12)
    v_mfma_f32_16x16x32_bf16 v[100:103], v[72:75], v[36:39], v[100:103]
    s_waitcnt lgkmcnt(10)
    v_mfma_f32_16x16x32_bf16 v[100:103], v[76:79], v[40:43], v[100:103]
    s_waitcnt lgkmcnt(8)
    v_mfma_f32_16x16x32_bf16 v[100:103], v[80:83], v[44:47], v[100:103]
    s_waitcnt lgkmcnt(6)
    v_mfma_f32_16x16x32_bf16 v[100:103], v[84:87], v[48:51], v[100:103]
    s_waitcnt lgkmcnt(4)
    v_mfma_f32_16x16x32_bf16 v[100:103], v[88:91], v[52:55], v[100:103]
    s_waitcnt lgkmcnt(2)
    v_mfma_f32_16x16x32_bf16 v[100:103], v[92:95], v[56:59], v[100:103]
    s_waitcnt lgkmcnt(0)
    v_mfma_f32_16x16x32_bf16 v[100:103], v[96:99], v[60:63], v[100:103]
    s_barrier
    ds_read_b64_tr_b16 v[64:65], v208 offset:0
    ds_read_b64_tr_b16 v[66:67], v208 offset:1152
    ds_read_b64_tr_b16 v[68:69], v208 offset:8
    ds_read_b64_tr_b16 v[70:71], v208 offset:1160
    ds_read_b64_tr_b16 v[72:73], v208 offset:16
    ds_read_b64_tr_b16 v[74:75], v208 offset:1168
    ds_read_b64_tr_b16 v[76:77], v208 offset:24
    ds_read_b64_tr_b16 v[78:79], v208 offset:1176
    ds_read_b64_tr_b16 v[80:81], v208 offset:32
    ds_read_b64_tr_b16 v[82:83], v208 offset:1184
    ds_read_b64_tr_b16 v[84:85], v208 offset:40
    ds_read_b64_tr_b16 v[86:87], v208 offset:1192
    ds_read_b64_tr_b16 v[88:89], v208 offset:48
    ds_read_b64_tr_b16 v[90:91], v208 offset:1200
    ds_read_b64_tr_b16 v[92:93], v208 offset:56
    ds_read_b64_tr_b16 v[94:95], v208 offset:1208
    ds_read_b64_tr_b16 v[96:97], v208 offset:64
    ds_read_b64_tr_b16 v[98:99], v208 offset:1216
    v_add_u32 v208, 0x9000, v208
    s_waitcnt lgkmcnt(15)
    v_mfma_f32_16x16x32_bf16 v[100:103], v[64:67], v[28:31], v[100:103]
    s_waitcnt lgkmcnt(14)
    v_mfma_f32_16x16x32_bf16 v[100:103], v[68:71], v[32:35], v[100:103]
    s_waitcnt lgkmcnt(12)
    v_mfma_f32_16x16x32_bf16 v[100:103], v[72:75], v[36:39], v[100:103]
    s_waitcnt lgkmcnt(10)
    v_mfma_f32_16x16x32_bf16 v[100:103], v[76:79], v[40:43], v[100:103]
    s_waitcnt lgkmcnt(8)
    v_mfma_f32_16x16x32_bf16 v[100:103], v[80:83], v[44:47], v[100:103]
    s_waitcnt lgkmcnt(6)
    v_mfma_f32_16x16x32_bf16 v[100:103], v[84:87], v[48:51], v[100:103]
    s_waitcnt lgkmcnt(4)
    v_mfma_f32_16x16x32_bf16 v[100:103], v[88:91], v[52:55], v[100:103]
    s_waitcnt lgkmcnt(2)
    v_mfma_f32_16x16x32_bf16 v[100:103], v[92:95], v[56:59], v[100:103]
    s_waitcnt lgkmcnt(0)
    v_mfma_f32_16x16x32_bf16 v[100:103], v[96:99], v[60:63], v[100:103]
    v_mov_b32 v24, 154368
    s_lshl_b32 s16, s15, 1
    s_mul_i32 s17, s15, 768
    s_add_u32 s17, s17, 147456
    v_mul_u32_u24 v8, 1728, v2
    v_add_u32 v8, s17, v8
    v_cmp_eq_u32 s[18:19], v2, v4
    v_add_u32 v9, 0, v3
    v_mad_u32_u24 v14, v9, 48, v8
    v_cndmask_b32 v14, v24, v14, s[18:19]
    v_subrev_u32 v9, s16, v9
    v_cmp_gt_u32 vcc, 18, v9
    s_nop 1
    v_cndmask_b32 v14, v24, v14, vcc
    v_add_u32 v9, 4, v3
    v_mad_u32_u24 v15, v9, 48, v8
    v_cndmask_b32 v15, v24, v15, s[18:19]
    v_add_u32 v9, 8, v3
    v_mad_u32_u24 v16, v9, 48, v8
    v_cndmask_b32 v16, v24, v16, s[18:19]
    v_add_u32 v9, 12, v3
    v_mad_u32_u24 v17, v9, 48, v8
    v_cndmask_b32 v17, v24, v17, s[18:19]
    v_add_u32 v9, 16, v3
    v_mad_u32_u24 v18, v9, 48, v8
    v_cndmask_b32 v18, v24, v18, s[18:19]
    v_subrev_u32 v9, s16, v9
    v_cmp_gt_u32 vcc, 18, v9
    s_nop 1
    v_cndmask_b32 v18, v24, v18, vcc
    v_add_u32 v9, 20, v3
    v_mad_u32_u24 v19, v9, 48, v8
    v_cndmask_b32 v19, v24, v19, s[18:19]
    v_subrev_u32 v9, s16, v9
    v_cmp_gt_u32 vcc, 18, v9
    s_nop 1
    v_cndmask_b32 v19, v24, v19, vcc
    s_mul_i32 s16, s14, 10240
    s_add_u32 s16, s16, 81920
    v_lshlrev_b32 v211, 4, v1
    v_add_u32 v211, s16, v211
    s_barrier
    ds_read_b64_tr_b16 v[64:65], v208 offset:0
    ds_read_b64_tr_b16 v[66:67], v208 offset:1152
    ds_read_b64_tr_b16 v[68:69], v208 offset:8
    ds_read_b64_tr_b16 v[70:71], v208 offset:1160
    ds_read_b64_tr_b16 v[72:73], v208 offset:16
    ds_read_b64_tr_b16 v[74:75], v208 offset:1168
    ds_read_b64_tr_b16 v[76:77], v208 offset:24
    ds_read_b64_tr_b16 v[78:79], v208 offset:1176
    ds_read_b64_tr_b16 v[80:81], v208 offset:32
    ds_read_b64_tr_b16 v[82:83], v208 offset:1184
    ds_read_b64_tr_b16 v[84:85], v208 offset:40
    ds_read_b64_tr_b16 v[86:87], v208 offset:1192
    ds_read_b64_tr_b16 v[88:89], v208 offset:48
    ds_read_b64_tr_b16 v[90:91], v208 offset:1200
    ds_read_b64_tr_b16 v[92:93], v208 offset:56
    ds_read_b64_tr_b16 v[94:95], v208 offset:1208
    ds_read_b64_tr_b16 v[96:97], v208 offset:64
    ds_read_b64_tr_b16 v[98:99], v208 offset:1216
    v_add_u32 v208, 0x9000, v208
    s_waitcnt lgkmcnt(15)
    v_mfma_f32_16x16x32_bf16 v[100:103], v[64:67], v[28:31], v[100:103]
    s_waitcnt lgkmcnt(14)
    v_mfma_f32_16x16x32_bf16 v[100:103], v[68:71], v[32:35], v[100:103]
    s_waitcnt lgkmcnt(12)
    v_mfma_f32_16x16x32_bf16 v[100:103], v[72:75], v[36:39], v[100:103]
    s_waitcnt lgkmcnt(10)
    v_mfma_f32_16x16x32_bf16 v[100:103], v[76:79], v[40:43], v[100:103]
    s_waitcnt lgkmcnt(8)
    v_mfma_f32_16x16x32_bf16 v[100:103], v[80:83], v[44:47], v[100:103]
    s_waitcnt lgkmcnt(6)
    v_mfma_f32_16x16x32_bf16 v[100:103], v[84:87], v[48:51], v[100:103]
    s_waitcnt lgkmcnt(4)
    v_mfma_f32_16x16x32_bf16 v[100:103], v[88:91], v[52:55], v[100:103]
    s_waitcnt lgkmcnt(2)
    v_mfma_f32_16x16x32_bf16 v[100:103], v[92:95], v[56:59], v[100:103]
    s_waitcnt lgkmcnt(0)
    v_mfma_f32_16x16x32_bf16 v[100:103], v[96:99], v[60:63], v[100:103]
    s_barrier
    ds_read_b64_tr_b16 v[64:65], v208 offset:0
    ds_read_b64_tr_b16 v[66:67], v208 offset:1152
    ds_read_b64_tr_b16 v[68:69], v208 offset:8
    ds_read_b64_tr_b16 v[70:71], v208 offset:1160
    ds_read_b64_tr_b16 v[72:73], v208 offset:16
    ds_read_b64_tr_b16 v[74:75], v208 offset:1168
    ds_read_b64_tr_b16 v[76:77], v208 offset:24
    ds_read_b64_tr_b16 v[78:79], v208 offset:1176
    ds_read_b64_tr_b16 v[80:81], v208 offset:32
    ds_read_b64_tr_b16 v[82:83], v208 offset:1184
    ds_read_b64_tr_b16 v[84:85], v208 offset:40
    ds_read_b64_tr_b16 v[86:87], v208 offset:1192
    ds_read_b64_tr_b16 v[88:89], v208 offset:48
    ds_read_b64_tr_b16 v[90:91], v208 offset:1200
    ds_read_b64_tr_b16 v[92:93], v208 offset:56
    ds_read_b64_tr_b16 v[94:95], v208 offset:1208
    ds_read_b64_tr_b16 v[96:97], v208 offset:64
    ds_read_b64_tr_b16 v[98:99], v208 offset:1216
    v_add_u32 v208, 0xfffe5000, v208
    buffer_load_dword v215, v209, s[88:91], s46 offen
    s_add_u32 s46, s46, 2064384
    s_waitcnt lgkmcnt(15)
    v_mfma_f32_16x16x32_bf16 v[100:103], v[64:67], v[28:31], v[100:103]
    s_waitcnt lgkmcnt(14)
    v_mfma_f32_16x16x32_bf16 v[100:103], v[68:71], v[32:35], v[100:103]
    s_waitcnt lgkmcnt(12)
    v_mfma_f32_16x16x32_bf16 v[100:103], v[72:75], v[36:39], v[100:103]
    s_waitcnt lgkmcnt(10)
    v_mfma_f32_16x16x32_bf16 v[100:103], v[76:79], v[40:43], v[100:103]
    s_waitcnt lgkmcnt(8)
    v_mfma_f32_16x16x32_bf16 v[100:103], v[80:83], v[44:47], v[100:103]
    s_waitcnt lgkmcnt(6)
    v_mfma_f32_16x16x32_bf16 v[100:103], v[84:87], v[48:51], v[100:103]
    s_waitcnt lgkmcnt(4)
    v_mfma_f32_16x16x32_bf16 v[100:103], v[88:91], v[52:55], v[100:103]
    s_waitcnt lgkmcnt(2)
    v_mfma_f32_16x16x32_bf16 v[100:103], v[92:95], v[56:59], v[100:103]
    s_waitcnt lgkmcnt(0)
    v_mfma_f32_16x16x32_bf16 v[100:103], v[96:99], v[60:63], v[100:103]
    s_barrier
    ds_read_b64_tr_b16 v[64:65], v208 offset:0
    ds_read_b64_tr_b16 v[66:67], v208 offset:1152
    ds_read_b64_tr_b16 v[68:69], v208 offset:8
    ds_read_b64_tr_b16 v[70:71], v208 offset:1160
    ds_read_b64_tr_b16 v[72:73], v208 offset:16
    ds_read_b64_tr_b16 v[74:75], v208 offset:1168
    ds_read_b64_tr_b16 v[76:77], v208 offset:24
    ds_read_b64_tr_b16 v[78:79], v208 offset:1176
    ds_read_b64_tr_b16 v[80:81], v208 offset:32
    ds_read_b64_tr_b16 v[82:83], v208 offset:1184
    ds_read_b64_tr_b16 v[84:85], v208 offset:40
    ds_read_b64_tr_b16 v[86:87], v208 offset:1192
    ds_read_b64_tr_b16 v[88:89], v208 offset:48
    ds_read_b64_tr_b16 v[90:91], v208 offset:1200
    ds_read_b64_tr_b16 v[92:93], v208 offset:56
    ds_read_b64_tr_b16 v[94:95], v208 offset:1208
    ds_read_b64_tr_b16 v[96:97], v208 offset:64
    ds_read_b64_tr_b16 v[98:99], v208 offset:1216
    v_add_u32 v208, 0x9000, v208
    buffer_load_dword v212, v209, s[88:91], s46 offen
    s_add_u32 s46, s46, 2064384
    s_waitcnt lgkmcnt(15)
    v_mfma_f32_16x16x32_bf16 v[100:103], v[64:67], v[28:31], v[100:103]
    s_waitcnt lgkmcnt(14)
    v_mfma_f32_16x16x32_bf16 v[100:103], v[68:71], v[32:35], v[100:103]
    s_waitcnt lgkmcnt(12)
    v_mfma_f32_16x16x32_bf16 v[100:103], v[72:75], v[36:39], v[100:103]
    s_waitcnt lgkmcnt(10)
    v_mfma_f32_16x16x32_bf16 v[100:103], v[76:79], v[40:43], v[100:103]
    s_waitcnt lgkmcnt(8)
    v_mfma_f32_16x16x32_bf16 v[100:103], v[80:83], v[44:47], v[100:103]
    s_waitcnt lgkmcnt(6)
    v_mfma_f32_16x16x32_bf16 v[100:103], v[84:87], v[48:51], v[100:103]
    s_waitcnt lgkmcnt(4)
    v_mfma_f32_16x16x32_bf16 v[100:103], v[88:91], v[52:55], v[100:103]
    s_waitcnt lgkmcnt(2)
    v_mfma_f32_16x16x32_bf16 v[100:103], v[92:95], v[56:59], v[100:103]
    s_waitcnt lgkmcnt(0)
    v_mfma_f32_16x16x32_bf16 v[100:103], v[96:99], v[60:63], v[100:103]
    s_barrier
    ds_read_b64_tr_b16 v[64:65], v208 offset:0
    ds_read_b64_tr_b16 v[66:67], v208 offset:1152
    ds_read_b64_tr_b16 v[68:69], v208 offset:8
    ds_read_b64_tr_b16 v[70:71], v208 offset:1160
    ds_read_b64_tr_b16 v[72:73], v208 offset:16
    ds_read_b64_tr_b16 v[74:75], v208 offset:1168
    ds_read_b64_tr_b16 v[76:77], v208 offset:24
    ds_read_b64_tr_b16 v[78:79], v208 offset:1176
    ds_read_b64_tr_b16 v[80:81], v208 offset:32
    ds_read_b64_tr_b16 v[82:83], v208 offset:1184
    ds_read_b64_tr_b16 v[84:85], v208 offset:40
    ds_read_b64_tr_b16 v[86:87], v208 offset:1192
    ds_read_b64_tr_b16 v[88:89], v208 offset:48
    ds_read_b64_tr_b16 v[90:91], v208 offset:1200
    ds_read_b64_tr_b16 v[92:93], v208 offset:56
    ds_read_b64_tr_b16 v[94:95], v208 offset:1208
    ds_read_b64_tr_b16 v[96:97], v208 offset:64
    ds_read_b64_tr_b16 v[98:99], v208 offset:1216
    v_add_u32 v208, 0x9000, v208
    buffer_load_dword v213, v209, s[88:91], s46 offen
    s_add_u32 s46, s46, 2064384
    s_waitcnt lgkmcnt(15)
    v_mfma_f32_16x16x32_bf16 v[100:103], v[64:67], v[28:31], v[100:103]
    s_waitcnt lgkmcnt(14)
    v_mfma_f32_16x16x32_bf16 v[100:103], v[68:71], v[32:35], v[100:103]
    s_waitcnt lgkmcnt(12)
    v_mfma_f32_16x16x32_bf16 v[100:103], v[72:75], v[36:39], v[100:103]
    s_waitcnt lgkmcnt(10)
    v_mfma_f32_16x16x32_bf16 v[100:103], v[76:79], v[40:43], v[100:103]
    s_waitcnt lgkmcnt(8)
    v_mfma_f32_16x16x32_bf16 v[100:103], v[80:83], v[44:47], v[100:103]
    s_waitcnt lgkmcnt(6)
    v_mfma_f32_16x16x32_bf16 v[100:103], v[84:87], v[48:51], v[100:103]
    s_waitcnt lgkmcnt(4)
    v_mfma_f32_16x16x32_bf16 v[100:103], v[88:91], v[52:55], v[100:103]
    s_waitcnt lgkmcnt(2)
    v_mfma_f32_16x16x32_bf16 v[100:103], v[92:95], v[56:59], v[100:103]
    s_waitcnt lgkmcnt(0)
    v_mfma_f32_16x16x32_bf16 v[100:103], v[96:99], v[60:63], v[100:103]
    s_barrier
    ds_read_b64_tr_b16 v[64:65], v208 offset:0
    ds_read_b64_tr_b16 v[66:67], v208 offset:1152
    ds_read_b64_tr_b16 v[68:69], v208 offset:8
    ds_read_b64_tr_b16 v[70:71], v208 offset:1160
    ds_read_b64_tr_b16 v[72:73], v208 offset:16
    ds_read_b64_tr_b16 v[74:75], v208 offset:1168
    ds_read_b64_tr_b16 v[76:77], v208 offset:24
    ds_read_b64_tr_b16 v[78:79], v208 offset:1176
    ds_read_b64_tr_b16 v[80:81], v208 offset:32
    ds_read_b64_tr_b16 v[82:83], v208 offset:1184
    ds_read_b64_tr_b16 v[84:85], v208 offset:40
    ds_read_b64_tr_b16 v[86:87], v208 offset:1192
    ds_read_b64_tr_b16 v[88:89], v208 offset:48
    ds_read_b64_tr_b16 v[90:91], v208 offset:1200
    ds_read_b64_tr_b16 v[92:93], v208 offset:56
    ds_read_b64_tr_b16 v[94:95], v208 offset:1208
    ds_read_b64_tr_b16 v[96:97], v208 offset:64
    ds_read_b64_tr_b16 v[98:99], v208 offset:1216
    v_add_u32 v208, 0x9000, v208
    buffer_load_dword v214, v209, s[88:91], s46 offen
    s_add_u32 s46, s46, 2064384
    s_waitcnt lgkmcnt(15)
    v_mfma_f32_16x16x32_bf16 v[100:103], v[64:67], v[28:31], v[100:103]
    s_waitcnt lgkmcnt(14)
    v_mfma_f32_16x16x32_bf16 v[100:103], v[68:71], v[32:35], v[100:103]
    s_waitcnt lgkmcnt(12)
    v_mfma_f32_16x16x32_bf16 v[100:103], v[72:75], v[36:39], v[100:103]
    s_waitcnt lgkmcnt(10)
    v_mfma_f32_16x16x32_bf16 v[100:103], v[76:79], v[40:43], v[100:103]
    s_waitcnt lgkmcnt(8)
    v_mfma_f32_16x16x32_bf16 v[100:103], v[80:83], v[44:47], v[100:103]
    s_waitcnt lgkmcnt(6)
    v_mfma_f32_16x16x32_bf16 v[100:103], v[84:87], v[48:51], v[100:103]
    s_waitcnt lgkmcnt(4)
    v_mfma_f32_16x16x32_bf16 v[100:103], v[88:91], v[52:55], v[100:103]
    s_waitcnt lgkmcnt(2)
    v_mfma_f32_16x16x32_bf16 v[100:103], v[92:95], v[56:59], v[100:103]
    s_waitcnt lgkmcnt(0)
    v_mfma_f32_16x16x32_bf16 v[100:103], v[96:99], v[60:63], v[100:103]
    s_barrier
    ds_read_b64_tr_b16 v[64:65], v208 offset:0
    ds_read_b64_tr_b16 v[66:67], v208 offset:1152
    ds_read_b64_tr_b16 v[68:69], v208 offset:8
    ds_read_b64_tr_b16 v[70:71], v208 offset:1160
    ds_read_b64_tr_b16 v[72:73], v208 offset:16
    ds_read_b64_tr_b16 v[74:75], v208 offset:1168
    ds_read_b64_tr_b16 v[76:77], v208 offset:24
    ds_read_b64_tr_b16 v[78:79], v208 offset:1176
    ds_read_b64_tr_b16 v[80:81], v208 offset:32
    ds_read_b64_tr_b16 v[82:83], v208 offset:1184
    ds_read_b64_tr_b16 v[84:85], v208 offset:40
    ds_read_b64_tr_b16 v[86:87], v208 offset:1192
    ds_read_b64_tr_b16 v[88:89], v208 offset:48
    ds_read_b64_tr_b16 v[90:91], v208 offset:1200
    ds_read_b64_tr_b16 v[92:93], v208 offset:56
    ds_read_b64_tr_b16 v[94:95], v208 offset:1208
    ds_read_b64_tr_b16 v[96:97], v208 offset:64
    ds_read_b64_tr_b16 v[98:99], v208 offset:1216
    v_add_u32 v208, 0xfffe5000, v208
    buffer_load_dword v215, v209, s[88:91], s46 offen
    s_add_u32 s46, s46, 2064384
    s_waitcnt lgkmcnt(15)
    v_mfma_f32_16x16x32_bf16 v[100:103], v[64:67], v[28:31], v[100:103]
    s_waitcnt lgkmcnt(14)
    v_mfma_f32_16x16x32_bf16 v[100:103], v[68:71], v[32:35], v[100:103]
    s_waitcnt lgkmcnt(12)
    v_mfma_f32_16x16x32_bf16 v[100:103], v[72:75], v[36:39], v[100:103]
    s_waitcnt lgkmcnt(10)
    v_mfma_f32_16x16x32_bf16 v[100:103], v[76:79], v[40:43], v[100:103]
    s_waitcnt lgkmcnt(8)
    v_mfma_f32_16x16x32_bf16 v[100:103], v[80:83], v[44:47], v[100:103]
    s_waitcnt lgkmcnt(6)
    v_mfma_f32_16x16x32_bf16 v[100:103], v[84:87], v[48:51], v[100:103]
    s_waitcnt lgkmcnt(4)
    v_mfma_f32_16x16x32_bf16 v[100:103], v[88:91], v[52:55], v[100:103]
    s_waitcnt lgkmcnt(2)
    v_mfma_f32_16x16x32_bf16 v[100:103], v[92:95], v[56:59], v[100:103]
    s_waitcnt lgkmcnt(0)
    v_mfma_f32_16x16x32_bf16 v[100:103], v[96:99], v[60:63], v[100:103]
    s_barrier
    ds_read_b64_tr_b16 v[64:65], v208 offset:0
    ds_read_b64_tr_b16 v[66:67], v208 offset:1152
    ds_read_b64_tr_b16 v[68:69], v208 offset:8
    ds_read_b64_tr_b16 v[70:71], v208 offset:1160
    ds_read_b64_tr_b16 v[72:73], v208 offset:16
    ds_read_b64_tr_b16 v[74:75], v208 offset:1168
    ds_read_b64_tr_b16 v[76:77], v208 offset:24
    ds_read_b64_tr_b16 v[78:79], v208 offset:1176
    ds_read_b64_tr_b16 v[80:81], v208 offset:32
    ds_read_b64_tr_b16 v[82:83], v208 offset:1184
    ds_read_b64_tr_b16 v[84:85], v208 offset:40
    ds_read_b64_tr_b16 v[86:87], v208 offset:1192
    ds_read_b64_tr_b16 v[88:89], v208 offset:48
    ds_read_b64_tr_b16 v[90:91], v208 offset:1200
    ds_read_b64_tr_b16 v[92:93], v208 offset:56
    ds_read_b64_tr_b16 v[94:95], v208 offset:1208
    ds_read_b64_tr_b16 v[96:97], v208 offset:64
    ds_read_b64_tr_b16 v[98:99], v208 offset:1216
    v_add_u32 v208, 0x9000, v208
    buffer_load_dword v212, v209, s[88:91], s46 offen
    s_add_u32 s46, s46, 2064384
    s_waitcnt lgkmcnt(15)
    v_mfma_f32_16x16x32_bf16 v[100:103], v[64:67], v[28:31], v[100:103]
    s_waitcnt lgkmcnt(14)
    v_mfma_f32_16x16x32_bf16 v[100:103], v[68:71], v[32:35], v[100:103]
    s_waitcnt lgkmcnt(12)
    v_mfma_f32_16x16x32_bf16 v[100:103], v[72:75], v[36:39], v[100:103]
    s_waitcnt lgkmcnt(10)
    v_mfma_f32_16x16x32_bf16 v[100:103], v[76:79], v[40:43], v[100:103]
    s_waitcnt lgkmcnt(8)
    v_mfma_f32_16x16x32_bf16 v[100:103], v[80:83], v[44:47], v[100:103]
    s_waitcnt lgkmcnt(6)
    v_mfma_f32_16x16x32_bf16 v[100:103], v[84:87], v[48:51], v[100:103]
    s_waitcnt lgkmcnt(4)
    v_mfma_f32_16x16x32_bf16 v[100:103], v[88:91], v[52:55], v[100:103]
    s_waitcnt lgkmcnt(2)
    v_mfma_f32_16x16x32_bf16 v[100:103], v[92:95], v[56:59], v[100:103]
    s_waitcnt lgkmcnt(0)
    v_mfma_f32_16x16x32_bf16 v[100:103], v[96:99], v[60:63], v[100:103]
    v_lshlrev_b32 v6, 4, v2
    v_lshl_add_u32 v7, v5, 6, v6
    s_mul_i32 s16, s48, 576
    s_add_u32 s16, s16, 154432
    v_add_u32 v7, s16, v7
    s_mov_b32 s16, 0x01ff01ff
    s_mov_b32 s17, 0x01ff01ff
    s_nop 3
    s_mov_b64 exec, s[16:17]
    ds_write_b128 v7, v[100:103]
    s_mov_b64 exec, -1
    s_waitcnt lgkmcnt(0)
    s_branch p1q_pjoin
p1q_post:
    v_lshlrev_b32 v6, 4, v2
    v_and_b32 v27, 7, v1
    v_lshlrev_b32 v27, 2, v27
    s_lshl_b32 s16, s15, 8
    s_add_u32 s16, s16, 154432
    v_add_u32 v6, s16, v6
    ds_read_b128 v[64:67], v6 offset:0
    ds_read_b128 v[120:123], v6 offset:576
    ds_read_b128 v[68:71], v6 offset:64
    ds_read_b128 v[124:127], v6 offset:640
    ds_read_b128 v[72:75], v6 offset:128
    ds_read_b128 v[128:131], v6 offset:704
    ds_read_b128 v[76:79], v6 offset:192
    ds_read_b128 v[132:135], v6 offset:768
    ds_read_b128 v[80:83], v6 offset:256
    ds_read_b128 v[136:139], v6 offset:832
    ds_read_b128 v[84:87], v6 offset:320
    ds_read_b128 v[140:143], v6 offset:896
    s_waitcnt lgkmcnt(0)
    v_pk_add_f32 v[64:65], v[64:65], v[120:121]
    v_pk_add_f32 v[66:67], v[66:67], v[122:123]
    v_pk_add_f32 v[68:69], v[68:69], v[124:125]
    v_pk_add_f32 v[70:71], v[70:71], v[126:127]
    v_pk_add_f32 v[72:73], v[72:73], v[128:129]
    v_pk_add_f32 v[74:75], v[74:75], v[130:131]
    v_pk_add_f32 v[76:77], v[76:77], v[132:133]
    v_pk_add_f32 v[78:79], v[78:79], v[134:135]
    v_pk_add_f32 v[80:81], v[80:81], v[136:137]
    v_pk_add_f32 v[82:83], v[82:83], v[138:139]
    v_pk_add_f32 v[84:85], v[84:85], v[140:141]
    v_pk_add_f32 v[86:87], v[86:87], v[142:143]
    s_cmp_eq_u32 s53, 0
    s_cbranch_scc1 p1q_np_9
    ds_read_b64_tr_b16 v[216:217], v14 offset:0
    ds_read_b64_tr_b16 v[218:219], v15 offset:0
    ds_read_b64_tr_b16 v[220:221], v14 offset:8
    ds_read_b64_tr_b16 v[222:223], v15 offset:8
    ds_read_b64_tr_b16 v[224:225], v14 offset:16
    ds_read_b64_tr_b16 v[226:227], v15 offset:16
    ds_read_b64_tr_b16 v[228:229], v14 offset:24
    ds_read_b64_tr_b16 v[230:231], v15 offset:24
    ds_read_b64_tr_b16 v[232:233], v14 offset:32
    ds_read_b64_tr_b16 v[234:235], v15 offset:32
    ds_read_b64_tr_b16 v[236:237], v16 offset:0
    ds_read_b64_tr_b16 v[238:239], v17 offset:0
    ds_read_b64_tr_b16 v[240:241], v16 offset:8
    ds_read_b64_tr_b16 v[242:243], v17 offset:8
    ds_read_b64_tr_b16 v[244:245], v16 offset:16
    ds_read_b64_tr_b16 v[246:247], v17 offset:16
    ds_read_b64_tr_b16 v[248:249], v16 offset:24
    ds_read_b64_tr_b16 v[250:251], v17 offset:24
    ds_read_b64_tr_b16 v[252:253], v16 offset:32
    ds_read_b64_tr_b16 v[254:255], v17 offset:32
    ds_read_b64_tr_b16 v[168:169], v18 offset:0
    ds_read_b64_tr_b16 v[170:171], v19 offset:0
    ds_read_b64_tr_b16 v[172:173], v18 offset:8
    ds_read_b64_tr_b16 v[174:175], v19 offset:8
    ds_read_b64_tr_b16 v[176:177], v18 offset:16
    ds_read_b64_tr_b16 v[178:179], v19 offset:16
    ds_read_b64_tr_b16 v[180:181], v18 offset:24
    ds_read_b64_tr_b16 v[182:183], v19 offset:24
    ds_read_b64_tr_b16 v[184:185], v18 offset:32
    ds_read_b64_tr_b16 v[186:187], v19 offset:32
p1q_np_9:
    v_pk_mul_f32 v[28:29], v[28:29], v[12:13] op_sel:[0,1] op_sel_hi:[1,1]
    v_pk_mul_f32 v[30:31], v[30:31], v[12:13] op_sel:[0,1] op_sel_hi:[1,1]
    v_pk_mul_f32 v[32:33], v[32:33], v[12:13] op_sel:[0,1] op_sel_hi:[1,1]
    v_pk_mul_f32 v[34:35], v[34:35], v[12:13] op_sel:[0,1] op_sel_hi:[1,1]
    v_pk_mul_f32 v[36:37], v[36:37], v[12:13] op_sel:[0,1] op_sel_hi:[1,1]
    v_pk_mul_f32 v[38:39], v[38:39], v[12:13] op_sel:[0,1] op_sel_hi:[1,1]
    v_pk_mul_f32 v[40:41], v[40:41], v[12:13] op_sel:[0,1] op_sel_hi:[1,1]
    v_pk_mul_f32 v[42:43], v[42:43], v[12:13] op_sel:[0,1] op_sel_hi:[1,1]
    v_pk_mul_f32 v[44:45], v[44:45], v[12:13] op_sel:[0,1] op_sel_hi:[1,1]
    v_pk_mul_f32 v[46:47], v[46:47], v[12:13] op_sel:[0,1] op_sel_hi:[1,1]
    v_pk_mul_f32 v[48:49], v[48:49], v[12:13] op_sel:[0,1] op_sel_hi:[1,1]
    v_pk_mul_f32 v[50:51], v[50:51], v[12:13] op_sel:[0,1] op_sel_hi:[1,1]
    v_pk_fma_f32 v[28:29], v[64:65], v[12:13], v[28:29] op_sel_hi:[1,0,1] neg_lo:[0,1,0] neg_hi:[0,1,0]
    v_pk_fma_f32 v[30:31], v[66:67], v[12:13], v[30:31] op_sel_hi:[1,0,1] neg_lo:[0,1,0] neg_hi:[0,1,0]
    v_pk_fma_f32 v[32:33], v[68:69], v[12:13], v[32:33] op_sel_hi:[1,0,1] neg_lo:[0,1,0] neg_hi:[0,1,0]
    v_pk_fma_f32 v[34:35], v[70:71], v[12:13], v[34:35] op_sel_hi:[1,0,1] neg_lo:[0,1,0] neg_hi:[0,1,0]
    v_pk_fma_f32 v[36:37], v[72:73], v[12:13], v[36:37] op_sel_hi:[1,0,1] neg_lo:[0,1,0] neg_hi:[0,1,0]
    v_pk_fma_f32 v[38:39], v[74:75], v[12:13], v[38:39] op_sel_hi:[1,0,1] neg_lo:[0,1,0] neg_hi:[0,1,0]
    v_pk_fma_f32 v[40:41], v[76:77], v[12:13], v[40:41] op_sel_hi:[1,0,1] neg_lo:[0,1,0] neg_hi:[0,1,0]
    v_pk_fma_f32 v[42:43], v[78:79], v[12:13], v[42:43] op_sel_hi:[1,0,1] neg_lo:[0,1,0] neg_hi:[0,1,0]
    v_pk_fma_f32 v[44:45], v[80:81], v[12:13], v[44:45] op_sel_hi:[1,0,1] neg_lo:[0,1,0] neg_hi:[0,1,0]
    v_pk_fma_f32 v[46:47], v[82:83], v[12:13], v[46:47] op_sel_hi:[1,0,1] neg_lo:[0,1,0] neg_hi:[0,1,0]
    v_pk_fma_f32 v[48:49], v[84:85], v[12:13], v[48:49] op_sel_hi:[1,0,1] neg_lo:[0,1,0] neg_hi:[0,1,0]
    v_pk_fma_f32 v[50:51], v[86:87], v[12:13], v[50:51] op_sel_hi:[1,0,1] neg_lo:[0,1,0] neg_hi:[0,1,0]
    v_cvt_pk_bf16_f32 v120, v28, v29
    v_cvt_pk_bf16_f32 v121, v30, v31
    v_cvt_pk_bf16_f32 v122, v32, v33
    v_cvt_pk_bf16_f32 v123, v34, v35
    v_cvt_pk_bf16_f32 v124, v36, v37
    v_cvt_pk_bf16_f32 v125, v38, v39
    v_cvt_pk_bf16_f32 v126, v40, v41
    v_cvt_pk_bf16_f32 v127, v42, v43
    v_cvt_pk_bf16_f32 v128, v44, v45
    v_cvt_pk_bf16_f32 v129, v46, v47
    v_cvt_pk_bf16_f32 v130, v48, v49
    v_cvt_pk_bf16_f32 v131, v50, v51
    s_cmp_eq_u32 s15, 0
    s_cselect_b64 s[16:17], -1, 0
    v_cndmask_b32 v130, 0, v130, s[16:17]
    v_cndmask_b32 v131, 0, v131, s[16:17]
    s_waitcnt lgkmcnt(0)
    v_mfma_f32_16x16x32_bf16 v[140:143], v[216:219], v[120:123], 0
    v_mfma_f32_16x16x32_bf16 v[144:147], v[220:223], v[120:123], 0
    v_mfma_f32_16x16x32_bf16 v[148:151], v[224:227], v[120:123], 0
    v_mfma_f32_16x16x32_bf16 v[152:155], v[228:231], v[120:123], 0
    v_mfma_f32_16x16x32_bf16 v[156:159], v[232:235], v[120:123], 0
    v_mfma_f32_16x16x32_bf16 v[140:143], v[236:239], v[124:127], v[140:143]
    v_mfma_f32_16x16x32_bf16 v[144:147], v[240:243], v[124:127], v[144:147]
    v_mfma_f32_16x16x32_bf16 v[148:151], v[244:247], v[124:127], v[148:151]
    v_mfma_f32_16x16x32_bf16 v[152:155], v[248:251], v[124:127], v[152:155]
    v_mfma_f32_16x16x32_bf16 v[156:159], v[252:255], v[124:127], v[156:159]
    v_mfma_f32_16x16x32_bf16 v[140:143], v[168:171], v[128:131], v[140:143]
    v_mfma_f32_16x16x32_bf16 v[144:147], v[172:175], v[128:131], v[144:147]
    v_mfma_f32_16x16x32_bf16 v[148:151], v[176:179], v[128:131], v[148:151]
    v_mfma_f32_16x16x32_bf16 v[152:155], v[180:183], v[128:131], v[152:155]
    v_mfma_f32_16x16x32_bf16 v[156:159], v[184:187], v[128:131], v[156:159]
    s_mov_b32 s54, 0x3fb8aa3b
    s_mov_b32 s55, 0x3fb8aa3b
    s_lshl_b32 s16, s10, 2
    s_add_u32 s16, s16, s14
    s_lshl_b32 s16, s16, 2
    s_add_u32 s16, s16, s11
    s_mul_i32 s16, s16, 9216
    s_lshl_b32 s17, s15, 3
    s_add_u32 s17, s17, s16
    s_add_u32 s17, s17, 8192
    s_lshl_b32 s18, s15, 10
    s_add_u32 s16, s16, s18
    v_lshlrev_b32 v8, 11, v2
    v_lshl_add_u32 v8, v5, 4, v8
    v_lshlrev_b32 v7, 4, v1
    v_max3_f32 v64, v140, v141, v142
    v_min3_f32 v65, v140, v141, v142
    v_max3_f32 v64, v64, v143, v144
    v_min3_f32 v65, v65, v143, v144
    v_max3_f32 v64, v64, v145, v146
    v_min3_f32 v65, v65, v145, v146
    v_max3_f32 v64, v64, v147, v148
    v_min3_f32 v65, v65, v147, v148
    v_max3_f32 v64, v64, v149, v150
    v_min3_f32 v65, v65, v149, v150
    v_max3_f32 v64, v64, v151, v152
    v_min3_f32 v65, v65, v151, v152
    v_max3_f32 v64, v64, v153, v154
    v_min3_f32 v65, v65, v153, v154
    v_max3_f32 v64, v64, v155, v156
    v_min3_f32 v65, v65, v155, v156
    v_max_f32 v64, v64, v157
    v_min_f32 v65, v65, v157
    v_mul_f32 v64, s54, v64
    v_mul_f32 v65, s54, v65
    v_pk_fma_f32 v[28:29], v[140:141], s[54:55], v[64:65] op_sel_hi:[1,0,0] neg_lo:[0,0,1] neg_hi:[0,0,1]
    v_pk_fma_f32 v[46:47], v[140:141], s[54:55], v[64:65] op_sel:[0,0,1] op_sel_hi:[1,0,1] neg_lo:[1,0,0] neg_hi:[1,0,0]
    v_pk_fma_f32 v[30:31], v[142:143], s[54:55], v[64:65] op_sel_hi:[1,0,0] neg_lo:[0,0,1] neg_hi:[0,0,1]
    v_pk_fma_f32 v[48:49], v[142:143], s[54:55], v[64:65] op_sel:[0,0,1] op_sel_hi:[1,0,1] neg_lo:[1,0,0] neg_hi:[1,0,0]
    v_pk_fma_f32 v[32:33], v[144:145], s[54:55], v[64:65] op_sel_hi:[1,0,0] neg_lo:[0,0,1] neg_hi:[0,0,1]
    v_pk_fma_f32 v[50:51], v[144:145], s[54:55], v[64:65] op_sel:[0,0,1] op_sel_hi:[1,0,1] neg_lo:[1,0,0] neg_hi:[1,0,0]
    v_pk_fma_f32 v[34:35], v[146:147], s[54:55], v[64:65] op_sel_hi:[1,0,0] neg_lo:[0,0,1] neg_hi:[0,0,1]
    v_pk_fma_f32 v[52:53], v[146:147], s[54:55], v[64:65] op_sel:[0,0,1] op_sel_hi:[1,0,1] neg_lo:[1,0,0] neg_hi:[1,0,0]
    v_pk_fma_f32 v[36:37], v[148:149], s[54:55], v[64:65] op_sel_hi:[1,0,0] neg_lo:[0,0,1] neg_hi:[0,0,1]
    v_pk_fma_f32 v[54:55], v[148:149], s[54:55], v[64:65] op_sel:[0,0,1] op_sel_hi:[1,0,1] neg_lo:[1,0,0] neg_hi:[1,0,0]
    v_pk_fma_f32 v[38:39], v[150:151], s[54:55], v[64:65] op_sel_hi:[1,0,0] neg_lo:[0,0,1] neg_hi:[0,0,1]
    v_pk_fma_f32 v[56:57], v[150:151], s[54:55], v[64:65] op_sel:[0,0,1] op_sel_hi:[1,0,1] neg_lo:[1,0,0] neg_hi:[1,0,0]
    v_pk_fma_f32 v[40:41], v[152:153], s[54:55], v[64:65] op_sel_hi:[1,0,0] neg_lo:[0,0,1] neg_hi:[0,0,1]
    v_pk_fma_f32 v[58:59], v[152:153], s[54:55], v[64:65] op_sel:[0,0,1] op_sel_hi:[1,0,1] neg_lo:[1,0,0] neg_hi:[1,0,0]
    v_pk_fma_f32 v[42:43], v[154:155], s[54:55], v[64:65] op_sel_hi:[1,0,0] neg_lo:[0,0,1] neg_hi:[0,0,1]
    v_pk_fma_f32 v[60:61], v[154:155], s[54:55], v[64:65] op_sel:[0,0,1] op_sel_hi:[1,0,1] neg_lo:[1,0,0] neg_hi:[1,0,0]
    v_pk_fma_f32 v[44:45], v[156:157], s[54:55], v[64:65] op_sel_hi:[1,0,0] neg_lo:[0,0,1] neg_hi:[0,0,1]
    v_pk_fma_f32 v[62:63], v[156:157], s[54:55], v[64:65] op_sel:[0,0,1] op_sel_hi:[1,0,1] neg_lo:[1,0,0] neg_hi:[1,0,0]
    v_exp_f32 v28, v28
    v_exp_f32 v29, v29
    v_exp_f32 v30, v30
    v_exp_f32 v31, v31
    v_exp_f32 v32, v32
    v_exp_f32 v33, v33
    v_exp_f32 v34, v34
    v_exp_f32 v35, v35
    v_exp_f32 v36, v36
    v_exp_f32 v37, v37
    v_exp_f32 v38, v38
    v_exp_f32 v39, v39
    v_exp_f32 v40, v40
    v_exp_f32 v41, v41
    v_exp_f32 v42, v42
    v_exp_f32 v43, v43
    v_exp_f32 v44, v44
    v_exp_f32 v45, v45
    v_exp_f32 v46, v46
    v_exp_f32 v47, v47
    v_exp_f32 v48, v48
    v_exp_f32 v49, v49
    v_exp_f32 v50, v50
    v_exp_f32 v51, v51
    v_exp_f32 v52, v52
    v_exp_f32 v53, v53
    v_exp_f32 v54, v54
    v_exp_f32 v55, v55
    v_exp_f32 v56, v56
    v_exp_f32 v57, v57
    v_exp_f32 v58, v58
    v_exp_f32 v59, v59
    v_exp_f32 v60, v60
    v_exp_f32 v61, v61
    v_exp_f32 v62, v62
    v_exp_f32 v63, v63
    v_pk_add_f32 v[66:67], v[28:29], v[30:31]
    v_pk_add_f32 v[68:69], v[46:47], v[48:49]
    v_pk_add_f32 v[66:67], v[66:67], v[32:33]
    v_pk_add_f32 v[68:69], v[68:69], v[50:51]
    v_pk_add_f32 v[66:67], v[66:67], v[34:35]
    v_pk_add_f32 v[68:69], v[68:69], v[52:53]
    v_pk_add_f32 v[66:67], v[66:67], v[36:37]
    v_pk_add_f32 v[68:69], v[68:69], v[54:55]
    v_pk_add_f32 v[66:67], v[66:67], v[38:39]
    v_pk_add_f32 v[68:69], v[68:69], v[56:57]
    v_pk_add_f32 v[66:67], v[66:67], v[40:41]
    v_pk_add_f32 v[68:69], v[68:69], v[58:59]
    v_pk_add_f32 v[66:67], v[66:67], v[42:43]
    v_pk_add_f32 v[68:69], v[68:69], v[60:61]
    v_pk_add_f32 v[66:67], v[66:67], v[44:45]
    v_pk_add_f32 v[68:69], v[68:69], v[62:63]
    v_add_f32 v66, v66, v67
    v_add_f32 v68, v68, v69
    v_rcp_f32 v66, v66
    v_rcp_f32 v68, v68
    v_pk_mul_f32 v[28:29], v[28:29], v[66:67] op_sel_hi:[1,0]
    v_pk_mul_f32 v[46:47], v[46:47], v[68:69] op_sel_hi:[1,0]
    v_pk_mul_f32 v[30:31], v[30:31], v[66:67] op_sel_hi:[1,0]
    v_pk_mul_f32 v[48:49], v[48:49], v[68:69] op_sel_hi:[1,0]
    v_pk_mul_f32 v[32:33], v[32:33], v[66:67] op_sel_hi:[1,0]
    v_pk_mul_f32 v[50:51], v[50:51], v[68:69] op_sel_hi:[1,0]
    v_pk_mul_f32 v[34:35], v[34:35], v[66:67] op_sel_hi:[1,0]
    v_pk_mul_f32 v[52:53], v[52:53], v[68:69] op_sel_hi:[1,0]
    v_pk_mul_f32 v[36:37], v[36:37], v[66:67] op_sel_hi:[1,0]
    v_pk_mul_f32 v[54:55], v[54:55], v[68:69] op_sel_hi:[1,0]
    v_pk_mul_f32 v[38:39], v[38:39], v[66:67] op_sel_hi:[1,0]
    v_pk_mul_f32 v[56:57], v[56:57], v[68:69] op_sel_hi:[1,0]
    v_pk_mul_f32 v[40:41], v[40:41], v[66:67] op_sel_hi:[1,0]
    v_pk_mul_f32 v[58:59], v[58:59], v[68:69] op_sel_hi:[1,0]
    v_pk_mul_f32 v[42:43], v[42:43], v[66:67] op_sel_hi:[1,0]
    v_pk_mul_f32 v[60:61], v[60:61], v[68:69] op_sel_hi:[1,0]
    v_pk_mul_f32 v[44:45], v[44:45], v[66:67] op_sel_hi:[1,0]
    v_pk_mul_f32 v[62:63], v[62:63], v[68:69] op_sel_hi:[1,0]
    v_cvt_pk_bf16_f32 v72, v28, v29
    v_cvt_pk_bf16_f32 v73, v30, v31
    v_cvt_pk_bf16_f32 v74, v32, v33
    v_cvt_pk_bf16_f32 v75, v34, v35
    v_cvt_pk_bf16_f32 v76, v36, v37
    v_cvt_pk_bf16_f32 v77, v38, v39
    v_cvt_pk_bf16_f32 v78, v40, v41
    v_cvt_pk_bf16_f32 v79, v42, v43
    v_cvt_pk_bf16_f32 v80, v44, v45
    v_cvt_pk_bf16_f32 v81, v46, v47
    v_cvt_pk_bf16_f32 v82, v48, v49
    v_cvt_pk_bf16_f32 v83, v50, v51
    v_cvt_pk_bf16_f32 v84, v52, v53
    v_cvt_pk_bf16_f32 v85, v54, v55
    v_cvt_pk_bf16_f32 v86, v56, v57
    v_cvt_pk_bf16_f32 v87, v58, v59
    v_cvt_pk_bf16_f32 v88, v60, v61
    v_cvt_pk_bf16_f32 v89, v62, v63
    buffer_store_dwordx4 v[72:75], v8, s[36:39], s16 offen offset:0 sc1
    buffer_store_dwordx4 v[76:79], v8, s[36:39], s16 offen offset:256 sc1
    buffer_store_dwordx4 v[80:83], v8, s[36:39], s16 offen offset:512 sc1
    buffer_store_dwordx4 v[84:87], v8, s[36:39], s16 offen offset:768 sc1
    buffer_store_dwordx2 v[88:89], v7, s[36:39], s17 offen sc1
    s_mov_b32 s18, 0
p1_zp_10:
    buffer_load_dword v10, v27, s[40:43], 0 offen sc1
    s_add_u32 s18, s18, 1
    s_cmp_gt_u32 s18, 0x80000
    s_cbranch_scc1 p1_zx_11
    s_waitcnt vmcnt(0)
    v_cmp_ne_u32 vcc, 1, v10
    s_cbranch_vccnz p1_zp_10
p1_zx_11:
    s_and_b32 s16, s2, 31
    s_lshr_b32 s17, s2, 7
    s_lshl_b32 s17, s17, 5
    s_add_u32 s16, s16, s17
    s_lshl_b32 s16, s16, 7
    v_mov_b32 v6, 1
    v_mov_b32 v7, 0
    s_waitcnt vmcnt(0)
    s_mov_b64 exec, 1
    buffer_atomic_add v6, v7, s[96:99], s16 offen sc1
    s_mov_b64 exec, -1
    s_load_dwordx2 s[44:45], s[0:1], 40
    s_lshl_b32 s16, s2, 3
    s_add_u32 s16, s16, s13
    s_lshl_b32 s16, s16, 13
    s_add_u32 s16, s16, 12386304
    v_lshlrev_b32 v6, 7, v1
    s_waitcnt lgkmcnt(0)
    s_mov_b32 s88, s44
    s_and_b32 s89, s45, 0xffff
    s_mov_b32 s90, 0x1200000
    s_mov_b32 s91, 0x00020000
    buffer_load_dword v254, v6, s[88:91], s16 offen
    s_add_u32 s16, s16, 8388608
    s_branch p1_late
    s_branch p1_done
p1_done:
p1_late:
    s_waitcnt lgkmcnt(0)
    s_barrier
    s_mov_b32 s58, 0
    s_branch p2_pre
p1_early:
    s_mov_b32 s58, 1
p2_pre:
    s_load_dwordx2 s[4:5], s[0:1], 0
    s_load_dwordx2 s[6:7], s[0:1], 24
    s_load_dwordx2 s[8:9], s[0:1], 88
    v_lshrrev_b32 v1, 6, v0
    s_and_b32 s16, s2, 7
    s_lshr_b32 s17, s2, 3
    v_readfirstlane_b32 s13, v1
    s_lshl_b32 s10, s16, 3
    s_lshr_b32 s18, s17, 2
    s_add_u32 s10, s10, s18
    s_and_b32 s11, s17, 3
    s_and_b32 s14, s13, 3
    s_lshr_b32 s15, s13, 2
    v_and_b32 v1, 63, v0
    v_lshrrev_b32 v2, 4, v1
    v_bfe_u32 v3, v1, 2, 2
    v_and_b32 v4, 3, v1
    v_and_b32 v5, 15, v1
    v_lshlrev_b32 v6, 4, v1
    v_mov_b32 v11, 0x40000000
    v_lshlrev_b32 v7, 4, v5
    v_add_u32 v7, 2048, v7
    s_lshl_b32 s16, s15, 1
    v_subrev_u32 v10, s16, v2
    v_cmp_eq_u32 vcc, 0, v10
    s_nop 1
    v_cndmask_b32 v12, v11, v7, vcc
    v_cmp_eq_u32 vcc, 1, v10
    s_nop 1
    v_cndmask_b32 v13, v11, v7, vcc
    v_mul_u32_u24 v7, 144, v4
    v_lshl_add_u32 v8, v2, 5, v7
    v_add_u32 v8, 2304, v8
    v_cmp_gt_u32 s[48:49], 3, v4
    s_nop 1
    v_cndmask_b32 v8, v11, v8, s[48:49]
    v_cmp_eq_u32 vcc, 0, v3
    s_nop 1
    v_cndmask_b32 v14, v11, v8, vcc
    v_cmp_eq_u32 vcc, 1, v3
    s_nop 1
    v_cndmask_b32 v15, v11, v8, vcc
    v_cmp_eq_u32 vcc, 2, v3
    s_nop 1
    v_cndmask_b32 v16, v11, v8, vcc
    v_cmp_eq_u32 vcc, 3, v3
    s_nop 1
    v_cndmask_b32 v17, v11, v8, vcc
    v_mul_u32_u24 v8, 2816, v3
    v_add3_u32 v8, v8, v7, 0
    v_add_u32 v8, 2432, v8
    v_cndmask_b32 v8, v11, v8, s[48:49]
    v_lshrrev_b32 v9, 1, v3
    v_cmp_eq_u32 vcc, v9, v10
    s_nop 1
    v_cndmask_b32 v18, v11, v8, vcc
    v_and_b32 v9, 1, v3
    v_cmp_eq_u32 s[50:51], 1, v9
    s_waitcnt lgkmcnt(0)
    s_add_u32 s28, s8, 0x1000000
    s_addc_u32 s29, s9, 0
    s_and_b32 s29, s29, 0xffff
    s_mov_b32 s30, 0x16000
    s_mov_b32 s31, 0x00020000
    s_add_u32 s32, s8, 0xa80000
    s_addc_u32 s33, s9, 0
    s_and_b32 s33, s33, 0xffff
    s_mov_b32 s34, 0x480000
    s_mov_b32 s35, 0x00020000
    s_lshl_b32 s16, s14, 1
    s_add_u32 s16, s16, s15
    s_mul_i32 s52, s16, 11264
    s_mov_b32 s24, s6
    s_and_b32 s25, s7, 0xffff
    s_mov_b32 s26, 0xa2000
    s_mov_b32 s27, 0x00020000
    s_and_b32 s56, s13, 1
    s_cmp_lt_u32 s13, 4
    s_cselect_b32 s16, 2, 0
    s_add_u32 s56, s56, s16
    s_bfe_u32 s57, s13, 0x10001
    v_mov_b32 v8, v1
    v_mul_u32_u24 v9, 57, v8
    v_lshrrev_b32 v9, 10, v9
    v_mul_u32_u24 v7, 18, v9
    v_sub_u32 v104, v8, v7
    v_mul_u32_u24 v105, 1152, v9
    v_lshl_add_u32 v105, v104, 4, v105
    v_add_u32 v106, 163584, v105
    v_cmp_gt_u32 vcc, 36, v8
    s_nop 1
    v_cndmask_b32 v106, v11, v106, vcc
    s_lshl_b32 s16, s57, 6
    v_add_u32 v8, s16, v1
    v_mul_u32_u24 v9, 57, v8
    v_lshrrev_b32 v9, 10, v9
    v_mul_u32_u24 v7, 18, v9
    v_sub_u32 v104, v8, v7
    v_mul_u32_u24 v105, 1152, v9
    v_lshl_add_u32 v105, v104, 4, v105
    s_mul_i32 s16, s11, 288
    s_mul_i32 s53, s14, 165888
    s_add_u32 s53, s53, s16
    s_mul_i32 s59, s56, 165888
    s_add_u32 s59, s59, s16
    s_mul_i32 s54, s14, 40960
    s_mul_i32 s55, s56, 40960
    s_lshl_b32 s16, s57, 10
    s_add_u32 s55, s55, s16
    s_mov_b32 m0, s55
    s_nop 0
    buffer_load_dwordx4 v105, s[24:27], s59 offen lds
    s_add_u32 s55, s55, 2048
    v_add_u32 v104, 2, v104
    v_cmp_lt_u32 vcc, 17, v104
    v_subrev_u32 v7, 18, v104
    v_add_u32 v105, 8096, v105
    v_add_u32 v8, 864, v105
    v_cndmask_b32 v104, v104, v7, vcc
    v_cndmask_b32 v105, v105, v8, vcc
    s_mov_b32 m0, s55
    s_nop 0
    buffer_load_dwordx4 v105, s[24:27], s59 offen lds
    s_add_u32 s55, s55, 2048
    v_add_u32 v104, 2, v104
    v_cmp_lt_u32 vcc, 17, v104
    v_subrev_u32 v7, 18, v104
    v_add_u32 v105, 8096, v105
    v_add_u32 v8, 864, v105
    v_cndmask_b32 v104, v104, v7, vcc
    v_cndmask_b32 v105, v105, v8, vcc
    s_mov_b32 m0, s55
    s_nop 0
    buffer_load_dwordx4 v105, s[24:27], s59 offen lds
    s_add_u32 s55, s55, 2048
    v_add_u32 v104, 2, v104
    v_cmp_lt_u32 vcc, 17, v104
    v_subrev_u32 v7, 18, v104
    v_add_u32 v105, 8096, v105
    v_add_u32 v8, 864, v105
    v_cndmask_b32 v104, v104, v7, vcc
    v_cndmask_b32 v105, v105, v8, vcc
    s_mov_b32 m0, s55
    s_nop 0
    buffer_load_dwordx4 v105, s[24:27], s59 offen lds
    s_add_u32 s55, s55, 2048
    v_add_u32 v104, 2, v104
    v_cmp_lt_u32 vcc, 17, v104
    v_subrev_u32 v7, 18, v104
    v_add_u32 v105, 8096, v105
    v_add_u32 v8, 864, v105
    v_cndmask_b32 v104, v104, v7, vcc
    v_cndmask_b32 v105, v105, v8, vcc
    s_mov_b32 m0, s55
    s_nop 0
    buffer_load_dwordx4 v105, s[24:27], s59 offen lds
    s_add_u32 s55, s55, 2048
    v_add_u32 v104, 2, v104
    v_cmp_lt_u32 vcc, 17, v104
    v_subrev_u32 v7, 18, v104
    v_add_u32 v105, 8096, v105
    v_add_u32 v8, 864, v105
    v_cndmask_b32 v104, v104, v7, vcc
    v_cndmask_b32 v105, v105, v8, vcc
    s_mov_b32 m0, s55
    s_nop 0
    buffer_load_dwordx4 v105, s[24:27], s59 offen lds
    s_add_u32 s55, s55, 2048
    v_add_u32 v104, 2, v104
    v_cmp_lt_u32 vcc, 17, v104
    v_subrev_u32 v7, 18, v104
    v_add_u32 v105, 8096, v105
    v_add_u32 v8, 864, v105
    v_cndmask_b32 v104, v104, v7, vcc
    v_cndmask_b32 v105, v105, v8, vcc
    s_mov_b32 m0, s55
    s_nop 0
    buffer_load_dwordx4 v105, s[24:27], s59 offen lds
    s_add_u32 s55, s55, 2048
    v_add_u32 v104, 2, v104
    v_cmp_lt_u32 vcc, 17, v104
    v_subrev_u32 v7, 18, v104
    v_add_u32 v105, 8096, v105
    v_add_u32 v8, 864, v105
    v_cndmask_b32 v104, v104, v7, vcc
    v_cndmask_b32 v105, v105, v8, vcc
    s_mov_b32 m0, s55
    s_nop 0
    buffer_load_dwordx4 v105, s[24:27], s59 offen lds
    s_add_u32 s55, s55, 2048
    v_add_u32 v104, 2, v104
    v_cmp_lt_u32 vcc, 17, v104
    v_subrev_u32 v7, 18, v104
    v_add_u32 v105, 8096, v105
    v_add_u32 v8, 864, v105
    v_cndmask_b32 v104, v104, v7, vcc
    v_cndmask_b32 v105, v105, v8, vcc
    s_mov_b32 m0, s55
    s_nop 0
    buffer_load_dwordx4 v105, s[24:27], s59 offen lds
    s_add_u32 s55, s55, 2048
    v_add_u32 v104, 2, v104
    v_cmp_lt_u32 vcc, 17, v104
    v_subrev_u32 v7, 18, v104
    v_add_u32 v105, 8096, v105
    v_add_u32 v8, 864, v105
    v_cndmask_b32 v104, v104, v7, vcc
    v_cndmask_b32 v105, v105, v8, vcc
    s_mov_b32 m0, s55
    s_nop 0
    buffer_load_dwordx4 v105, s[24:27], s59 offen lds
    s_add_u32 s55, s55, 2048
    v_add_u32 v104, 2, v104
    v_cmp_lt_u32 vcc, 17, v104
    v_subrev_u32 v7, 18, v104
    v_add_u32 v105, 8096, v105
    v_add_u32 v8, 864, v105
    v_cndmask_b32 v104, v104, v7, vcc
    v_cndmask_b32 v105, v105, v8, vcc
    s_mov_b32 m0, s55
    s_nop 0
    buffer_load_dwordx4 v105, s[24:27], s59 offen lds
    s_add_u32 s55, s55, 2048
    v_add_u32 v104, 2, v104
    v_cmp_lt_u32 vcc, 17, v104
    v_subrev_u32 v7, 18, v104
    v_add_u32 v105, 8096, v105
    v_add_u32 v8, 864, v105
    v_cndmask_b32 v104, v104, v7, vcc
    v_cndmask_b32 v105, v105, v8, vcc
    s_mov_b32 m0, s55
    s_nop 0
    buffer_load_dwordx4 v105, s[24:27], s59 offen lds
    s_add_u32 s55, s55, 2048
    v_add_u32 v104, 2, v104
    v_cmp_lt_u32 vcc, 17, v104
    v_subrev_u32 v7, 18, v104
    v_add_u32 v105, 8096, v105
    v_add_u32 v8, 864, v105
    v_cndmask_b32 v104, v104, v7, vcc
    v_cndmask_b32 v105, v105, v8, vcc
    s_mov_b32 m0, s55
    s_nop 0
    buffer_load_dwordx4 v105, s[24:27], s59 offen lds
    s_add_u32 s55, s55, 2048
    v_add_u32 v104, 2, v104
    v_cmp_lt_u32 vcc, 17, v104
    v_subrev_u32 v7, 18, v104
    v_add_u32 v105, 8096, v105
    v_add_u32 v8, 864, v105
    v_cndmask_b32 v104, v104, v7, vcc
    v_cndmask_b32 v105, v105, v8, vcc
    s_mov_b32 m0, s55
    s_nop 0
    buffer_load_dwordx4 v105, s[24:27], s59 offen lds
    s_add_u32 s55, s55, 2048
    v_add_u32 v104, 2, v104
    v_cmp_lt_u32 vcc, 17, v104
    v_subrev_u32 v7, 18, v104
    v_add_u32 v105, 8096, v105
    v_add_u32 v8, 864, v105
    v_cndmask_b32 v104, v104, v7, vcc
    v_cndmask_b32 v105, v105, v8, vcc
    s_mov_b32 m0, s55
    s_nop 0
    buffer_load_dwordx4 v105, s[24:27], s59 offen lds
    s_add_u32 s55, s55, 2048
    v_add_u32 v104, 2, v104
    v_cmp_lt_u32 vcc, 17, v104
    v_subrev_u32 v7, 18, v104
    v_add_u32 v105, 8096, v105
    v_add_u32 v8, 864, v105
    v_cndmask_b32 v104, v104, v7, vcc
    v_cndmask_b32 v105, v105, v8, vcc
    s_mov_b32 m0, s55
    s_nop 0
    buffer_load_dwordx4 v105, s[24:27], s59 offen lds
    s_add_u32 s55, s55, 2048
    v_add_u32 v104, 2, v104
    v_cmp_lt_u32 vcc, 17, v104
    v_subrev_u32 v7, 18, v104
    v_add_u32 v105, 8096, v105
    v_add_u32 v8, 864, v105
    v_cndmask_b32 v104, v104, v7, vcc
    v_cndmask_b32 v105, v105, v8, vcc
    s_mov_b32 m0, s55
    s_nop 0
    buffer_load_dwordx4 v105, s[24:27], s59 offen lds
    s_add_u32 s55, s55, 2048
    v_add_u32 v104, 2, v104
    v_cmp_lt_u32 vcc, 17, v104
    v_subrev_u32 v7, 18, v104
    v_add_u32 v105, 8096, v105
    v_add_u32 v8, 864, v105
    v_cndmask_b32 v104, v104, v7, vcc
    v_cndmask_b32 v105, v105, v8, vcc
    s_mov_b32 m0, s55
    s_nop 0
    buffer_load_dwordx4 v105, s[24:27], s59 offen lds
    s_add_u32 s55, s55, 2048
    v_add_u32 v104, 2, v104
    v_cmp_lt_u32 vcc, 17, v104
    v_subrev_u32 v7, 18, v104
    v_add_u32 v105, 8096, v105
    v_add_u32 v8, 864, v105
    v_cndmask_b32 v104, v104, v7, vcc
    v_cndmask_b32 v105, v105, v8, vcc
    s_mov_b32 m0, s55
    s_nop 0
    buffer_load_dwordx4 v105, s[24:27], s59 offen lds
    s_add_u32 s55, s55, 2048
    v_add_u32 v104, 2, v104
    v_cmp_lt_u32 vcc, 17, v104
    v_subrev_u32 v7, 18, v104
    v_add_u32 v105, 8096, v105
    v_add_u32 v8, 864, v105
    v_cndmask_b32 v104, v104, v7, vcc
    v_cndmask_b32 v105, v105, v8, vcc
    s_mov_b32 m0, s55
    s_nop 0
    buffer_load_dwordx4 v105, s[24:27], s59 offen lds
    s_add_u32 s55, s55, 2048
    v_add_u32 v104, 2, v104
    v_cmp_lt_u32 vcc, 17, v104
    v_subrev_u32 v7, 18, v104
    v_add_u32 v105, 8096, v105
    v_add_u32 v8, 864, v105
    v_cndmask_b32 v104, v104, v7, vcc
    v_cndmask_b32 v105, v105, v8, vcc
    s_mov_b32 s20, s4
    s_and_b32 s21, s5, 0xffff
    s_mov_b32 s22, 0x240000
    s_mov_b32 s23, 0x00020000
    s_add_u32 s36, s8, 0x800000
    s_addc_u32 s37, s9, 0
    s_and_b32 s37, s37, 0xffff
    s_mov_b32 s38, 0x240000
    s_mov_b32 s39, 0x00020000
    s_mov_b32 s40, s8
    s_and_b32 s41, s9, 0xffff
    s_mov_b32 s42, 0x240000
    s_mov_b32 s43, 0x00020000
    s_add_u32 s44, s8, 0x1080000
    s_addc_u32 s45, s9, 0
    s_and_b32 s45, s45, 0xffff
    s_mov_b32 s46, 0x10000
    s_mov_b32 s47, 0x00020000
    s_lshl_b32 s16, s10, 5
    s_mul_i32 s17, s16, 1152
    s_mul_i32 s18, s11, 288
    s_add_u32 s17, s17, s18
    s_movk_i32 s18, 3641
    v_mov_b32 v7, v0
    v_mul_lo_u32 v8, v7, s18
    v_lshrrev_b32 v8, 16, v8
    v_mul_u32_u24 v9, 18, v8
    v_sub_u32 v9, v7, v9
    v_mul_u32_u24 v109, 592, v8
    v_lshl_add_u32 v109, v9, 5, v109
    v_add_u32 v109, 12288, v109
    v_mul_u32_u24 v107, 1152, v8
    v_lshl_add_u32 v107, v9, 4, v107
    v_add_u32 v107, s17, v107
    v_lshlrev_b32 v111, 3, v8
    v_lshlrev_b32 v113, 4, v7
    v_lshlrev_b32 v115, 3, v7
    v_add_u32 v7, 64, v0
    v_mul_lo_u32 v8, v7, s18
    v_lshrrev_b32 v8, 16, v8
    v_mul_u32_u24 v9, 18, v8
    v_sub_u32 v9, v7, v9
    v_mul_u32_u24 v110, 592, v8
    v_lshl_add_u32 v110, v9, 5, v110
    v_add_u32 v110, 12288, v110
    v_mul_u32_u24 v108, 1152, v8
    v_lshl_add_u32 v108, v9, 4, v108
    v_add_u32 v108, s17, v108
    v_lshlrev_b32 v112, 3, v8
    v_lshlrev_b32 v114, 4, v7
    v_lshlrev_b32 v116, 3, v7
    v_lshl_add_u32 v7, v2, 2, v3
    v_mul_u32_u24 v117, 288, v7
    v_lshl_add_u32 v117, v4, 3, v117
    v_add_u32 v117, s54, v117
    v_lshrrev_b32 v7, 1, v3
    v_lshl_add_u32 v7, v7, 2, v2
    v_mul_u32_u24 v7, 18, v7
    v_and_b32 v8, 1, v3
    v_add3_u32 v7, v7, v8, 16
    v_subrev_u32 v8, 106, v7
    v_cmp_lt_u32 vcc, 141, v7
    s_nop 1
    v_cndmask_b32 v7, v7, v8, vcc
    v_mul_u32_u24 v118, 288, v7
    v_lshl_add_u32 v118, v4, 3, v118
    v_add_u32 v118, s54, v118
    s_lshl_b32 s16, s15, 11
    s_add_u32 s16, s16, s54
    v_add_u32 v119, s16, v6
    s_lshl_b32 s16, s15, 8
    s_add_u32 s16, s16, s54
    v_lshl_add_u32 v120, v1, 2, s16
    s_cmp_eq_u32 s58, 0
    s_cbranch_scc1 p2_nA_12
    s_barrier
p2_nA_12:
    s_cmp_lg_u32 s13, 0
    s_cbranch_scc1 p2_np0_13
    v_and_b32 v10, 31, v0
    v_lshlrev_b32 v10, 7, v10
    s_mov_b32 s16, 0
    s_mov_b32 s18, 0
poll_14:
    buffer_load_dword v9, v10, s[96:99], s16 offen sc1
    s_add_u32 s18, s18, 1
    s_cmp_gt_u32 s18, 0x80000
    s_cbranch_scc1 pollx_15
    s_waitcnt vmcnt(0)
    v_cmp_gt_u32 vcc, 32, v9
    s_cbranch_vccnz poll_14
pollx_15:
    s_waitcnt vmcnt(0)
p2_np0_13:
    s_waitcnt vmcnt(0)
    s_barrier
    s_lshl_b32 s16, s10, 3
    s_add_u32 s16, s16, s14
    s_mul_i32 s16, s16, 9216
    s_lshl_b32 s17, s15, 12
    s_add_u32 s17, s17, s16
    s_add_u32 s16, s16, 8192
    buffer_load_dwordx4 v[144:147], v6, s[32:35], s17 offen offset:0 sc1
    buffer_load_dwordx4 v[148:151], v6, s[32:35], s17 offen offset:1024 sc1
    buffer_load_dwordx4 v[152:155], v6, s[32:35], s17 offen offset:2048 sc1
    buffer_load_dwordx4 v[156:159], v6, s[32:35], s17 offen offset:3072 sc1
    buffer_load_dwordx4 v[160:163], v6, s[32:35], s16 offen sc1
    s_add_u32 s16, s16, 36864
    s_add_u32 s17, s17, 36864
    buffer_load_dwordx4 v[164:167], v6, s[32:35], s17 offen offset:0 sc1
    buffer_load_dwordx4 v[168:171], v6, s[32:35], s17 offen offset:1024 sc1
    buffer_load_dwordx4 v[172:175], v6, s[32:35], s17 offen offset:2048 sc1
    buffer_load_dwordx4 v[176:179], v6, s[32:35], s17 offen offset:3072 sc1
    buffer_load_dwordx4 v[180:183], v6, s[32:35], s16 offen sc1
    s_cmp_lg_u32 s13, 1
    s_cbranch_scc1 p2_np1_16
    v_and_b32 v10, 31, v0
    v_lshlrev_b32 v10, 7, v10
    s_mov_b32 s16, 4096
    s_mov_b32 s18, 0
poll_17:
    buffer_load_dword v9, v10, s[96:99], s16 offen sc1
    s_add_u32 s18, s18, 1
    s_cmp_gt_u32 s18, 0x80000
    s_cbranch_scc1 pollx_18
    s_waitcnt vmcnt(0)
    v_cmp_gt_u32 vcc, 16, v9
    s_cbranch_vccnz poll_17
pollx_18:
    s_waitcnt vmcnt(0)
p2_np1_16:
    s_barrier
    s_add_u32 s16, s52, 0
    buffer_load_dwordx4 v[20:23], v6, s[28:31], s16 offen sc1
    buffer_load_dwordx4 v[24:27], v6, s[28:31], s16 offen offset:1024 sc1
    buffer_load_dwordx4 v[28:31], v12, s[28:31], s16 offen sc1
    buffer_load_dwordx4 v[32:35], v14, s[28:31], s16 offen sc1
    buffer_load_dwordx4 v[36:39], v14, s[28:31], s16 offen offset:16 sc1
    s_add_u32 s16, s52, 2816
    buffer_load_dwordx4 v[40:43], v6, s[28:31], s16 offen sc1
    buffer_load_dwordx4 v[44:47], v6, s[28:31], s16 offen offset:1024 sc1
    buffer_load_dwordx4 v[48:51], v12, s[28:31], s16 offen sc1
    buffer_load_dwordx4 v[52:55], v15, s[28:31], s16 offen sc1
    buffer_load_dwordx4 v[56:59], v15, s[28:31], s16 offen offset:16 sc1
    s_add_u32 s16, s52, 5632
    buffer_load_dwordx4 v[60:63], v6, s[28:31], s16 offen sc1
    buffer_load_dwordx4 v[64:67], v6, s[28:31], s16 offen offset:1024 sc1
    buffer_load_dwordx4 v[68:71], v13, s[28:31], s16 offen sc1
    buffer_load_dwordx4 v[72:75], v16, s[28:31], s16 offen sc1
    buffer_load_dwordx4 v[76:79], v16, s[28:31], s16 offen offset:16 sc1
    s_add_u32 s16, s52, 8448
    buffer_load_dwordx4 v[80:83], v6, s[28:31], s16 offen sc1
    buffer_load_dwordx4 v[84:87], v6, s[28:31], s16 offen offset:1024 sc1
    buffer_load_dwordx4 v[88:91], v13, s[28:31], s16 offen sc1
    buffer_load_dwordx4 v[92:95], v17, s[28:31], s16 offen sc1
    buffer_load_dwordx4 v[96:99], v17, s[28:31], s16 offen offset:16 sc1
    buffer_load_dwordx4 v[100:103], v18, s[28:31], s52 offen sc1
    ds_read_b64_tr_b16 v[184:185], v117 offset:0
    ds_read_b64_tr_b16 v[186:187], v117 offset:5184
    ds_read_b64_tr_b16 v[188:189], v117 offset:32
    ds_read_b64_tr_b16 v[190:191], v117 offset:5216
    ds_read_b64_tr_b16 v[192:193], v117 offset:64
    ds_read_b64_tr_b16 v[194:195], v117 offset:5248
    ds_read_b64_tr_b16 v[196:197], v117 offset:96
    ds_read_b64_tr_b16 v[198:199], v117 offset:5280
    ds_read_b64_tr_b16 v[200:201], v117 offset:128
    ds_read_b64_tr_b16 v[202:203], v117 offset:5312
    ds_read_b64_tr_b16 v[204:205], v117 offset:160
    ds_read_b64_tr_b16 v[206:207], v117 offset:5344
    ds_read_b64_tr_b16 v[208:209], v117 offset:192
    ds_read_b64_tr_b16 v[210:211], v117 offset:5376
    ds_read_b64_tr_b16 v[212:213], v117 offset:224
    ds_read_b64_tr_b16 v[214:215], v117 offset:5408
    ds_read_b64_tr_b16 v[216:217], v117 offset:256
    ds_read_b64_tr_b16 v[218:219], v117 offset:5440
    ds_read_b64_tr_b16 v[220:221], v117 offset:10368
    ds_read_b64_tr_b16 v[222:223], v117 offset:15552
    ds_read_b64_tr_b16 v[224:225], v117 offset:10400
    ds_read_b64_tr_b16 v[226:227], v117 offset:15584
    ds_read_b64_tr_b16 v[228:229], v117 offset:10432
    ds_read_b64_tr_b16 v[230:231], v117 offset:15616
    ds_read_b64_tr_b16 v[232:233], v117 offset:10464
    ds_read_b64_tr_b16 v[234:235], v117 offset:15648
    ds_read_b64_tr_b16 v[236:237], v117 offset:10496
    ds_read_b64_tr_b16 v[238:239], v117 offset:15680
    ds_read_b64_tr_b16 v[240:241], v117 offset:10528
    ds_read_b64_tr_b16 v[242:243], v117 offset:15712
    ds_read_b64_tr_b16 v[244:245], v117 offset:10560
    ds_read_b64_tr_b16 v[246:247], v117 offset:15744
    ds_read_b64_tr_b16 v[248:249], v117 offset:10592
    ds_read_b64_tr_b16 v[250:251], v117 offset:15776
    ds_read_b64_tr_b16 v[252:253], v117 offset:10624
    ds_read_b64_tr_b16 v[254:255], v117 offset:15808
    s_waitcnt lgkmcnt(0)
    s_barrier
    s_add_u32 m0, s54, 10368
    s_cmp_lg_u32 s15, 0
    s_cbranch_scc1 p2_nl_19
    buffer_load_dwordx4 v106, s[24:27], s53 offen lds
p2_nl_19:
    s_waitcnt vmcnt(0)
    v_cvt_pk_bf16_f32 v20, v20, v21
    v_cvt_pk_bf16_f32 v21, v22, v23
    v_cvt_pk_bf16_f32 v22, v24, v25
    v_cvt_pk_bf16_f32 v23, v26, v27
    v_cvt_pk_bf16_f32 v24, v28, v29
    v_cvt_pk_bf16_f32 v25, v30, v31
    v_mov_b32 v26, 0
    v_mov_b32 v27, 0
    v_cvt_pk_bf16_f32 v28, v32, v33
    v_cvt_pk_bf16_f32 v29, v34, v35
    v_cvt_pk_bf16_f32 v30, v36, v37
    v_cvt_pk_bf16_f32 v31, v38, v39
    v_cvt_pk_bf16_f32 v40, v40, v41
    v_cvt_pk_bf16_f32 v41, v42, v43
    v_cvt_pk_bf16_f32 v42, v44, v45
    v_cvt_pk_bf16_f32 v43, v46, v47
    v_cvt_pk_bf16_f32 v46, v48, v49
    v_cvt_pk_bf16_f32 v47, v50, v51
    v_mov_b32 v44, 0
    v_mov_b32 v45, 0
    v_cvt_pk_bf16_f32 v48, v52, v53
    v_cvt_pk_bf16_f32 v49, v54, v55
    v_cvt_pk_bf16_f32 v50, v56, v57
    v_cvt_pk_bf16_f32 v51, v58, v59
    v_cvt_pk_bf16_f32 v60, v60, v61
    v_cvt_pk_bf16_f32 v61, v62, v63
    v_cvt_pk_bf16_f32 v62, v64, v65
    v_cvt_pk_bf16_f32 v63, v66, v67
    v_cvt_pk_bf16_f32 v64, v68, v69
    v_cvt_pk_bf16_f32 v65, v70, v71
    v_mov_b32 v66, 0
    v_mov_b32 v67, 0
    v_cvt_pk_bf16_f32 v68, v72, v73
    v_cvt_pk_bf16_f32 v69, v74, v75
    v_cvt_pk_bf16_f32 v70, v76, v77
    v_cvt_pk_bf16_f32 v71, v78, v79
    v_cvt_pk_bf16_f32 v80, v80, v81
    v_cvt_pk_bf16_f32 v81, v82, v83
    v_cvt_pk_bf16_f32 v82, v84, v85
    v_cvt_pk_bf16_f32 v83, v86, v87
    v_cvt_pk_bf16_f32 v86, v88, v89
    v_cvt_pk_bf16_f32 v87, v90, v91
    v_mov_b32 v84, 0
    v_mov_b32 v85, 0
    v_cvt_pk_bf16_f32 v88, v92, v93
    v_cvt_pk_bf16_f32 v89, v94, v95
    v_cvt_pk_bf16_f32 v90, v96, v97
    v_cvt_pk_bf16_f32 v91, v98, v99
    v_cvt_pk_bf16_f32 v9, v100, v101
    v_cvt_pk_bf16_f32 v10, v102, v103
    v_cndmask_b32 v100, v9, 0, s[50:51]
    v_cndmask_b32 v101, v10, 0, s[50:51]
    v_cndmask_b32 v102, 0, v9, s[50:51]
    v_cndmask_b32 v103, 0, v10, s[50:51]
    s_nop 1
    v_mfma_f32_16x16x32_bf16 v[124:127], v[100:103], v[160:163], 0
    v_mfma_f32_16x16x32_bf16 v[128:131], v[100:103], v[180:183], 0
    v_mfma_f32_16x16x32_bf16 v[124:127], v[28:31], v[144:147], v[124:127]
    v_mfma_f32_16x16x32_bf16 v[128:131], v[28:31], v[164:167], v[128:131]
    v_mfma_f32_16x16x32_bf16 v[124:127], v[48:51], v[148:151], v[124:127]
    v_mfma_f32_16x16x32_bf16 v[128:131], v[48:51], v[168:171], v[128:131]
    v_mfma_f32_16x16x32_bf16 v[124:127], v[68:71], v[152:155], v[124:127]
    v_mfma_f32_16x16x32_bf16 v[128:131], v[68:71], v[172:175], v[128:131]
    v_mfma_f32_16x16x32_bf16 v[124:127], v[88:91], v[156:159], v[124:127]
    v_mfma_f32_16x16x32_bf16 v[128:131], v[88:91], v[176:179], v[128:131]
    v_mfma_f32_16x16x32_bf16 v[32:35], v[20:23], v[144:147], 0
    v_mfma_f32_16x16x32_bf16 v[36:39], v[20:23], v[164:167], 0
    v_mfma_f32_16x16x32_bf16 v[32:35], v[24:27], v[160:163], v[32:35]
    v_mfma_f32_16x16x32_bf16 v[36:39], v[24:27], v[180:183], v[36:39]
    v_mfma_f32_16x16x32_bf16 v[52:55], v[40:43], v[148:151], 0
    v_mfma_f32_16x16x32_bf16 v[56:59], v[40:43], v[168:171], 0
    v_mfma_f32_16x16x32_bf16 v[52:55], v[44:47], v[160:163], v[52:55]
    v_mfma_f32_16x16x32_bf16 v[56:59], v[44:47], v[180:183], v[56:59]
    v_mfma_f32_16x16x32_bf16 v[72:75], v[60:63], v[152:155], 0
    v_mfma_f32_16x16x32_bf16 v[76:79], v[60:63], v[172:175], 0
    v_mfma_f32_16x16x32_bf16 v[72:75], v[64:67], v[160:163], v[72:75]
    v_mfma_f32_16x16x32_bf16 v[76:79], v[64:67], v[180:183], v[76:79]
    v_mfma_f32_16x16x32_bf16 v[92:95], v[80:83], v[156:159], 0
    v_mfma_f32_16x16x32_bf16 v[96:99], v[80:83], v[176:179], 0
    v_mfma_f32_16x16x32_bf16 v[92:95], v[84:87], v[160:163], v[92:95]
    v_mfma_f32_16x16x32_bf16 v[96:99], v[84:87], v[180:183], v[96:99]
    v_add_f32 v132, 0x358637bd, v124
    v_rcp_f32 v132, v132
    s_nop 0
    v_mul_f32 v9, v125, v132
    v_mul_f32 v10, v126, v132
    v_cvt_pk_bf16_f32 v64, v9, v10
    v_mov_b32 v134, v132
    s_nop 1
    v_permlane32_swap_b32 v132, v134
    v_mov_b32 v133, v132
    v_mov_b32 v135, v134
    s_nop 0
    v_permlane16_swap_b32 v132, v133
    v_permlane16_swap_b32 v134, v135
    v_add_f32 v136, 0x358637bd, v128
    v_rcp_f32 v136, v136
    s_nop 0
    v_mul_f32 v9, v129, v136
    v_mul_f32 v10, v130, v136
    v_cvt_pk_bf16_f32 v65, v9, v10
    v_mov_b32 v138, v136
    s_nop 1
    v_permlane32_swap_b32 v136, v138
    v_mov_b32 v137, v136
    v_mov_b32 v139, v138
    s_nop 0
    v_permlane16_swap_b32 v136, v137
    v_permlane16_swap_b32 v138, v139
    buffer_load_dwordx4 v[20:23], v107, s[20:23], 0 offen
    s_cmp_eq_u32 s13, 7
    s_cselect_b64 s[58:59], -1, 0
    v_cndmask_b32 v108, v11, v108, s[58:59]
    buffer_load_dwordx4 v[24:27], v108, s[20:23], 0 offen
    v_pk_mul_f32 v[32:33], v[32:33], v[132:133] op_sel_hi:[1,0]
    v_pk_mul_f32 v[34:35], v[34:35], v[132:133] op_sel_hi:[1,0]
    v_cvt_pk_bf16_f32 v40, v32, v33
    v_cvt_pk_bf16_f32 v41, v34, v35
    v_pk_mul_f32 v[36:37], v[36:37], v[136:137] op_sel_hi:[1,0]
    v_pk_mul_f32 v[38:39], v[38:39], v[136:137] op_sel_hi:[1,0]
    v_cvt_pk_bf16_f32 v48, v36, v37
    v_cvt_pk_bf16_f32 v49, v38, v39
    v_pk_mul_f32 v[52:53], v[52:53], v[132:133] op_sel:[0,1] op_sel_hi:[1,1]
    v_pk_mul_f32 v[54:55], v[54:55], v[132:133] op_sel:[0,1] op_sel_hi:[1,1]
    v_cvt_pk_bf16_f32 v42, v52, v53
    v_cvt_pk_bf16_f32 v43, v54, v55
    v_pk_mul_f32 v[56:57], v[56:57], v[136:137] op_sel:[0,1] op_sel_hi:[1,1]
    v_pk_mul_f32 v[58:59], v[58:59], v[136:137] op_sel:[0,1] op_sel_hi:[1,1]
    v_cvt_pk_bf16_f32 v50, v56, v57
    v_cvt_pk_bf16_f32 v51, v58, v59
    v_pk_mul_f32 v[72:73], v[72:73], v[134:135] op_sel_hi:[1,0]
    v_pk_mul_f32 v[74:75], v[74:75], v[134:135] op_sel_hi:[1,0]
    v_cvt_pk_bf16_f32 v44, v72, v73
    v_cvt_pk_bf16_f32 v45, v74, v75
    v_pk_mul_f32 v[76:77], v[76:77], v[138:139] op_sel_hi:[1,0]
    v_pk_mul_f32 v[78:79], v[78:79], v[138:139] op_sel_hi:[1,0]
    v_cvt_pk_bf16_f32 v60, v76, v77
    v_cvt_pk_bf16_f32 v61, v78, v79
    v_pk_mul_f32 v[92:93], v[92:93], v[134:135] op_sel:[0,1] op_sel_hi:[1,1]
    v_pk_mul_f32 v[94:95], v[94:95], v[134:135] op_sel:[0,1] op_sel_hi:[1,1]
    v_cvt_pk_bf16_f32 v46, v92, v93
    v_cvt_pk_bf16_f32 v47, v94, v95
    v_pk_mul_f32 v[96:97], v[96:97], v[138:139] op_sel:[0,1] op_sel_hi:[1,1]
    v_pk_mul_f32 v[98:99], v[98:99], v[138:139] op_sel:[0,1] op_sel_hi:[1,1]
    v_cvt_pk_bf16_f32 v62, v96, v97
    v_cvt_pk_bf16_f32 v63, v98, v99
    ds_read_b64_tr_b16 v[144:145], v117 offset:20736
    ds_read_b64_tr_b16 v[146:147], v117 offset:25920
    ds_read_b64_tr_b16 v[148:149], v117 offset:20768
    ds_read_b64_tr_b16 v[150:151], v117 offset:25952
    ds_read_b64_tr_b16 v[152:153], v117 offset:20800
    ds_read_b64_tr_b16 v[154:155], v117 offset:25984
    ds_read_b64_tr_b16 v[156:157], v117 offset:20832
    ds_read_b64_tr_b16 v[158:159], v117 offset:26016
    ds_read_b64_tr_b16 v[160:161], v117 offset:20864
    ds_read_b64_tr_b16 v[162:163], v117 offset:26048
    ds_read_b64_tr_b16 v[164:165], v117 offset:20896
    ds_read_b64_tr_b16 v[166:167], v117 offset:26080
    ds_read_b64_tr_b16 v[168:169], v117 offset:20928
    ds_read_b64_tr_b16 v[170:171], v117 offset:26112
    ds_read_b64_tr_b16 v[172:173], v117 offset:20960
    ds_read_b64_tr_b16 v[174:175], v117 offset:26144
    ds_read_b64_tr_b16 v[176:177], v117 offset:20992
    ds_read_b64_tr_b16 v[178:179], v117 offset:26176
    ds_write_b128 v119, v[40:43] offset:0
    ds_write_b128 v119, v[44:47] offset:1024
    ds_write_b32 v120, v64 offset:4096
    ds_write_b128 v119, v[48:51] offset:5184
    ds_write_b128 v119, v[60:63] offset:6208
    ds_write_b32 v120, v65 offset:9280
    s_mul_i32 s16, s15, 5184
    s_add_u32 s16, s16, s54
    v_add_u32 v7, s16, v6
    v_lshl_add_u32 v8, v1, 2, s16
    s_waitcnt lgkmcnt(0)
    s_barrier
    ds_read_b128 v[124:127], v7 offset:0
    ds_read_b128 v[128:131], v7 offset:1024
    ds_read_b128 v[132:135], v7 offset:2048
    ds_read_b128 v[136:139], v7 offset:3072
    ds_read2st64_b32 v[140:141], v8 offset0:16 offset1:17
    v_mov_b32 v142, 0
    v_mov_b32 v143, 0
    s_waitcnt lgkmcnt(0)
    v_mfma_f32_16x16x32_bf16 v[68:71], v[184:187], v[124:127], 0
    ds_read_b64_tr_b16 v[28:29], v117 offset:31104
    ds_read_b64_tr_b16 v[30:31], v117 offset:36288
    v_mfma_f32_16x16x32_bf16 v[72:75], v[188:191], v[124:127], 0
    ds_read_b64_tr_b16 v[32:33], v117 offset:31136
    ds_read_b64_tr_b16 v[34:35], v117 offset:36320
    v_mfma_f32_16x16x32_bf16 v[76:79], v[192:195], v[124:127], 0
    ds_read_b64_tr_b16 v[36:37], v117 offset:31168
    ds_read_b64_tr_b16 v[38:39], v117 offset:36352
    v_mfma_f32_16x16x32_bf16 v[80:83], v[196:199], v[124:127], 0
    ds_read_b64_tr_b16 v[40:41], v117 offset:31200
    ds_read_b64_tr_b16 v[42:43], v117 offset:36384
    v_mfma_f32_16x16x32_bf16 v[84:87], v[200:203], v[124:127], 0
    ds_read_b64_tr_b16 v[44:45], v117 offset:31232
    ds_read_b64_tr_b16 v[46:47], v117 offset:36416
    v_mfma_f32_16x16x32_bf16 v[88:91], v[204:207], v[124:127], 0
    ds_read_b64_tr_b16 v[48:49], v117 offset:31264
    ds_read_b64_tr_b16 v[50:51], v117 offset:36448
    v_mfma_f32_16x16x32_bf16 v[92:95], v[208:211], v[124:127], 0
    ds_read_b64_tr_b16 v[52:53], v117 offset:31296
    ds_read_b64_tr_b16 v[54:55], v117 offset:36480
    v_mfma_f32_16x16x32_bf16 v[96:99], v[212:215], v[124:127], 0
    ds_read_b64_tr_b16 v[56:57], v117 offset:31328
    ds_read_b64_tr_b16 v[58:59], v117 offset:36512
    v_mfma_f32_16x16x32_bf16 v[100:103], v[216:219], v[124:127], 0
    ds_read_b64_tr_b16 v[60:61], v117 offset:31360
    ds_read_b64_tr_b16 v[62:63], v117 offset:36544
    v_mfma_f32_16x16x32_bf16 v[68:71], v[220:223], v[128:131], v[68:71]
    ds_read_b64_tr_b16 v[184:185], v118 offset:0
    ds_read_b64_tr_b16 v[186:187], v118 offset:0
    v_mfma_f32_16x16x32_bf16 v[72:75], v[224:227], v[128:131], v[72:75]
    ds_read_b64_tr_b16 v[188:189], v118 offset:32
    ds_read_b64_tr_b16 v[190:191], v118 offset:32
    v_mfma_f32_16x16x32_bf16 v[76:79], v[228:231], v[128:131], v[76:79]
    ds_read_b64_tr_b16 v[192:193], v118 offset:64
    ds_read_b64_tr_b16 v[194:195], v118 offset:64
    v_mfma_f32_16x16x32_bf16 v[80:83], v[232:235], v[128:131], v[80:83]
    ds_read_b64_tr_b16 v[196:197], v118 offset:96
    ds_read_b64_tr_b16 v[198:199], v118 offset:96
    v_mfma_f32_16x16x32_bf16 v[84:87], v[236:239], v[128:131], v[84:87]
    ds_read_b64_tr_b16 v[200:201], v118 offset:128
    ds_read_b64_tr_b16 v[202:203], v118 offset:128
    v_mfma_f32_16x16x32_bf16 v[88:91], v[240:243], v[128:131], v[88:91]
    ds_read_b64_tr_b16 v[204:205], v118 offset:160
    ds_read_b64_tr_b16 v[206:207], v118 offset:160
    v_mfma_f32_16x16x32_bf16 v[92:95], v[244:247], v[128:131], v[92:95]
    ds_read_b64_tr_b16 v[208:209], v118 offset:192
    ds_read_b64_tr_b16 v[210:211], v118 offset:192
    v_mfma_f32_16x16x32_bf16 v[96:99], v[248:251], v[128:131], v[96:99]
    ds_read_b64_tr_b16 v[212:213], v118 offset:224
    ds_read_b64_tr_b16 v[214:215], v118 offset:224
    v_mfma_f32_16x16x32_bf16 v[100:103], v[252:255], v[128:131], v[100:103]
    ds_read_b64_tr_b16 v[216:217], v118 offset:256
    ds_read_b64_tr_b16 v[218:219], v118 offset:256
    v_mfma_f32_16x16x32_bf16 v[68:71], v[144:147], v[132:135], v[68:71]
    v_mfma_f32_16x16x32_bf16 v[72:75], v[148:151], v[132:135], v[72:75]
    v_mfma_f32_16x16x32_bf16 v[76:79], v[152:155], v[132:135], v[76:79]
    v_mfma_f32_16x16x32_bf16 v[80:83], v[156:159], v[132:135], v[80:83]
    v_mfma_f32_16x16x32_bf16 v[84:87], v[160:163], v[132:135], v[84:87]
    v_mfma_f32_16x16x32_bf16 v[88:91], v[164:167], v[132:135], v[88:91]
    v_mfma_f32_16x16x32_bf16 v[92:95], v[168:171], v[132:135], v[92:95]
    v_mfma_f32_16x16x32_bf16 v[96:99], v[172:175], v[132:135], v[96:99]
    v_mfma_f32_16x16x32_bf16 v[100:103], v[176:179], v[132:135], v[100:103]
    s_waitcnt lgkmcnt(0)
    s_barrier
    v_mfma_f32_16x16x32_bf16 v[68:71], v[28:31], v[136:139], v[68:71]
    v_mfma_f32_16x16x32_bf16 v[72:75], v[32:35], v[136:139], v[72:75]
    v_mfma_f32_16x16x32_bf16 v[76:79], v[36:39], v[136:139], v[76:79]
    v_mfma_f32_16x16x32_bf16 v[80:83], v[40:43], v[136:139], v[80:83]
    v_mfma_f32_16x16x32_bf16 v[84:87], v[44:47], v[136:139], v[84:87]
    v_mfma_f32_16x16x32_bf16 v[88:91], v[48:51], v[136:139], v[88:91]
    v_mfma_f32_16x16x32_bf16 v[92:95], v[52:55], v[136:139], v[92:95]
    v_mfma_f32_16x16x32_bf16 v[96:99], v[56:59], v[136:139], v[96:99]
    v_mfma_f32_16x16x32_bf16 v[100:103], v[60:63], v[136:139], v[100:103]
    v_mfma_f32_16x16x32_bf16 v[68:71], v[184:187], v[140:143], v[68:71]
    v_mfma_f32_16x16x32_bf16 v[72:75], v[188:191], v[140:143], v[72:75]
    v_mfma_f32_16x16x32_bf16 v[76:79], v[192:195], v[140:143], v[76:79]
    v_mfma_f32_16x16x32_bf16 v[80:83], v[196:199], v[140:143], v[80:83]
    v_mfma_f32_16x16x32_bf16 v[84:87], v[200:203], v[140:143], v[84:87]
    v_mfma_f32_16x16x32_bf16 v[88:91], v[204:207], v[140:143], v[88:91]
    v_mfma_f32_16x16x32_bf16 v[92:95], v[208:211], v[140:143], v[92:95]
    v_mfma_f32_16x16x32_bf16 v[96:99], v[212:215], v[140:143], v[96:99]
    v_mfma_f32_16x16x32_bf16 v[100:103], v[216:219], v[140:143], v[100:103]
    v_mul_u32_u24 v7, 592, v5
    v_lshl_add_u32 v7, v2, 4, v7
    s_mul_i32 s16, s15, 9472
    s_add_u32 s16, s16, s54
    v_add_u32 v7, s16, v7
    ds_write_b128 v7, v[68:71] offset:12288
    ds_write_b128 v7, v[72:75] offset:12352
    ds_write_b128 v7, v[76:79] offset:12416
    ds_write_b128 v7, v[80:83] offset:12480
    ds_write_b128 v7, v[84:87] offset:12544
    ds_write_b128 v7, v[88:91] offset:12608
    ds_write_b128 v7, v[92:95] offset:12672
    ds_write_b128 v7, v[96:99] offset:12736
    ds_write_b128 v7, v[100:103] offset:12800
    s_waitcnt lgkmcnt(0)
    s_barrier
    s_waitcnt vmcnt(0)
    v_add_u32 v7, 81920, v109
    ds_read_b128 v[44:47], v109 offset:0
    ds_read_b128 v[48:51], v109 offset:16
    ds_read_b128 v[52:55], v109 offset:40960
    ds_read_b128 v[56:59], v109 offset:40976
    ds_read_b128 v[60:63], v7 offset:0
    ds_read_b128 v[64:67], v7 offset:16
    ds_read_b128 v[68:71], v7 offset:40960
    ds_read_b128 v[72:75], v7 offset:40976
    v_lshlrev_b32 v28, 16, v20
    v_and_b32 v29, 0xffff0000, v20
    v_lshlrev_b32 v30, 16, v21
    v_and_b32 v31, 0xffff0000, v21
    v_lshlrev_b32 v32, 16, v22
    v_and_b32 v33, 0xffff0000, v22
    v_lshlrev_b32 v34, 16, v23
    v_and_b32 v35, 0xffff0000, v23
    s_waitcnt lgkmcnt(4)
    v_pk_add_f32 v[44:45], v[44:45], v[52:53]
    v_pk_add_f32 v[46:47], v[46:47], v[54:55]
    v_pk_add_f32 v[48:49], v[48:49], v[56:57]
    v_pk_add_f32 v[50:51], v[50:51], v[58:59]
    v_pk_add_f32 v[28:29], v[28:29], v[44:45]
    v_pk_add_f32 v[30:31], v[30:31], v[46:47]
    v_pk_add_f32 v[32:33], v[32:33], v[48:49]
    v_pk_add_f32 v[34:35], v[34:35], v[50:51]
    s_waitcnt lgkmcnt(0)
    v_pk_add_f32 v[60:61], v[60:61], v[68:69]
    v_pk_add_f32 v[62:63], v[62:63], v[70:71]
    v_pk_add_f32 v[64:65], v[64:65], v[72:73]
    v_pk_add_f32 v[66:67], v[66:67], v[74:75]
    v_pk_add_f32 v[28:29], v[28:29], v[60:61]
    v_pk_add_f32 v[30:31], v[30:31], v[62:63]
    v_pk_add_f32 v[32:33], v[32:33], v[64:65]
    v_pk_add_f32 v[34:35], v[34:35], v[66:67]
    v_cvt_pk_bf16_f32 v20, v28, v29
    v_cvt_pk_bf16_f32 v21, v30, v31
    v_cvt_pk_bf16_f32 v22, v32, v33
    v_cvt_pk_bf16_f32 v23, v34, v35
    v_lshlrev_b32 v28, 16, v20
    v_and_b32 v29, 0xffff0000, v20
    v_lshlrev_b32 v30, 16, v21
    v_and_b32 v31, 0xffff0000, v21
    v_lshlrev_b32 v32, 16, v22
    v_and_b32 v33, 0xffff0000, v22
    v_lshlrev_b32 v34, 16, v23
    v_and_b32 v35, 0xffff0000, v23
    v_pk_add_f32 v[44:45], v[28:29], v[30:31]
    v_pk_mul_f32 v[46:47], v[28:29], v[28:29]
    v_pk_fma_f32 v[46:47], v[30:31], v[30:31], v[46:47]
    v_pk_add_f32 v[44:45], v[44:45], v[32:33]
    v_pk_fma_f32 v[46:47], v[32:33], v[32:33], v[46:47]
    v_pk_add_f32 v[44:45], v[44:45], v[34:35]
    v_pk_fma_f32 v[46:47], v[34:35], v[34:35], v[46:47]
    v_add_f32 v44, v44, v45
    v_add_f32 v45, v46, v47
    ds_write_b64 v115, v[44:45] offset:32768
    buffer_store_dwordx4 v[20:23], v107, s[36:39], 0 offen sc1
    s_cmp_lg_u32 s13, 7
    s_cbranch_scc1 p2_one_20
    v_add_u32 v7, 81920, v110
    ds_read_b128 v[44:47], v110 offset:0
    ds_read_b128 v[48:51], v110 offset:16
    ds_read_b128 v[52:55], v110 offset:40960
    ds_read_b128 v[56:59], v110 offset:40976
    ds_read_b128 v[60:63], v7 offset:0
    ds_read_b128 v[64:67], v7 offset:16
    ds_read_b128 v[68:71], v7 offset:40960
    ds_read_b128 v[72:75], v7 offset:40976
    v_lshlrev_b32 v36, 16, v24
    v_and_b32 v37, 0xffff0000, v24
    v_lshlrev_b32 v38, 16, v25
    v_and_b32 v39, 0xffff0000, v25
    v_lshlrev_b32 v40, 16, v26
    v_and_b32 v41, 0xffff0000, v26
    v_lshlrev_b32 v42, 16, v27
    v_and_b32 v43, 0xffff0000, v27
    s_waitcnt lgkmcnt(4)
    v_pk_add_f32 v[44:45], v[44:45], v[52:53]
    v_pk_add_f32 v[46:47], v[46:47], v[54:55]
    v_pk_add_f32 v[48:49], v[48:49], v[56:57]
    v_pk_add_f32 v[50:51], v[50:51], v[58:59]
    v_pk_add_f32 v[36:37], v[36:37], v[44:45]
    v_pk_add_f32 v[38:39], v[38:39], v[46:47]
    v_pk_add_f32 v[40:41], v[40:41], v[48:49]
    v_pk_add_f32 v[42:43], v[42:43], v[50:51]
    s_waitcnt lgkmcnt(0)
    v_pk_add_f32 v[60:61], v[60:61], v[68:69]
    v_pk_add_f32 v[62:63], v[62:63], v[70:71]
    v_pk_add_f32 v[64:65], v[64:65], v[72:73]
    v_pk_add_f32 v[66:67], v[66:67], v[74:75]
    v_pk_add_f32 v[36:37], v[36:37], v[60:61]
    v_pk_add_f32 v[38:39], v[38:39], v[62:63]
    v_pk_add_f32 v[40:41], v[40:41], v[64:65]
    v_pk_add_f32 v[42:43], v[42:43], v[66:67]
    v_cvt_pk_bf16_f32 v24, v36, v37
    v_cvt_pk_bf16_f32 v25, v38, v39
    v_cvt_pk_bf16_f32 v26, v40, v41
    v_cvt_pk_bf16_f32 v27, v42, v43
    v_lshlrev_b32 v36, 16, v24
    v_and_b32 v37, 0xffff0000, v24
    v_lshlrev_b32 v38, 16, v25
    v_and_b32 v39, 0xffff0000, v25
    v_lshlrev_b32 v40, 16, v26
    v_and_b32 v41, 0xffff0000, v26
    v_lshlrev_b32 v42, 16, v27
    v_and_b32 v43, 0xffff0000, v27
    v_pk_add_f32 v[44:45], v[36:37], v[38:39]
    v_pk_mul_f32 v[46:47], v[36:37], v[36:37]
    v_pk_fma_f32 v[46:47], v[38:39], v[38:39], v[46:47]
    v_pk_add_f32 v[44:45], v[44:45], v[40:41]
    v_pk_fma_f32 v[46:47], v[40:41], v[40:41], v[46:47]
    v_pk_add_f32 v[44:45], v[44:45], v[42:43]
    v_pk_fma_f32 v[46:47], v[42:43], v[42:43], v[46:47]
    v_add_f32 v44, v44, v45
    v_add_f32 v45, v46, v47
    ds_write_b64 v116, v[44:45] offset:32768
    buffer_store_dwordx4 v[24:27], v108, s[36:39], 0 offen sc1
p2_one_20:
    s_waitcnt lgkmcnt(0)
    s_barrier
    s_cmp_lg_u32 s13, 0
    s_cbranch_scc1 p2_np_21
    v_lshrrev_b32 v7, 1, v1
    v_mul_u32_u24 v7, 144, v7
    v_and_b32 v9, 1, v1
    v_lshl_add_u32 v7, v9, 2, v7
    v_add_u32 v10, 32768, v7
    ds_read2_b32 v[44:45], v10 offset0:0 offset1:2
    ds_read2_b32 v[46:47], v10 offset0:4 offset1:6
    ds_read2_b32 v[48:49], v10 offset0:8 offset1:10
    ds_read2_b32 v[50:51], v10 offset0:12 offset1:14
    ds_read2_b32 v[52:53], v10 offset0:16 offset1:18
    ds_read2_b32 v[54:55], v10 offset0:20 offset1:22
    ds_read2_b32 v[56:57], v10 offset0:24 offset1:26
    ds_read2_b32 v[58:59], v10 offset0:28 offset1:30
    ds_read2_b32 v[60:61], v10 offset0:32 offset1:34
    v_lshlrev_b32 v8, 2, v1
    s_lshl_b32 s16, s10, 10
    s_lshl_b32 s17, s11, 8
    s_add_u32 s17, s17, s16
    s_waitcnt lgkmcnt(0)
    v_pk_add_f32 v[44:45], v[44:45], v[52:53]
    v_pk_add_f32 v[46:47], v[46:47], v[54:55]
    v_pk_add_f32 v[48:49], v[48:49], v[56:57]
    v_pk_add_f32 v[50:51], v[50:51], v[58:59]
    v_pk_add_f32 v[44:45], v[44:45], v[48:49]
    v_pk_add_f32 v[46:47], v[46:47], v[50:51]
    v_pk_add_f32 v[44:45], v[44:45], v[46:47]
    v_pk_add_f32 v[44:45], v[44:45], v[60:61]
    v_add_f32 v7, v44, v45
    v_cmp_eq_u32 vcc, -1, v7
    v_mov_b32 v10, 0x7fc00000
    s_nop 0
    v_cndmask_b32 v7, v7, v10, vcc
    buffer_store_dword v7, v8, s[44:47], s17 offen sc1
    s_mov_b32 s18, 0
p2_poll_22:
    buffer_load_dword v44, v8, s[44:47], s16 offen offset:0 sc1
    buffer_load_dword v45, v8, s[44:47], s16 offen offset:256 sc1
    buffer_load_dword v46, v8, s[44:47], s16 offen offset:512 sc1
    buffer_load_dword v47, v8, s[44:47], s16 offen offset:768 sc1
    s_add_u32 s18, s18, 1
    s_waitcnt vmcnt(0)
    v_cmp_eq_u32 vcc, -1, v44
    v_cmp_eq_u32 s[58:59], -1, v45
    s_nop 0
    s_or_b64 vcc, vcc, s[58:59]
    v_cmp_eq_u32 s[58:59], -1, v46
    s_nop 0
    s_or_b64 vcc, vcc, s[58:59]
    v_cmp_eq_u32 s[58:59], -1, v47
    s_nop 0
    s_or_b64 vcc, vcc, s[58:59]
    s_cmp_gt_u32 s18, 0x100000
    s_cbranch_scc1 p2_pd_23
    s_cbranch_vccnz p2_poll_22
p2_pd_23:
    v_add_f32 v44, v44, v45
    v_add_f32 v46, v46, v47
    v_add_f32 v44, v44, v46
    v_mul_f32 v44, 0x3ae38e39, v44
    s_nop 1
    v_mov_b32_dpp v45, v44 quad_perm:[0,0,2,2] row_mask:0xf bank_mask:0xf
    v_fma_f32 v46, -v45, v45, v44
    v_max_f32 v46, 0, v46
    v_add_f32 v47, 0x3727c5ac, v46
    v_rcp_f32 v48, v47
    v_rsq_f32 v47, v47
    v_mul_f32 v46, v46, v48
    v_add_f32 v46, 0x3727c5ac, v46
    v_rsq_f32 v46, v46
    s_nop 0
    v_mul_f32 v46, v46, v47
    v_cmp_eq_u32 vcc, 1, v9
    s_nop 1
    v_cndmask_b32 v44, v44, v46, vcc
    ds_write_b32 v8, v44 offset:37888
    s_waitcnt lgkmcnt(0)
p2_np_21:
    v_lshl_add_u32 v7, v2, 2, v3
    v_mul_u32_u24 v7, 288, v7
    v_lshl_add_u32 v7, v4, 3, v7
    s_lshl_b32 s16, s13, 5
    v_add_u32 v7, s16, v7
    s_mul_i32 s16, s10, 36
    s_mul_i32 s17, s11, 9
    s_add_u32 s16, s16, s17
    s_add_u32 s16, s16, s13
    s_lshl_b32 s16, s16, 10
    s_add_u32 s17, s16, 8192
    s_cmp_eq_u32 s13, 0
    s_cselect_b32 s17, s17, 0x40000000
    s_barrier
    ds_read_b64 v[44:45], v111 offset:37888
    s_waitcnt lgkmcnt(0)
    v_pk_add_f32 v[28:29], v[28:29], v[44:45] op_sel_hi:[1,0] neg_lo:[0,1] neg_hi:[0,1]
    v_pk_add_f32 v[30:31], v[30:31], v[44:45] op_sel_hi:[1,0] neg_lo:[0,1] neg_hi:[0,1]
    v_pk_add_f32 v[32:33], v[32:33], v[44:45] op_sel_hi:[1,0] neg_lo:[0,1] neg_hi:[0,1]
    v_pk_add_f32 v[34:35], v[34:35], v[44:45] op_sel_hi:[1,0] neg_lo:[0,1] neg_hi:[0,1]
    v_pk_mul_f32 v[28:29], v[28:29], v[44:45] op_sel:[0,1] op_sel_hi:[1,1]
    v_pk_mul_f32 v[30:31], v[30:31], v[44:45] op_sel:[0,1] op_sel_hi:[1,1]
    v_pk_mul_f32 v[32:33], v[32:33], v[44:45] op_sel:[0,1] op_sel_hi:[1,1]
    v_pk_mul_f32 v[34:35], v[34:35], v[44:45] op_sel:[0,1] op_sel_hi:[1,1]
    v_cvt_pk_bf16_f32 v52, v28, v29
    v_cvt_pk_bf16_f32 v53, v30, v31
    v_cvt_pk_bf16_f32 v54, v32, v33
    v_cvt_pk_bf16_f32 v55, v34, v35
    ds_write_b128 v113, v[52:55] offset:40960
    s_cmp_lg_u32 s13, 7
    s_cbranch_scc1 p2_one2_24
    ds_read_b64 v[46:47], v112 offset:37888
    s_waitcnt lgkmcnt(0)
    v_pk_add_f32 v[36:37], v[36:37], v[46:47] op_sel_hi:[1,0] neg_lo:[0,1] neg_hi:[0,1]
    v_pk_add_f32 v[38:39], v[38:39], v[46:47] op_sel_hi:[1,0] neg_lo:[0,1] neg_hi:[0,1]
    v_pk_add_f32 v[40:41], v[40:41], v[46:47] op_sel_hi:[1,0] neg_lo:[0,1] neg_hi:[0,1]
    v_pk_add_f32 v[42:43], v[42:43], v[46:47] op_sel_hi:[1,0] neg_lo:[0,1] neg_hi:[0,1]
    v_pk_mul_f32 v[36:37], v[36:37], v[46:47] op_sel:[0,1] op_sel_hi:[1,1]
    v_pk_mul_f32 v[38:39], v[38:39], v[46:47] op_sel:[0,1] op_sel_hi:[1,1]
    v_pk_mul_f32 v[40:41], v[40:41], v[46:47] op_sel:[0,1] op_sel_hi:[1,1]
    v_pk_mul_f32 v[42:43], v[42:43], v[46:47] op_sel:[0,1] op_sel_hi:[1,1]
    v_cvt_pk_bf16_f32 v56, v36, v37
    v_cvt_pk_bf16_f32 v57, v38, v39
    v_cvt_pk_bf16_f32 v58, v40, v41
    v_cvt_pk_bf16_f32 v59, v42, v43
    ds_write_b128 v114, v[56:59] offset:40960
p2_one2_24:
    s_waitcnt lgkmcnt(0)
    s_barrier
    ds_read_b64_tr_b16 v[60:61], v7 offset:40960
    ds_read_b64_tr_b16 v[62:63], v7 offset:45568
    ds_read_b64_tr_b16 v[64:65], v7 offset:41216
    ds_read_b64_tr_b16 v[66:67], v7 offset:45824
    s_waitcnt lgkmcnt(0)
    buffer_store_dwordx4 v[60:63], v6, s[40:43], s16 offen sc1
    buffer_store_dwordx4 v[64:67], v6, s[40:43], s17 offen sc1
    s_waitcnt vmcnt(0) lgkmcnt(0)
    s_barrier
    s_cmp_lg_u32 s13, 0
    s_cbranch_scc1 arr_25
    s_and_b32 s16, s2, 63
    s_lshl_b32 s16, s16, 7
    s_add_u32 s16, s16, 8192
    v_mov_b32 v7, 1
    v_mov_b32 v8, 0
    s_mov_b64 exec, 1
    buffer_atomic_add v7, v8, s[96:99], s16 offen sc1
    s_mov_b64 exec, -1
arr_25:
    s_cmp_ge_u32 s2, 216
    s_cbranch_scc1 g3_pf
    s_load_dwordx4 s[4:7], s[0:1], 40
    s_load_dwordx2 s[8:9], s[0:1], 88
    v_lshrrev_b32 v1, 6, v0
    s_and_b32 s10, s2, 7
    s_lshr_b32 s19, s2, 3
    v_readfirstlane_b32 s13, v1
    s_mul_i32 s10, s10, 27
    s_add_u32 s10, s10, s19
    s_mul_i32 s11, s10, 171
    s_lshr_b32 s11, s11, 10
    s_mul_i32 s12, s11, 6
    s_sub_u32 s12, s10, s12
    v_and_b32 v1, 63, v0
    v_lshrrev_b32 v2, 4, v1
    v_lshlrev_b32 v8, 4, v1
    s_and_b32 s14, s13, 1
    s_bfe_u32 s15, s13, 0x10001
    s_cmp_lt_u32 s13, 4
    s_cbranch_scc1 g3_cons
    s_and_b32 s18, s13, 3
    s_lshl_b32 s16, s18, 4
    s_movk_i32 s17, 9216
    v_and_b32 v6, 15, v1
    v_add_u32 v7, s16, v2
    v_mul_lo_u32 v7, v7, s17
    v_add_u32 v5, 0, v2
    v_lshlrev_b32 v5, 1, v5
    v_xor_b32 v5, v5, v6
    v_lshl_add_u32 v9, v5, 4, v7
    v_add_u32 v11, 71680, v9
    v_add_u32 v5, 4, v2
    v_lshlrev_b32 v5, 1, v5
    v_xor_b32 v5, v5, v6
    v_lshl_add_u32 v10, v5, 4, v7
    v_add_u32 v10, 35840, v10
    v_add_u32 v12, 71680, v10
    s_lshl_b32 s36, s11, 8
    s_mul_i32 s37, s15, 36864
    s_mul_i32 s16, s12, 6144
    s_add_u32 s37, s37, s16
    s_mul_i32 s16, s14, 3072
    s_add_u32 s37, s37, s16
    s_lshl_b32 s38, s18, 12
    s_mul_i32 s39, s18, 3072
    s_add_u32 s39, s39, 16384
    s_waitcnt lgkmcnt(0)
    s_mov_b32 s20, s4
    s_and_b32 s21, s5, 0xffff
    s_mov_b32 s22, 0x1200000
    s_mov_b32 s23, 0x00020000
    s_mov_b32 s24, s8
    s_and_b32 s25, s9, 0xffff
    s_mov_b32 s26, 0x240000
    s_mov_b32 s27, 0x00020000
    s_mov_b32 s43, 28672
    s_mov_b32 m0, s38
    s_nop 0
    buffer_load_dwordx4 v9, s[20:23], s36 offen offset:0 lds
    buffer_load_dwordx4 v10, s[20:23], s36 offen offset:1024 lds
    buffer_load_dwordx4 v11, s[20:23], s36 offen offset:2048 lds
    buffer_load_dwordx4 v12, s[20:23], s36 offen offset:3072 lds
    s_add_u32 s36, s36, 589824
    s_add_u32 s38, s38, 0x7000
    s_mov_b32 m0, s38
    s_nop 0
    buffer_load_dwordx4 v9, s[20:23], s36 offen offset:0 lds
    buffer_load_dwordx4 v10, s[20:23], s36 offen offset:1024 lds
    buffer_load_dwordx4 v11, s[20:23], s36 offen offset:2048 lds
    buffer_load_dwordx4 v12, s[20:23], s36 offen offset:3072 lds
    s_add_u32 s36, s36, 589824
    s_add_u32 s38, s38, 0x7000
    s_mov_b32 m0, s38
    s_nop 0
    buffer_load_dwordx4 v9, s[20:23], s36 offen offset:0 lds
    buffer_load_dwordx4 v10, s[20:23], s36 offen offset:1024 lds
    buffer_load_dwordx4 v11, s[20:23], s36 offen offset:2048 lds
    buffer_load_dwordx4 v12, s[20:23], s36 offen offset:3072 lds
    s_add_u32 s36, s36, 589824
    s_add_u32 s38, s38, 0x7000
    s_mov_b32 m0, s38
    s_nop 0
    buffer_load_dwordx4 v9, s[20:23], s36 offen offset:0 lds
    buffer_load_dwordx4 v10, s[20:23], s36 offen offset:1024 lds
    buffer_load_dwordx4 v11, s[20:23], s36 offen offset:2048 lds
    buffer_load_dwordx4 v12, s[20:23], s36 offen offset:3072 lds
    s_add_u32 s36, s36, 589824
    s_add_u32 s38, s38, 0x7000
    s_mov_b32 m0, s38
    s_nop 0
    buffer_load_dwordx4 v9, s[20:23], s36 offen offset:0 lds
    buffer_load_dwordx4 v10, s[20:23], s36 offen offset:1024 lds
    buffer_load_dwordx4 v11, s[20:23], s36 offen offset:2048 lds
    buffer_load_dwordx4 v12, s[20:23], s36 offen offset:3072 lds
    s_add_u32 s36, s36, 589824
    s_add_u32 s38, s38, 0xfffe4000
    s_cmp_lg_u32 s13, 4
    s_cbranch_scc1 g3_np_26
    v_and_b32 v6, 63, v0
    v_lshlrev_b32 v6, 7, v6
    s_mov_b32 s16, 8192
    s_mov_b32 s18, 0
poll_27:
    buffer_load_dword v5, v6, s[96:99], s16 offen sc1
    s_add_u32 s18, s18, 1
    s_cmp_gt_u32 s18, 0x80000
    s_cbranch_scc1 pollx_28
    s_waitcnt vmcnt(0)
    v_cmp_gt_u32 vcc, 4, v5
    s_cbranch_vccnz poll_27
pollx_28:
    s_waitcnt vmcnt(0)
g3_np_26:
    s_barrier
    s_mov_b32 m0, s39
    s_nop 0
    buffer_load_dwordx4 v8, s[24:27], s37 offen offset:0 sc1 lds
    buffer_load_dwordx4 v8, s[24:27], s37 offen offset:1024 sc1 lds
    buffer_load_dwordx4 v8, s[24:27], s37 offen offset:2048 sc1 lds
    s_add_u32 s37, s37, 73728
    s_add_u32 s39, s39, 0x7000
    s_mov_b32 m0, s39
    s_nop 0
    buffer_load_dwordx4 v8, s[24:27], s37 offen offset:0 sc1 lds
    buffer_load_dwordx4 v8, s[24:27], s37 offen offset:1024 sc1 lds
    buffer_load_dwordx4 v8, s[24:27], s37 offen offset:2048 sc1 lds
    s_add_u32 s37, s37, 73728
    s_add_u32 s39, s39, 0x7000
    s_mov_b32 m0, s39
    s_nop 0
    buffer_load_dwordx4 v8, s[24:27], s37 offen offset:0 sc1 lds
    buffer_load_dwordx4 v8, s[24:27], s37 offen offset:1024 sc1 lds
    buffer_load_dwordx4 v8, s[24:27], s37 offen offset:2048 sc1 lds
    s_add_u32 s37, s37, 73728
    s_add_u32 s39, s39, 0x7000
    s_mov_b32 m0, s39
    s_nop 0
    buffer_load_dwordx4 v8, s[24:27], s37 offen offset:0 sc1 lds
    buffer_load_dwordx4 v8, s[24:27], s37 offen offset:1024 sc1 lds
    buffer_load_dwordx4 v8, s[24:27], s37 offen offset:2048 sc1 lds
    s_add_u32 s37, s37, 73728
    s_add_u32 s39, s39, 0x7000
    s_mov_b32 m0, s39
    s_nop 0
    buffer_load_dwordx4 v8, s[24:27], s37 offen offset:0 sc1 lds
    buffer_load_dwordx4 v8, s[24:27], s37 offen offset:1024 sc1 lds
    buffer_load_dwordx4 v8, s[24:27], s37 offen offset:2048 sc1 lds
    s_add_u32 s37, s37, 73728
    s_add_u32 s39, s39, 0xfffe4000
    s_waitcnt vmcnt(12)
    s_barrier
    s_waitcnt vmcnt(9) lgkmcnt(0)
    s_barrier
    s_mov_b32 m0, s38
    s_nop 0
    buffer_load_dwordx4 v9, s[20:23], s36 offen offset:0 lds
    buffer_load_dwordx4 v10, s[20:23], s36 offen offset:1024 lds
    buffer_load_dwordx4 v11, s[20:23], s36 offen offset:2048 lds
    buffer_load_dwordx4 v12, s[20:23], s36 offen offset:3072 lds
    s_add_u32 s36, s36, 589824
    s_mov_b32 m0, s39
    s_nop 0
    buffer_load_dwordx4 v8, s[24:27], s37 offen offset:0 sc1 lds
    buffer_load_dwordx4 v8, s[24:27], s37 offen offset:1024 sc1 lds
    buffer_load_dwordx4 v8, s[24:27], s37 offen offset:2048 sc1 lds
    s_add_u32 s37, s37, 73728
    s_add_u32 s38, s38, 0x7000
    s_add_u32 s39, s39, 0x7000
    s_waitcnt vmcnt(13) lgkmcnt(0)
    s_barrier
    s_mov_b32 m0, s38
    s_nop 0
    buffer_load_dwordx4 v9, s[20:23], s36 offen offset:0 lds
    buffer_load_dwordx4 v10, s[20:23], s36 offen offset:1024 lds
    buffer_load_dwordx4 v11, s[20:23], s36 offen offset:2048 lds
    buffer_load_dwordx4 v12, s[20:23], s36 offen offset:3072 lds
    s_add_u32 s36, s36, 589824
    s_mov_b32 m0, s39
    s_nop 0
    buffer_load_dwordx4 v8, s[24:27], s37 offen offset:0 sc1 lds
    buffer_load_dwordx4 v8, s[24:27], s37 offen offset:1024 sc1 lds
    buffer_load_dwordx4 v8, s[24:27], s37 offen offset:2048 sc1 lds
    s_add_u32 s37, s37, 73728
    s_add_u32 s38, s38, 0x7000
    s_add_u32 s39, s39, 0x7000
    s_waitcnt vmcnt(17) lgkmcnt(0)
    s_barrier
    s_mov_b32 m0, s38
    s_nop 0
    buffer_load_dwordx4 v9, s[20:23], s36 offen offset:0 lds
    buffer_load_dwordx4 v10, s[20:23], s36 offen offset:1024 lds
    buffer_load_dwordx4 v11, s[20:23], s36 offen offset:2048 lds
    buffer_load_dwordx4 v12, s[20:23], s36 offen offset:3072 lds
    s_add_u32 s36, s36, 589824
    s_mov_b32 m0, s39
    s_nop 0
    buffer_load_dwordx4 v8, s[24:27], s37 offen offset:0 sc1 lds
    buffer_load_dwordx4 v8, s[24:27], s37 offen offset:1024 sc1 lds
    buffer_load_dwordx4 v8, s[24:27], s37 offen offset:2048 sc1 lds
    s_add_u32 s37, s37, 73728
    s_add_u32 s38, s38, 0x7000
    s_add_u32 s39, s39, 0x7000
    s_waitcnt vmcnt(21) lgkmcnt(0)
    s_barrier
    s_mov_b32 m0, s38
    s_nop 0
    buffer_load_dwordx4 v9, s[20:23], s36 offen offset:0 lds
    buffer_load_dwordx4 v10, s[20:23], s36 offen offset:1024 lds
    buffer_load_dwordx4 v11, s[20:23], s36 offen offset:2048 lds
    buffer_load_dwordx4 v12, s[20:23], s36 offen offset:3072 lds
    s_add_u32 s36, s36, 589824
    s_mov_b32 m0, s39
    s_nop 0
    buffer_load_dwordx4 v8, s[24:27], s37 offen offset:0 sc1 lds
    buffer_load_dwordx4 v8, s[24:27], s37 offen offset:1024 sc1 lds
    buffer_load_dwordx4 v8, s[24:27], s37 offen offset:2048 sc1 lds
    s_add_u32 s37, s37, 73728
    s_add_u32 s38, s38, 0x7000
    s_add_u32 s39, s39, 0x7000
    s_mov_b32 s40, 4
    s_mov_b32 s41, 4
g3_ploop:
    s_add_u32 s40, s40, 1
    s_cmp_eq_u32 s40, 5
    s_cselect_b32 s42, 0xfffe4000, s43
    s_cselect_b32 s40, 0, s40
    s_waitcnt vmcnt(21)
    s_barrier
    s_mov_b32 m0, s38
    s_nop 0
    buffer_load_dwordx4 v9, s[20:23], s36 offen offset:0 lds
    buffer_load_dwordx4 v10, s[20:23], s36 offen offset:1024 lds
    buffer_load_dwordx4 v11, s[20:23], s36 offen offset:2048 lds
    buffer_load_dwordx4 v12, s[20:23], s36 offen offset:3072 lds
    s_add_u32 s36, s36, 589824
    s_mov_b32 m0, s39
    s_nop 0
    buffer_load_dwordx4 v8, s[24:27], s37 offen offset:0 sc1 lds
    buffer_load_dwordx4 v8, s[24:27], s37 offen offset:1024 sc1 lds
    buffer_load_dwordx4 v8, s[24:27], s37 offen offset:2048 sc1 lds
    s_add_u32 s37, s37, 73728
    s_add_u32 s38, s38, s42
    s_add_u32 s39, s39, s42
    s_add_u32 s41, s41, 1
    s_cmp_lt_u32 s41, 27
    s_cbranch_scc1 g3_ploop
    s_waitcnt vmcnt(21)
    s_barrier
    s_waitcnt vmcnt(14)
    s_barrier
    s_waitcnt vmcnt(7)
    s_barrier
    s_waitcnt vmcnt(0)
    s_barrier
    s_branch g3_done
g3_cons:
    v_bfe_u32 v3, v1, 2, 2
    v_and_b32 v4, 3, v1
    v_and_b32 v5, 1, v2
    v_lshl_add_u32 v5, v5, 2, v3
    v_lshl_add_u32 v6, v2, 2, v3
    v_lshlrev_b32 v6, 8, v6
    v_lshl_add_u32 v6, v4, 3, v6
    s_lshl_b32 s16, s15, 2
    s_add_u32 s17, s16, 0
    v_xor_b32 v7, s17, v5
    v_lshl_add_u32 v9, v7, 5, v6
    s_add_u32 s17, s16, 1
    v_xor_b32 v7, s17, v5
    v_lshl_add_u32 v10, v7, 5, v6
    s_add_u32 s17, s16, 2
    v_xor_b32 v7, s17, v5
    v_lshl_add_u32 v11, v7, 5, v6
    s_add_u32 s17, s16, 3
    v_xor_b32 v7, s17, v5
    v_lshl_add_u32 v12, v7, 5, v6
    s_mul_i32 s16, s14, 3072
    s_add_u32 s16, s16, 16384
    v_add_u32 v13, s16, v8
    s_waitcnt lgkmcnt(0)
    s_add_u32 s28, s8, 0x280000
    s_addc_u32 s29, s9, 0
    s_and_b32 s29, s29, 0xffff
    s_mov_b32 s30, 0x510000
    s_mov_b32 s31, 0x00020000
    s_mov_b32 s32, s6
    s_and_b32 s33, s7, 0xffff
    s_mov_b32 s34, 0x2400
    s_mov_b32 s35, 0x00020000
    s_lshl_b32 s36, s11, 8
    s_lshl_b32 s16, s15, 7
    v_lshl_add_u32 v5, v2, 3, s16
    buffer_load_dwordx2 v[14:15], v5, s[32:35], s36 offen offset:0
    buffer_load_dwordx2 v[16:17], v5, s[32:35], s36 offen offset:32
    buffer_load_dwordx2 v[18:19], v5, s[32:35], s36 offen offset:64
    buffer_load_dwordx2 v[20:21], v5, s[32:35], s36 offen offset:96
    s_lshl_b32 s50, s11, 2
    s_lshl_b32 s18, s15, 1
    s_add_u32 s50, s50, s18
    s_mul_i32 s50, s50, 36
    s_mul_i32 s18, s12, 6
    s_add_u32 s50, s50, s18
    s_mul_i32 s18, s14, 3
    s_add_u32 s50, s50, s18
    s_lshl_b32 s50, s50, 10
    s_add_u32 s51, s50, 36864
    s_mov_b32 s44, 0xc0135761
    s_mov_b32 s45, 0xc0135761
    v_mov_b32 v128, 0xbdd2d3e8
    v_mov_b32 v129, 0xbdd2d3e8
    s_waitcnt vmcnt(0)
    v_lshlrev_b32 v24, 16, v14
    v_and_b32 v25, 0xffff0000, v14
    v_lshlrev_b32 v26, 16, v15
    v_and_b32 v27, 0xffff0000, v15
    v_mov_b32 v28, v24
    v_mov_b32 v29, v25
    v_mov_b32 v30, v26
    v_mov_b32 v31, v27
    v_mov_b32 v32, v24
    v_mov_b32 v33, v25
    v_mov_b32 v34, v26
    v_mov_b32 v35, v27
    v_lshlrev_b32 v36, 16, v16
    v_and_b32 v37, 0xffff0000, v16
    v_lshlrev_b32 v38, 16, v17
    v_and_b32 v39, 0xffff0000, v17
    v_mov_b32 v40, v36
    v_mov_b32 v41, v37
    v_mov_b32 v42, v38
    v_mov_b32 v43, v39
    v_mov_b32 v44, v36
    v_mov_b32 v45, v37
    v_mov_b32 v46, v38
    v_mov_b32 v47, v39
    v_lshlrev_b32 v48, 16, v18
    v_and_b32 v49, 0xffff0000, v18
    v_lshlrev_b32 v50, 16, v19
    v_and_b32 v51, 0xffff0000, v19
    v_mov_b32 v52, v48
    v_mov_b32 v53, v49
    v_mov_b32 v54, v50
    v_mov_b32 v55, v51
    v_mov_b32 v56, v48
    v_mov_b32 v57, v49
    v_mov_b32 v58, v50
    v_mov_b32 v59, v51
    v_lshlrev_b32 v60, 16, v20
    v_and_b32 v61, 0xffff0000, v20
    v_lshlrev_b32 v62, 16, v21
    v_and_b32 v63, 0xffff0000, v21
    v_mov_b32 v64, v60
    v_mov_b32 v65, v61
    v_mov_b32 v66, v62
    v_mov_b32 v67, v63
    v_mov_b32 v68, v60
    v_mov_b32 v69, v61
    v_mov_b32 v70, v62
    v_mov_b32 v71, v63
    s_barrier
    s_setprio 2
    s_mov_b32 s40, 0
    s_mov_b32 s43, 28672
    s_mov_b32 s41, 0
    s_barrier
    ds_read_b128 v[88:91], v13 offset:0
    ds_read_b64_tr_b16 v[72:73], v9 offset:0
    ds_read_b64_tr_b16 v[74:75], v9 offset:4096
    ds_read_b128 v[92:95], v13 offset:1024
    ds_read_b128 v[96:99], v13 offset:2048
    ds_read_b64_tr_b16 v[76:77], v10 offset:0
    ds_read_b64_tr_b16 v[78:79], v10 offset:4096
    ds_read_b64_tr_b16 v[80:81], v11 offset:0
    ds_read_b64_tr_b16 v[82:83], v11 offset:4096
    ds_read_b64_tr_b16 v[84:85], v12 offset:0
    ds_read_b64_tr_b16 v[86:87], v12 offset:4096
g3_cloop:
    s_waitcnt lgkmcnt(0)
    v_mfma_f32_16x16x32_bf16 v[24:27], v[72:75], v[88:91], v[24:27]
    ds_read_b128 v[116:119], v13 offset:6144
    ds_read_b64_tr_b16 v[100:101], v9 offset:8192
    v_mfma_f32_16x16x32_bf16 v[28:31], v[72:75], v[92:95], v[28:31]
    ds_read_b64_tr_b16 v[102:103], v9 offset:12288
    ds_read_b128 v[120:123], v13 offset:7168
    v_mfma_f32_16x16x32_bf16 v[32:35], v[72:75], v[96:99], v[32:35]
    ds_read_b128 v[124:127], v13 offset:8192
    ds_read_b64_tr_b16 v[104:105], v10 offset:8192
    v_mfma_f32_16x16x32_bf16 v[36:39], v[76:79], v[88:91], v[36:39]
    ds_read_b64_tr_b16 v[106:107], v10 offset:12288
    ds_read_b64_tr_b16 v[108:109], v11 offset:8192
    v_mfma_f32_16x16x32_bf16 v[40:43], v[76:79], v[92:95], v[40:43]
    ds_read_b64_tr_b16 v[110:111], v11 offset:12288
    ds_read_b64_tr_b16 v[112:113], v12 offset:8192
    v_mfma_f32_16x16x32_bf16 v[44:47], v[76:79], v[96:99], v[44:47]
    ds_read_b64_tr_b16 v[114:115], v12 offset:12288
    s_add_u32 s40, s40, 1
    v_mfma_f32_16x16x32_bf16 v[48:51], v[80:83], v[88:91], v[48:51]
    s_cmp_eq_u32 s40, 5
    s_cselect_b32 s42, 0xfffe4000, s43
    v_mfma_f32_16x16x32_bf16 v[52:55], v[80:83], v[92:95], v[52:55]
    s_cselect_b32 s40, 0, s40
    v_add_u32 v9, s42, v9
    v_mfma_f32_16x16x32_bf16 v[56:59], v[80:83], v[96:99], v[56:59]
    v_add_u32 v10, s42, v10
    v_add_u32 v11, s42, v11
    v_mfma_f32_16x16x32_bf16 v[60:63], v[84:87], v[88:91], v[60:63]
    v_add_u32 v12, s42, v12
    v_add_u32 v13, s42, v13
    v_mfma_f32_16x16x32_bf16 v[64:67], v[84:87], v[92:95], v[64:67]
    s_add_u32 s41, s41, 1
    s_cmp_lt_u32 s41, 32
    v_mfma_f32_16x16x32_bf16 v[68:71], v[84:87], v[96:99], v[68:71]
    s_waitcnt lgkmcnt(0)
    v_mfma_f32_16x16x32_bf16 v[24:27], v[100:103], v[116:119], v[24:27]
    v_mfma_f32_16x16x32_bf16 v[28:31], v[100:103], v[120:123], v[28:31]
    v_mfma_f32_16x16x32_bf16 v[32:35], v[100:103], v[124:127], v[32:35]
    s_cbranch_scc0 g3_clast
    s_barrier
    v_mfma_f32_16x16x32_bf16 v[36:39], v[104:107], v[116:119], v[36:39]
    ds_read_b128 v[88:91], v13 offset:0
    ds_read_b64_tr_b16 v[72:73], v9 offset:0
    v_mfma_f32_16x16x32_bf16 v[40:43], v[104:107], v[120:123], v[40:43]
    ds_read_b64_tr_b16 v[74:75], v9 offset:4096
    ds_read_b128 v[92:95], v13 offset:1024
    v_mfma_f32_16x16x32_bf16 v[44:47], v[104:107], v[124:127], v[44:47]
    ds_read_b128 v[96:99], v13 offset:2048
    ds_read_b64_tr_b16 v[76:77], v10 offset:0
    v_mfma_f32_16x16x32_bf16 v[48:51], v[108:111], v[116:119], v[48:51]
    ds_read_b64_tr_b16 v[78:79], v10 offset:4096
    ds_read_b64_tr_b16 v[80:81], v11 offset:0
    v_mfma_f32_16x16x32_bf16 v[52:55], v[108:111], v[120:123], v[52:55]
    ds_read_b64_tr_b16 v[82:83], v11 offset:4096
    ds_read_b64_tr_b16 v[84:85], v12 offset:0
    v_mfma_f32_16x16x32_bf16 v[56:59], v[108:111], v[124:127], v[56:59]
    ds_read_b64_tr_b16 v[86:87], v12 offset:4096
    v_mfma_f32_16x16x32_bf16 v[60:63], v[112:115], v[116:119], v[60:63]
    v_mfma_f32_16x16x32_bf16 v[64:67], v[112:115], v[120:123], v[64:67]
    v_mfma_f32_16x16x32_bf16 v[68:71], v[112:115], v[124:127], v[68:71]
    s_branch g3_cloop
g3_clast:
    v_mfma_f32_16x16x32_bf16 v[36:39], v[104:107], v[116:119], v[36:39]
    v_mfma_f32_16x16x32_bf16 v[40:43], v[104:107], v[120:123], v[40:43]
    v_mfma_f32_16x16x32_bf16 v[44:47], v[104:107], v[124:127], v[44:47]
    v_mfma_f32_16x16x32_bf16 v[48:51], v[108:111], v[116:119], v[48:51]
    v_mfma_f32_16x16x32_bf16 v[52:55], v[108:111], v[120:123], v[52:55]
    v_mfma_f32_16x16x32_bf16 v[56:59], v[108:111], v[124:127], v[56:59]
    v_mfma_f32_16x16x32_bf16 v[60:63], v[112:115], v[116:119], v[60:63]
    v_mfma_f32_16x16x32_bf16 v[64:67], v[112:115], v[120:123], v[64:67]
    v_mfma_f32_16x16x32_bf16 v[68:71], v[112:115], v[124:127], v[68:71]
    s_setprio 0
    v_pk_mul_f32 v[72:73], v[24:25], v[24:25]
    v_pk_mul_f32 v[74:75], v[26:27], v[26:27]
    v_pk_mul_f32 v[76:77], v[36:37], v[36:37]
    v_pk_mul_f32 v[78:79], v[38:39], v[38:39]
    v_pk_fma_f32 v[72:73], v[72:73], v[128:129], s[44:45]
    v_pk_fma_f32 v[74:75], v[74:75], v[128:129], s[44:45]
    v_pk_fma_f32 v[76:77], v[76:77], v[128:129], s[44:45]
    v_pk_fma_f32 v[78:79], v[78:79], v[128:129], s[44:45]
    v_pk_mul_f32 v[72:73], v[72:73], v[24:25]
    v_pk_mul_f32 v[74:75], v[74:75], v[26:27]
    v_pk_mul_f32 v[76:77], v[76:77], v[36:37]
    v_pk_mul_f32 v[78:79], v[78:79], v[38:39]
    v_exp_f32 v72, v72
    v_exp_f32 v73, v73
    v_exp_f32 v74, v74
    v_exp_f32 v75, v75
    v_exp_f32 v76, v76
    v_exp_f32 v77, v77
    v_exp_f32 v78, v78
    v_exp_f32 v79, v79
    v_pk_add_f32 v[72:73], v[72:73], 1.0 op_sel_hi:[1,0]
    v_pk_add_f32 v[74:75], v[74:75], 1.0 op_sel_hi:[1,0]
    v_pk_add_f32 v[76:77], v[76:77], 1.0 op_sel_hi:[1,0]
    v_pk_add_f32 v[78:79], v[78:79], 1.0 op_sel_hi:[1,0]
    v_rcp_f32 v72, v72
    v_rcp_f32 v73, v73
    v_rcp_f32 v74, v74
    v_rcp_f32 v75, v75
    v_rcp_f32 v76, v76
    v_rcp_f32 v77, v77
    v_rcp_f32 v78, v78
    v_rcp_f32 v79, v79
    v_pk_mul_f32 v[24:25], v[24:25], v[72:73]
    v_pk_mul_f32 v[26:27], v[26:27], v[74:75]
    v_pk_mul_f32 v[36:37], v[36:37], v[76:77]
    v_pk_mul_f32 v[38:39], v[38:39], v[78:79]
    v_cvt_pk_bf16_f32 v100, v24, v25
    v_cvt_pk_bf16_f32 v101, v26, v27
    v_cvt_pk_bf16_f32 v102, v36, v37
    v_cvt_pk_bf16_f32 v103, v38, v39
    buffer_store_dwordx4 v[100:103], v8, s[28:31], s50 offen offset:0 sc1
    v_pk_mul_f32 v[72:73], v[28:29], v[28:29]
    v_pk_mul_f32 v[74:75], v[30:31], v[30:31]
    v_pk_mul_f32 v[76:77], v[40:41], v[40:41]
    v_pk_mul_f32 v[78:79], v[42:43], v[42:43]
    v_pk_fma_f32 v[72:73], v[72:73], v[128:129], s[44:45]
    v_pk_fma_f32 v[74:75], v[74:75], v[128:129], s[44:45]
    v_pk_fma_f32 v[76:77], v[76:77], v[128:129], s[44:45]
    v_pk_fma_f32 v[78:79], v[78:79], v[128:129], s[44:45]
    v_pk_mul_f32 v[72:73], v[72:73], v[28:29]
    v_pk_mul_f32 v[74:75], v[74:75], v[30:31]
    v_pk_mul_f32 v[76:77], v[76:77], v[40:41]
    v_pk_mul_f32 v[78:79], v[78:79], v[42:43]
    v_exp_f32 v72, v72
    v_exp_f32 v73, v73
    v_exp_f32 v74, v74
    v_exp_f32 v75, v75
    v_exp_f32 v76, v76
    v_exp_f32 v77, v77
    v_exp_f32 v78, v78
    v_exp_f32 v79, v79
    v_pk_add_f32 v[72:73], v[72:73], 1.0 op_sel_hi:[1,0]
    v_pk_add_f32 v[74:75], v[74:75], 1.0 op_sel_hi:[1,0]
    v_pk_add_f32 v[76:77], v[76:77], 1.0 op_sel_hi:[1,0]
    v_pk_add_f32 v[78:79], v[78:79], 1.0 op_sel_hi:[1,0]
    v_rcp_f32 v72, v72
    v_rcp_f32 v73, v73
    v_rcp_f32 v74, v74
    v_rcp_f32 v75, v75
    v_rcp_f32 v76, v76
    v_rcp_f32 v77, v77
    v_rcp_f32 v78, v78
    v_rcp_f32 v79, v79
    v_pk_mul_f32 v[28:29], v[28:29], v[72:73]
    v_pk_mul_f32 v[30:31], v[30:31], v[74:75]
    v_pk_mul_f32 v[40:41], v[40:41], v[76:77]
    v_pk_mul_f32 v[42:43], v[42:43], v[78:79]
    v_cvt_pk_bf16_f32 v104, v28, v29
    v_cvt_pk_bf16_f32 v105, v30, v31
    v_cvt_pk_bf16_f32 v106, v40, v41
    v_cvt_pk_bf16_f32 v107, v42, v43
    buffer_store_dwordx4 v[104:107], v8, s[28:31], s50 offen offset:1024 sc1
    v_pk_mul_f32 v[72:73], v[32:33], v[32:33]
    v_pk_mul_f32 v[74:75], v[34:35], v[34:35]
    v_pk_mul_f32 v[76:77], v[44:45], v[44:45]
    v_pk_mul_f32 v[78:79], v[46:47], v[46:47]
    v_pk_fma_f32 v[72:73], v[72:73], v[128:129], s[44:45]
    v_pk_fma_f32 v[74:75], v[74:75], v[128:129], s[44:45]
    v_pk_fma_f32 v[76:77], v[76:77], v[128:129], s[44:45]
    v_pk_fma_f32 v[78:79], v[78:79], v[128:129], s[44:45]
    v_pk_mul_f32 v[72:73], v[72:73], v[32:33]
    v_pk_mul_f32 v[74:75], v[74:75], v[34:35]
    v_pk_mul_f32 v[76:77], v[76:77], v[44:45]
    v_pk_mul_f32 v[78:79], v[78:79], v[46:47]
    v_exp_f32 v72, v72
    v_exp_f32 v73, v73
    v_exp_f32 v74, v74
    v_exp_f32 v75, v75
    v_exp_f32 v76, v76
    v_exp_f32 v77, v77
    v_exp_f32 v78, v78
    v_exp_f32 v79, v79
    v_pk_add_f32 v[72:73], v[72:73], 1.0 op_sel_hi:[1,0]
    v_pk_add_f32 v[74:75], v[74:75], 1.0 op_sel_hi:[1,0]
    v_pk_add_f32 v[76:77], v[76:77], 1.0 op_sel_hi:[1,0]
    v_pk_add_f32 v[78:79], v[78:79], 1.0 op_sel_hi:[1,0]
    v_rcp_f32 v72, v72
    v_rcp_f32 v73, v73
    v_rcp_f32 v74, v74
    v_rcp_f32 v75, v75
    v_rcp_f32 v76, v76
    v_rcp_f32 v77, v77
    v_rcp_f32 v78, v78
    v_rcp_f32 v79, v79
    v_pk_mul_f32 v[32:33], v[32:33], v[72:73]
    v_pk_mul_f32 v[34:35], v[34:35], v[74:75]
    v_pk_mul_f32 v[44:45], v[44:45], v[76:77]
    v_pk_mul_f32 v[46:47], v[46:47], v[78:79]
    v_cvt_pk_bf16_f32 v108, v32, v33
    v_cvt_pk_bf16_f32 v109, v34, v35
    v_cvt_pk_bf16_f32 v110, v44, v45
    v_cvt_pk_bf16_f32 v111, v46, v47
    buffer_store_dwordx4 v[108:111], v8, s[28:31], s50 offen offset:2048 sc1
    v_pk_mul_f32 v[72:73], v[48:49], v[48:49]
    v_pk_mul_f32 v[74:75], v[50:51], v[50:51]
    v_pk_mul_f32 v[76:77], v[60:61], v[60:61]
    v_pk_mul_f32 v[78:79], v[62:63], v[62:63]
    v_pk_fma_f32 v[72:73], v[72:73], v[128:129], s[44:45]
    v_pk_fma_f32 v[74:75], v[74:75], v[128:129], s[44:45]
    v_pk_fma_f32 v[76:77], v[76:77], v[128:129], s[44:45]
    v_pk_fma_f32 v[78:79], v[78:79], v[128:129], s[44:45]
    v_pk_mul_f32 v[72:73], v[72:73], v[48:49]
    v_pk_mul_f32 v[74:75], v[74:75], v[50:51]
    v_pk_mul_f32 v[76:77], v[76:77], v[60:61]
    v_pk_mul_f32 v[78:79], v[78:79], v[62:63]
    v_exp_f32 v72, v72
    v_exp_f32 v73, v73
    v_exp_f32 v74, v74
    v_exp_f32 v75, v75
    v_exp_f32 v76, v76
    v_exp_f32 v77, v77
    v_exp_f32 v78, v78
    v_exp_f32 v79, v79
    v_pk_add_f32 v[72:73], v[72:73], 1.0 op_sel_hi:[1,0]
    v_pk_add_f32 v[74:75], v[74:75], 1.0 op_sel_hi:[1,0]
    v_pk_add_f32 v[76:77], v[76:77], 1.0 op_sel_hi:[1,0]
    v_pk_add_f32 v[78:79], v[78:79], 1.0 op_sel_hi:[1,0]
    v_rcp_f32 v72, v72
    v_rcp_f32 v73, v73
    v_rcp_f32 v74, v74
    v_rcp_f32 v75, v75
    v_rcp_f32 v76, v76
    v_rcp_f32 v77, v77
    v_rcp_f32 v78, v78
    v_rcp_f32 v79, v79
    v_pk_mul_f32 v[48:49], v[48:49], v[72:73]
    v_pk_mul_f32 v[50:51], v[50:51], v[74:75]
    v_pk_mul_f32 v[60:61], v[60:61], v[76:77]
    v_pk_mul_f32 v[62:63], v[62:63], v[78:79]
    v_cvt_pk_bf16_f32 v112, v48, v49
    v_cvt_pk_bf16_f32 v113, v50, v51
    v_cvt_pk_bf16_f32 v114, v60, v61
    v_cvt_pk_bf16_f32 v115, v62, v63
    buffer_store_dwordx4 v[112:115], v8, s[28:31], s51 offen offset:0 sc1
    v_pk_mul_f32 v[72:73], v[52:53], v[52:53]
    v_pk_mul_f32 v[74:75], v[54:55], v[54:55]
    v_pk_mul_f32 v[76:77], v[64:65], v[64:65]
    v_pk_mul_f32 v[78:79], v[66:67], v[66:67]
    v_pk_fma_f32 v[72:73], v[72:73], v[128:129], s[44:45]
    v_pk_fma_f32 v[74:75], v[74:75], v[128:129], s[44:45]
    v_pk_fma_f32 v[76:77], v[76:77], v[128:129], s[44:45]
    v_pk_fma_f32 v[78:79], v[78:79], v[128:129], s[44:45]
    v_pk_mul_f32 v[72:73], v[72:73], v[52:53]
    v_pk_mul_f32 v[74:75], v[74:75], v[54:55]
    v_pk_mul_f32 v[76:77], v[76:77], v[64:65]
    v_pk_mul_f32 v[78:79], v[78:79], v[66:67]
    v_exp_f32 v72, v72
    v_exp_f32 v73, v73
    v_exp_f32 v74, v74
    v_exp_f32 v75, v75
    v_exp_f32 v76, v76
    v_exp_f32 v77, v77
    v_exp_f32 v78, v78
    v_exp_f32 v79, v79
    v_pk_add_f32 v[72:73], v[72:73], 1.0 op_sel_hi:[1,0]
    v_pk_add_f32 v[74:75], v[74:75], 1.0 op_sel_hi:[1,0]
    v_pk_add_f32 v[76:77], v[76:77], 1.0 op_sel_hi:[1,0]
    v_pk_add_f32 v[78:79], v[78:79], 1.0 op_sel_hi:[1,0]
    v_rcp_f32 v72, v72
    v_rcp_f32 v73, v73
    v_rcp_f32 v74, v74
    v_rcp_f32 v75, v75
    v_rcp_f32 v76, v76
    v_rcp_f32 v77, v77
    v_rcp_f32 v78, v78
    v_rcp_f32 v79, v79
    v_pk_mul_f32 v[52:53], v[52:53], v[72:73]
    v_pk_mul_f32 v[54:55], v[54:55], v[74:75]
    v_pk_mul_f32 v[64:65], v[64:65], v[76:77]
    v_pk_mul_f32 v[66:67], v[66:67], v[78:79]
    v_cvt_pk_bf16_f32 v116, v52, v53
    v_cvt_pk_bf16_f32 v117, v54, v55
    v_cvt_pk_bf16_f32 v118, v64, v65
    v_cvt_pk_bf16_f32 v119, v66, v67
    buffer_store_dwordx4 v[116:119], v8, s[28:31], s51 offen offset:1024 sc1
    v_pk_mul_f32 v[72:73], v[56:57], v[56:57]
    v_pk_mul_f32 v[74:75], v[58:59], v[58:59]
    v_pk_mul_f32 v[76:77], v[68:69], v[68:69]
    v_pk_mul_f32 v[78:79], v[70:71], v[70:71]
    v_pk_fma_f32 v[72:73], v[72:73], v[128:129], s[44:45]
    v_pk_fma_f32 v[74:75], v[74:75], v[128:129], s[44:45]
    v_pk_fma_f32 v[76:77], v[76:77], v[128:129], s[44:45]
    v_pk_fma_f32 v[78:79], v[78:79], v[128:129], s[44:45]
    v_pk_mul_f32 v[72:73], v[72:73], v[56:57]
    v_pk_mul_f32 v[74:75], v[74:75], v[58:59]
    v_pk_mul_f32 v[76:77], v[76:77], v[68:69]
    v_pk_mul_f32 v[78:79], v[78:79], v[70:71]
    v_exp_f32 v72, v72
    v_exp_f32 v73, v73
    v_exp_f32 v74, v74
    v_exp_f32 v75, v75
    v_exp_f32 v76, v76
    v_exp_f32 v77, v77
    v_exp_f32 v78, v78
    v_exp_f32 v79, v79
    v_pk_add_f32 v[72:73], v[72:73], 1.0 op_sel_hi:[1,0]
    v_pk_add_f32 v[74:75], v[74:75], 1.0 op_sel_hi:[1,0]
    v_pk_add_f32 v[76:77], v[76:77], 1.0 op_sel_hi:[1,0]
    v_pk_add_f32 v[78:79], v[78:79], 1.0 op_sel_hi:[1,0]
    v_rcp_f32 v72, v72
    v_rcp_f32 v73, v73
    v_rcp_f32 v74, v74
    v_rcp_f32 v75, v75
    v_rcp_f32 v76, v76
    v_rcp_f32 v77, v77
    v_rcp_f32 v78, v78
    v_rcp_f32 v79, v79
    v_pk_mul_f32 v[56:57], v[56:57], v[72:73]
    v_pk_mul_f32 v[58:59], v[58:59], v[74:75]
    v_pk_mul_f32 v[68:69], v[68:69], v[76:77]
    v_pk_mul_f32 v[70:71], v[70:71], v[78:79]
    v_cvt_pk_bf16_f32 v120, v56, v57
    v_cvt_pk_bf16_f32 v121, v58, v59
    v_cvt_pk_bf16_f32 v122, v68, v69
    v_cvt_pk_bf16_f32 v123, v70, v71
    buffer_store_dwordx4 v[120:123], v8, s[28:31], s51 offen offset:2048 sc1
    s_branch g3_done
g3_pf:
    s_load_dwordx2 s[4:5], s[0:1], 56
    s_sub_u32 s11, s2, 216
    s_waitcnt vmcnt(0) lgkmcnt(0)
    s_barrier
    s_cmp_lg_u32 s13, 0
    s_cbranch_scc1 arr_29
    s_and_b32 s16, s2, 63
    s_lshl_b32 s16, s16, 7
    s_add_u32 s16, s16, 16384
    v_mov_b32 v5, 1
    v_mov_b32 v6, 0
    s_mov_b64 exec, 1
    buffer_atomic_add v5, v6, s[96:99], s16 offen sc1
    s_mov_b64 exec, -1
arr_29:
    s_and_b32 s14, s2, 7
    s_lshr_b32 s15, s11, 3
    v_lshrrev_b32 v2, 1, v0
    v_and_b32 v3, 1, v0
    v_lshlrev_b32 v3, 7, v3
    s_load_dwordx2 s[6:7], s[0:1], 40
    s_mul_i32 s16, s14, 27
    s_add_u32 s17, s16, 26
    s_mul_i32 s16, s16, 171
    s_lshr_b32 s16, s16, 10
    s_mul_i32 s17, s17, 171
    s_lshr_b32 s17, s17, 10
    s_add_u32 s16, s16, 2
    s_andn2_b32 s16, s16, 3
    s_add_u32 s16, s16, 1
    s_add_u32 s18, s16, 4
    s_cmp_le_u32 s18, s17
    s_cselect_b32 s19, 1024, 0x40000000
    s_lshl_b32 s16, s16, 8
    s_mul_i32 s17, s15, 2359296
    s_add_u32 s16, s16, s17
    s_add_u32 s16, s16, 2949120
    s_add_u32 s19, s19, s16
    s_movk_i32 s17, 9216
    v_mul_lo_u32 v4, v2, s17
    v_add_u32 v4, v4, v3
    s_waitcnt lgkmcnt(0)
    s_mov_b32 s24, s6
    s_and_b32 s25, s7, 0xffff
    s_mov_b32 s26, 0x1200000
    s_mov_b32 s27, 0x00020000
    buffer_load_dword v240, v4, s[24:27], s16 offen
    buffer_load_dword v241, v4, s[24:27], s19 offen
    s_add_u32 s16, s16, 11796480
    s_add_u32 s19, s19, 11796480
    buffer_load_dword v242, v4, s[24:27], s16 offen
    buffer_load_dword v243, v4, s[24:27], s19 offen
    s_add_u32 s16, s16, 11796480
    s_add_u32 s19, s19, 11796480
    s_mov_b32 s20, s4
    s_and_b32 s21, s5, 0xffff
    s_mov_b32 s22, 0x1200000
    s_mov_b32 s23, 0x00020000
    v_lshlrev_b32 v1, 7, v0
    s_add_u32 s10, s11, 0
    s_and_b32 s12, s10, 3
    s_mul_i32 s12, s12, 4718592
    s_lshr_b32 s10, s10, 2
    s_lshl_b32 s16, s10, 16
    s_add_u32 s12, s12, s16
    s_cmp_lt_u32 s10, 72
    s_cselect_b32 s12, s12, 0x40000000
    buffer_load_dword v244, v1, s[20:23], s12 offen
    s_add_u32 s10, s11, 40
    s_and_b32 s12, s10, 3
    s_mul_i32 s12, s12, 4718592
    s_lshr_b32 s10, s10, 2
    s_lshl_b32 s16, s10, 16
    s_add_u32 s12, s12, s16
    s_cmp_lt_u32 s10, 72
    s_cselect_b32 s12, s12, 0x40000000
    buffer_load_dword v245, v1, s[20:23], s12 offen
    s_add_u32 s10, s11, 80
    s_and_b32 s12, s10, 3
    s_mul_i32 s12, s12, 4718592
    s_lshr_b32 s10, s10, 2
    s_lshl_b32 s16, s10, 16
    s_add_u32 s12, s12, s16
    s_cmp_lt_u32 s10, 72
    s_cselect_b32 s12, s12, 0x40000000
    buffer_load_dword v246, v1, s[20:23], s12 offen
    s_add_u32 s10, s11, 120
    s_and_b32 s12, s10, 3
    s_mul_i32 s12, s12, 4718592
    s_lshr_b32 s10, s10, 2
    s_lshl_b32 s16, s10, 16
    s_add_u32 s12, s12, s16
    s_cmp_lt_u32 s10, 72
    s_cselect_b32 s12, s12, 0x40000000
    buffer_load_dword v247, v1, s[20:23], s12 offen
    s_add_u32 s10, s11, 160
    s_and_b32 s12, s10, 3
    s_mul_i32 s12, s12, 4718592
    s_lshr_b32 s10, s10, 2
    s_lshl_b32 s16, s10, 16
    s_add_u32 s12, s12, s16
    s_cmp_lt_u32 s10, 72
    s_cselect_b32 s12, s12, 0x40000000
    buffer_load_dword v248, v1, s[20:23], s12 offen
    s_add_u32 s10, s11, 200
    s_and_b32 s12, s10, 3
    s_mul_i32 s12, s12, 4718592
    s_lshr_b32 s10, s10, 2
    s_lshl_b32 s16, s10, 16
    s_add_u32 s12, s12, s16
    s_cmp_lt_u32 s10, 72
    s_cselect_b32 s12, s12, 0x40000000
    buffer_load_dword v249, v1, s[20:23], s12 offen
    s_waitcnt vmcnt(9)
    s_add_u32 s10, s11, 240
    s_and_b32 s12, s10, 3
    s_mul_i32 s12, s12, 4718592
    s_lshr_b32 s10, s10, 2
    s_lshl_b32 s16, s10, 16
    s_add_u32 s12, s12, s16
    s_cmp_lt_u32 s10, 72
    s_cselect_b32 s12, s12, 0x40000000
    buffer_load_dword v250, v1, s[20:23], s12 offen
    s_waitcnt vmcnt(9)
    s_branch g3_after
g3_end:
g3_done:
    s_waitcnt vmcnt(0) lgkmcnt(0)
    s_barrier
    s_cmp_lg_u32 s13, 0
    s_cbranch_scc1 arr_30
    s_and_b32 s16, s2, 63
    s_lshl_b32 s16, s16, 7
    s_add_u32 s16, s16, 16384
    v_mov_b32 v5, 1
    v_mov_b32 v6, 0
    s_mov_b64 exec, 1
    buffer_atomic_add v5, v6, s[96:99], s16 offen sc1
    s_mov_b64 exec, -1
arr_30:
g3_after:
    s_load_dwordx4 s[4:7], s[0:1], 56
    s_load_dwordx2 s[8:9], s[0:1], 88
    s_load_dwordx2 s[44:45], s[0:1], 72
    v_lshrrev_b32 v1, 6, v0
    s_and_b32 s16, s2, 7
    s_lshr_b32 s17, s2, 3
    v_readfirstlane_b32 s13, v1
    s_lshr_b32 s10, s16, 1
    s_and_b32 s16, s16, 1
    s_lshl_b32 s16, s16, 3
    s_lshr_b32 s18, s17, 2
    s_add_u32 s11, s16, s18
    s_and_b32 s12, s17, 3
    s_lshl_b32 s46, s11, 2
    s_add_u32 s46, s46, s12
    v_and_b32 v1, 63, v0
    v_lshrrev_b32 v2, 4, v1
    v_lshlrev_b32 v8, 4, v1
    s_and_b32 s14, s13, 3
    s_cmp_lt_u32 s13, 4
    s_cbranch_scc1 g4_cons
    s_lshl_b32 s16, s14, 4
    v_and_b32 v6, 15, v1
    v_add_u32 v7, s16, v2
    v_lshlrev_b32 v7, 12, v7
    v_add_u32 v5, 0, v2
    v_lshlrev_b32 v5, 1, v5
    v_xor_b32 v5, v5, v6
    v_lshl_add_u32 v68, v5, 4, v7
    v_add_u32 v70, 30720, v68
    v_add_u32 v5, 4, v2
    v_lshlrev_b32 v5, 1, v5
    v_xor_b32 v5, v5, v6
    v_lshl_add_u32 v69, v5, 4, v7
    v_add_u32 v69, 15360, v69
    v_add_u32 v71, 30720, v69
    s_lshl_b32 s16, s14, 2
    s_add_u32 s16, s16, 0
    s_cmp_ge_u32 s16, 9
    s_cselect_b32 s17, 27648, 0
    s_lshl_b32 s16, s14, 12
    s_add_u32 s16, s16, s17
    v_add_u32 v72, s16, v8
    s_lshl_b32 s16, s14, 2
    s_add_u32 s16, s16, 1
    s_cmp_ge_u32 s16, 9
    s_cselect_b32 s17, 27648, 0
    s_lshl_b32 s16, s14, 12
    s_add_u32 s16, s16, s17
    v_add_u32 v73, s16, v8
    s_lshl_b32 s16, s14, 2
    s_add_u32 s16, s16, 2
    s_cmp_ge_u32 s16, 9
    s_cselect_b32 s17, 27648, 0
    s_lshl_b32 s16, s14, 12
    s_add_u32 s16, s16, s17
    v_add_u32 v74, s16, v8
    s_lshl_b32 s16, s14, 2
    s_add_u32 s16, s16, 3
    s_cmp_ge_u32 s16, 9
    s_cselect_b32 s17, 27648, 0
    s_lshl_b32 s16, s14, 12
    s_add_u32 s16, s16, s17
    v_add_u32 v75, s16, v8
    s_lshl_b32 s16, s14, 10
    s_add_u32 s16, s16, 44032
    s_cmp_ge_u32 s14, 2
    s_cselect_b32 s16, 0x40000000, s16
    v_add_u32 v76, s16, v8
    s_mul_i32 s36, s10, 4718592
    s_lshl_b32 s16, s11, 8
    s_add_u32 s36, s36, s16
    s_mul_i32 s37, s10, 1327104
    s_mul_i32 s16, s12, 9216
    s_add_u32 s37, s37, s16
    s_lshl_b32 s38, s14, 12
    s_add_u32 s39, s38, 16384
    s_lshl_b32 s47, s14, 10
    s_add_u32 s47, s47, 32768
    s_waitcnt lgkmcnt(0)
    s_mov_b32 s20, s4
    s_and_b32 s21, s5, 0xffff
    s_mov_b32 s22, 0x1200000
    s_mov_b32 s23, 0x00020000
    s_add_u32 s24, s8, 0x280000
    s_addc_u32 s25, s9, 0
    s_and_b32 s25, s25, 0xffff
    s_mov_b32 s26, 0x510000
    s_mov_b32 s27, 0x00020000
    s_mov_b32 s40, 0
    s_mov_b32 s43, 36864
    s_mov_b32 m0, s38
    s_nop 0
    buffer_load_dwordx4 v68, s[20:23], s36 offen offset:0 lds
    buffer_load_dwordx4 v69, s[20:23], s36 offen offset:1024 lds
    buffer_load_dwordx4 v70, s[20:23], s36 offen offset:2048 lds
    buffer_load_dwordx4 v71, s[20:23], s36 offen offset:3072 lds
    s_add_u32 s36, s36, 262144
    s_add_u32 s38, s38, 0x9000
    s_mov_b32 m0, s38
    s_nop 0
    buffer_load_dwordx4 v68, s[20:23], s36 offen offset:0 lds
    buffer_load_dwordx4 v69, s[20:23], s36 offen offset:1024 lds
    buffer_load_dwordx4 v70, s[20:23], s36 offen offset:2048 lds
    buffer_load_dwordx4 v71, s[20:23], s36 offen offset:3072 lds
    s_add_u32 s36, s36, 262144
    s_add_u32 s38, s38, 0x9000
    s_mov_b32 m0, s38
    s_nop 0
    buffer_load_dwordx4 v68, s[20:23], s36 offen offset:0 lds
    buffer_load_dwordx4 v69, s[20:23], s36 offen offset:1024 lds
    buffer_load_dwordx4 v70, s[20:23], s36 offen offset:2048 lds
    buffer_load_dwordx4 v71, s[20:23], s36 offen offset:3072 lds
    s_add_u32 s36, s36, 262144
    s_add_u32 s38, s38, 0x9000
    s_mov_b32 m0, s38
    s_nop 0
    buffer_load_dwordx4 v68, s[20:23], s36 offen offset:0 lds
    buffer_load_dwordx4 v69, s[20:23], s36 offen offset:1024 lds
    buffer_load_dwordx4 v70, s[20:23], s36 offen offset:2048 lds
    buffer_load_dwordx4 v71, s[20:23], s36 offen offset:3072 lds
    s_add_u32 s36, s36, 262144
    s_add_u32 s38, s38, 0xfffe5000
    s_cmp_lg_u32 s13, 4
    s_cbranch_scc1 g4_np_31
    v_and_b32 v6, 63, v0
    v_lshlrev_b32 v6, 7, v6
    s_mov_b32 s16, 16384
    s_mov_b32 s18, 0
poll_32:
    buffer_load_dword v5, v6, s[96:99], s16 offen sc1
    s_add_u32 s18, s18, 1
    s_cmp_gt_u32 s18, 0x80000
    s_cbranch_scc1 pollx_33
    s_waitcnt vmcnt(0)
    v_cmp_gt_u32 vcc, 4, v5
    s_cbranch_vccnz poll_32
pollx_33:
    s_waitcnt vmcnt(0)
g4_np_31:
    s_barrier
    s_mov_b32 m0, s39
    s_nop 0
    buffer_load_dwordx4 v72, s[24:27], s37 offen offset:0 sc1 lds
    buffer_load_dwordx4 v73, s[24:27], s37 offen offset:1024 sc1 lds
    buffer_load_dwordx4 v74, s[24:27], s37 offen offset:2048 sc1 lds
    buffer_load_dwordx4 v75, s[24:27], s37 offen offset:3072 sc1 lds
    s_mov_b32 m0, s47
    s_nop 0
    buffer_load_dwordx4 v76, s[24:27], s37 offen sc1 lds
    s_add_u32 s37, s37, 73728
    s_add_u32 s39, s39, 0x9000
    s_add_u32 s47, s47, 0x9000
    s_mov_b32 m0, s39
    s_nop 0
    buffer_load_dwordx4 v72, s[24:27], s37 offen offset:0 sc1 lds
    buffer_load_dwordx4 v73, s[24:27], s37 offen offset:1024 sc1 lds
    buffer_load_dwordx4 v74, s[24:27], s37 offen offset:2048 sc1 lds
    buffer_load_dwordx4 v75, s[24:27], s37 offen offset:3072 sc1 lds
    s_mov_b32 m0, s47
    s_nop 0
    buffer_load_dwordx4 v76, s[24:27], s37 offen sc1 lds
    s_add_u32 s37, s37, 73728
    s_add_u32 s39, s39, 0x9000
    s_add_u32 s47, s47, 0x9000
    s_mov_b32 m0, s39
    s_nop 0
    buffer_load_dwordx4 v72, s[24:27], s37 offen offset:0 sc1 lds
    buffer_load_dwordx4 v73, s[24:27], s37 offen offset:1024 sc1 lds
    buffer_load_dwordx4 v74, s[24:27], s37 offen offset:2048 sc1 lds
    buffer_load_dwordx4 v75, s[24:27], s37 offen offset:3072 sc1 lds
    s_mov_b32 m0, s47
    s_nop 0
    buffer_load_dwordx4 v76, s[24:27], s37 offen sc1 lds
    s_add_u32 s37, s37, 73728
    s_add_u32 s39, s39, 0x9000
    s_add_u32 s47, s47, 0x9000
    s_mov_b32 m0, s39
    s_nop 0
    buffer_load_dwordx4 v72, s[24:27], s37 offen offset:0 sc1 lds
    buffer_load_dwordx4 v73, s[24:27], s37 offen offset:1024 sc1 lds
    buffer_load_dwordx4 v74, s[24:27], s37 offen offset:2048 sc1 lds
    buffer_load_dwordx4 v75, s[24:27], s37 offen offset:3072 sc1 lds
    s_mov_b32 m0, s47
    s_nop 0
    buffer_load_dwordx4 v76, s[24:27], s37 offen sc1 lds
    s_add_u32 s37, s37, 73728
    s_add_u32 s39, s39, 0xfffe5000
    s_add_u32 s47, s47, 0xfffe5000
    s_add_u32 s28, s8, 0x800000
    s_addc_u32 s29, s9, 0
    s_and_b32 s29, s29, 0xffff
    s_mov_b32 s30, 0x240000
    s_mov_b32 s31, 0x00020000
    s_mov_b32 s32, s6
    s_and_b32 s33, s7, 0xffff
    s_mov_b32 s34, 0x1000
    s_mov_b32 s35, 0x00020000
    s_add_u32 s48, s8, 0x1100000
    s_addc_u32 s49, s9, 0
    s_and_b32 s49, s49, 0xffff
    s_mov_b32 s50, 0x900000
    s_mov_b32 s51, 0x00020000
    s_add_u32 s52, s8, 0x10c0000
    s_addc_u32 s53, s9, 0
    s_and_b32 s53, s53, 0xffff
    s_mov_b32 s54, 0x8000
    s_mov_b32 s55, 0x00020000
    s_mov_b32 s56, s44
    s_and_b32 s57, s45, 0xffff
    s_mov_b32 s58, 0x240000
    s_mov_b32 s59, 0x00020000
    s_lshl_b32 s16, s11, 7
    s_lshl_b32 s17, s10, 5
    s_add_u32 s16, s16, s17
    s_mul_i32 s17, s16, 1152
    s_mul_i32 s18, s12, 288
    s_add_u32 s17, s17, s18
    s_lshl_b32 s16, s16, 1
    s_movk_i32 s18, 3641
    v_add_u32 v5, 0, v0
    v_mul_lo_u32 v6, v5, s18
    v_lshrrev_b32 v6, 16, v6
    v_mul_u32_u24 v7, 18, v6
    v_sub_u32 v7, v5, v7
    v_mul_u32_u24 v24, 592, v6
    v_lshl_add_u32 v24, v7, 5, v24
    v_mul_u32_u24 v22, 1152, v6
    v_lshl_add_u32 v22, v7, 4, v22
    v_add_u32 v22, s17, v22
    buffer_load_dwordx4 v[12:15], v22, s[28:31], 0 offen sc1
    v_lshlrev_b32 v6, 1, v6
    buffer_load_ushort v20, v6, s[32:35], s16 offen
    v_add_u32 v5, 512, v0
    v_mul_lo_u32 v6, v5, s18
    v_lshrrev_b32 v6, 16, v6
    v_mul_u32_u24 v7, 18, v6
    v_sub_u32 v7, v5, v7
    v_mul_u32_u24 v25, 592, v6
    v_lshl_add_u32 v25, v7, 5, v25
    v_mul_u32_u24 v23, 1152, v6
    v_lshl_add_u32 v23, v7, 4, v23
    v_add_u32 v23, s17, v23
    v_cmp_gt_u32 vcc, 576, v5
    v_mov_b32 v7, 0x40000000
    s_nop 0
    v_cndmask_b32 v23, v7, v23, vcc
    v_cndmask_b32 v25, 0, v25, vcc
    buffer_load_dwordx4 v[16:19], v23, s[28:31], 0 offen sc1
    v_lshlrev_b32 v6, 1, v6
    buffer_load_ushort v21, v6, s[32:35], s16 offen
    s_waitcnt vmcnt(19)
    s_barrier
    s_waitcnt vmcnt(14)
    s_barrier
    s_mov_b32 m0, s38
    s_nop 0
    buffer_load_dwordx4 v68, s[20:23], s36 offen offset:0 lds
    buffer_load_dwordx4 v69, s[20:23], s36 offen offset:1024 lds
    buffer_load_dwordx4 v70, s[20:23], s36 offen offset:2048 lds
    buffer_load_dwordx4 v71, s[20:23], s36 offen offset:3072 lds
    s_add_u32 s36, s36, 262144
    s_mov_b32 m0, s39
    s_nop 0
    buffer_load_dwordx4 v72, s[24:27], s37 offen offset:0 sc1 lds
    buffer_load_dwordx4 v73, s[24:27], s37 offen offset:1024 sc1 lds
    buffer_load_dwordx4 v74, s[24:27], s37 offen offset:2048 sc1 lds
    buffer_load_dwordx4 v75, s[24:27], s37 offen offset:3072 sc1 lds
    s_mov_b32 m0, s47
    s_nop 0
    buffer_load_dwordx4 v76, s[24:27], s37 offen sc1 lds
    s_add_u32 s37, s37, 73728
    s_add_u32 s38, s38, 36864
    s_add_u32 s39, s39, 36864
    s_add_u32 s47, s47, 36864
    s_waitcnt vmcnt(18)
    s_barrier
    s_mov_b32 m0, s38
    s_nop 0
    buffer_load_dwordx4 v68, s[20:23], s36 offen offset:0 lds
    buffer_load_dwordx4 v69, s[20:23], s36 offen offset:1024 lds
    buffer_load_dwordx4 v70, s[20:23], s36 offen offset:2048 lds
    buffer_load_dwordx4 v71, s[20:23], s36 offen offset:3072 lds
    s_add_u32 s36, s36, 262144
    s_mov_b32 m0, s39
    s_nop 0
    buffer_load_dwordx4 v72, s[24:27], s37 offen offset:0 sc1 lds
    buffer_load_dwordx4 v73, s[24:27], s37 offen offset:1024 sc1 lds
    buffer_load_dwordx4 v74, s[24:27], s37 offen offset:2048 sc1 lds
    buffer_load_dwordx4 v75, s[24:27], s37 offen offset:3072 sc1 lds
    s_mov_b32 m0, s47
    s_nop 0
    buffer_load_dwordx4 v76, s[24:27], s37 offen sc1 lds
    s_add_u32 s37, s37, 73728
    s_add_u32 s38, s38, 36864
    s_add_u32 s39, s39, 36864
    s_add_u32 s47, s47, 36864
    s_waitcnt vmcnt(22)
    s_barrier
    s_mov_b32 m0, s38
    s_nop 0
    buffer_load_dwordx4 v68, s[20:23], s36 offen offset:0 lds
    buffer_load_dwordx4 v69, s[20:23], s36 offen offset:1024 lds
    buffer_load_dwordx4 v70, s[20:23], s36 offen offset:2048 lds
    buffer_load_dwordx4 v71, s[20:23], s36 offen offset:3072 lds
    s_add_u32 s36, s36, 262144
    s_mov_b32 m0, s39
    s_nop 0
    buffer_load_dwordx4 v72, s[24:27], s37 offen offset:0 sc1 lds
    buffer_load_dwordx4 v73, s[24:27], s37 offen offset:1024 sc1 lds
    buffer_load_dwordx4 v74, s[24:27], s37 offen offset:2048 sc1 lds
    buffer_load_dwordx4 v75, s[24:27], s37 offen offset:3072 sc1 lds
    s_mov_b32 m0, s47
    s_nop 0
    buffer_load_dwordx4 v76, s[24:27], s37 offen sc1 lds
    s_add_u32 s37, s37, 73728
    s_add_u32 s38, s38, 36864
    s_add_u32 s39, s39, 36864
    s_add_u32 s47, s47, 36864
    s_mov_b32 s40, 3
    s_mov_b32 s41, 3
g4_ploop:
    s_add_u32 s40, s40, 1
    s_cmp_eq_u32 s40, 4
    s_cselect_b32 s42, 0xfffe5000, s43
    s_cselect_b32 s40, 0, s40
    s_waitcnt vmcnt(18)
    s_barrier
    s_mov_b32 m0, s38
    s_nop 0
    buffer_load_dwordx4 v68, s[20:23], s36 offen offset:0 lds
    buffer_load_dwordx4 v69, s[20:23], s36 offen offset:1024 lds
    buffer_load_dwordx4 v70, s[20:23], s36 offen offset:2048 lds
    buffer_load_dwordx4 v71, s[20:23], s36 offen offset:3072 lds
    s_add_u32 s36, s36, 262144
    s_mov_b32 m0, s39
    s_nop 0
    buffer_load_dwordx4 v72, s[24:27], s37 offen offset:0 sc1 lds
    buffer_load_dwordx4 v73, s[24:27], s37 offen offset:1024 sc1 lds
    buffer_load_dwordx4 v74, s[24:27], s37 offen offset:2048 sc1 lds
    buffer_load_dwordx4 v75, s[24:27], s37 offen offset:3072 sc1 lds
    s_mov_b32 m0, s47
    s_nop 0
    buffer_load_dwordx4 v76, s[24:27], s37 offen sc1 lds
    s_add_u32 s37, s37, 73728
    s_add_u32 s38, s38, s42
    s_add_u32 s39, s39, s42
    s_add_u32 s47, s47, s42
    s_add_u32 s41, s41, 1
    s_cmp_lt_u32 s41, 14
    s_cbranch_scc1 g4_ploop
    s_waitcnt vmcnt(18)
    s_barrier
    s_waitcnt vmcnt(9)
    s_barrier
    s_waitcnt vmcnt(0)
    s_barrier
    s_barrier
    s_branch g4_join
g4_cons:
    v_bfe_u32 v3, v1, 2, 2
    v_and_b32 v4, 3, v1
    v_and_b32 v5, 1, v2
    v_lshl_add_u32 v5, v5, 2, v3
    v_lshl_add_u32 v6, v2, 2, v3
    v_lshlrev_b32 v6, 8, v6
    v_lshl_add_u32 v6, v4, 3, v6
    s_lshl_b32 s16, s13, 1
    s_add_u32 s17, s16, 0
    v_xor_b32 v7, s17, v5
    v_lshl_add_u32 v68, v7, 5, v6
    s_add_u32 s17, s16, 1
    v_xor_b32 v7, s17, v5
    v_lshl_add_u32 v69, v7, 5, v6
    v_add_u32 v70, 16384, v8
    v_mov_b32 v72, 0
    v_mov_b32 v73, 0
    v_mov_b32 v74, 0
    v_mov_b32 v75, 0
    v_mov_b32 v76, 0
    v_mov_b32 v77, 0
    v_mov_b32 v78, 0
    v_mov_b32 v79, 0
    v_mov_b32 v80, 0
    v_mov_b32 v81, 0
    v_mov_b32 v82, 0
    v_mov_b32 v83, 0
    v_mov_b32 v84, 0
    v_mov_b32 v85, 0
    v_mov_b32 v86, 0
    v_mov_b32 v87, 0
    v_mov_b32 v88, 0
    v_mov_b32 v89, 0
    v_mov_b32 v90, 0
    v_mov_b32 v91, 0
    v_mov_b32 v92, 0
    v_mov_b32 v93, 0
    v_mov_b32 v94, 0
    v_mov_b32 v95, 0
    v_mov_b32 v96, 0
    v_mov_b32 v97, 0
    v_mov_b32 v98, 0
    v_mov_b32 v99, 0
    v_mov_b32 v100, 0
    v_mov_b32 v101, 0
    v_mov_b32 v102, 0
    v_mov_b32 v103, 0
    v_mov_b32 v104, 0
    v_mov_b32 v105, 0
    v_mov_b32 v106, 0
    v_mov_b32 v107, 0
    v_mov_b32 v108, 0
    v_mov_b32 v109, 0
    v_mov_b32 v110, 0
    v_mov_b32 v111, 0
    v_mov_b32 v112, 0
    v_mov_b32 v113, 0
    v_mov_b32 v114, 0
    v_mov_b32 v115, 0
    v_mov_b32 v116, 0
    v_mov_b32 v117, 0
    v_mov_b32 v118, 0
    v_mov_b32 v119, 0
    v_mov_b32 v120, 0
    v_mov_b32 v121, 0
    v_mov_b32 v122, 0
    v_mov_b32 v123, 0
    v_mov_b32 v124, 0
    v_mov_b32 v125, 0
    v_mov_b32 v126, 0
    v_mov_b32 v127, 0
    v_mov_b32 v128, 0
    v_mov_b32 v129, 0
    v_mov_b32 v130, 0
    v_mov_b32 v131, 0
    v_mov_b32 v132, 0
    v_mov_b32 v133, 0
    v_mov_b32 v134, 0
    v_mov_b32 v135, 0
    v_mov_b32 v136, 0
    v_mov_b32 v137, 0
    v_mov_b32 v138, 0
    v_mov_b32 v139, 0
    v_mov_b32 v140, 0
    v_mov_b32 v141, 0
    v_mov_b32 v142, 0
    v_mov_b32 v143, 0
    s_waitcnt lgkmcnt(0)
    s_barrier
    s_add_u32 s28, s8, 0x800000
    s_addc_u32 s29, s9, 0
    s_and_b32 s29, s29, 0xffff
    s_mov_b32 s30, 0x240000
    s_mov_b32 s31, 0x00020000
    s_mov_b32 s32, s6
    s_and_b32 s33, s7, 0xffff
    s_mov_b32 s34, 0x1000
    s_mov_b32 s35, 0x00020000
    s_add_u32 s48, s8, 0x1100000
    s_addc_u32 s49, s9, 0
    s_and_b32 s49, s49, 0xffff
    s_mov_b32 s50, 0x900000
    s_mov_b32 s51, 0x00020000
    s_add_u32 s52, s8, 0x10c0000
    s_addc_u32 s53, s9, 0
    s_and_b32 s53, s53, 0xffff
    s_mov_b32 s54, 0x8000
    s_mov_b32 s55, 0x00020000
    s_mov_b32 s56, s44
    s_and_b32 s57, s45, 0xffff
    s_mov_b32 s58, 0x240000
    s_mov_b32 s59, 0x00020000
    s_lshl_b32 s16, s11, 7
    s_lshl_b32 s17, s10, 5
    s_add_u32 s16, s16, s17
    s_mul_i32 s17, s16, 1152
    s_mul_i32 s18, s12, 288
    s_add_u32 s17, s17, s18
    s_lshl_b32 s16, s16, 1
    s_movk_i32 s18, 3641
    v_add_u32 v5, 0, v0
    v_mul_lo_u32 v6, v5, s18
    v_lshrrev_b32 v6, 16, v6
    v_mul_u32_u24 v7, 18, v6
    v_sub_u32 v7, v5, v7
    v_mul_u32_u24 v24, 592, v6
    v_lshl_add_u32 v24, v7, 5, v24
    v_mul_u32_u24 v22, 1152, v6
    v_lshl_add_u32 v22, v7, 4, v22
    v_add_u32 v22, s17, v22
    buffer_load_dwordx4 v[12:15], v22, s[28:31], 0 offen sc1
    v_lshlrev_b32 v6, 1, v6
    buffer_load_ushort v20, v6, s[32:35], s16 offen
    v_add_u32 v5, 512, v0
    v_mul_lo_u32 v6, v5, s18
    v_lshrrev_b32 v6, 16, v6
    v_mul_u32_u24 v7, 18, v6
    v_sub_u32 v7, v5, v7
    v_mul_u32_u24 v25, 592, v6
    v_lshl_add_u32 v25, v7, 5, v25
    v_mul_u32_u24 v23, 1152, v6
    v_lshl_add_u32 v23, v7, 4, v23
    v_add_u32 v23, s17, v23
    v_cmp_gt_u32 vcc, 576, v5
    v_mov_b32 v7, 0x40000000
    s_nop 0
    v_cndmask_b32 v23, v7, v23, vcc
    v_cndmask_b32 v25, 0, v25, vcc
    buffer_load_dwordx4 v[16:19], v23, s[28:31], 0 offen sc1
    v_lshlrev_b32 v6, 1, v6
    buffer_load_ushort v21, v6, s[32:35], s16 offen
    s_setprio 2
    s_mov_b32 s40, 0
    s_mov_b32 s43, 36864
    s_mov_b32 s41, 0
    s_barrier
    ds_read_b128 v[152:155], v70 offset:0
    ds_read_b64_tr_b16 v[144:145], v68 offset:0
    ds_read_b64_tr_b16 v[146:147], v68 offset:4096
    ds_read_b64_tr_b16 v[148:149], v69 offset:0
    ds_read_b64_tr_b16 v[150:151], v69 offset:4096
    ds_read_b128 v[156:159], v70 offset:1024
    ds_read_b128 v[160:163], v70 offset:2048
    ds_read_b128 v[164:167], v70 offset:3072
    ds_read_b128 v[168:171], v70 offset:4096
    ds_read_b128 v[172:175], v70 offset:5120
    ds_read_b128 v[176:179], v70 offset:6144
    ds_read_b128 v[180:183], v70 offset:7168
    ds_read_b128 v[184:187], v70 offset:8192
g4_cloop:
    s_waitcnt lgkmcnt(0)
    v_mfma_f32_16x16x32_bf16 v[72:75], v[152:155], v[144:147], v[72:75]
    ds_read_b128 v[196:199], v70 offset:9216
    ds_read_b64_tr_b16 v[188:189], v68 offset:8192
    v_mfma_f32_16x16x32_bf16 v[76:79], v[152:155], v[148:151], v[76:79]
    ds_read_b64_tr_b16 v[190:191], v68 offset:12288
    ds_read_b64_tr_b16 v[192:193], v69 offset:8192
    v_mfma_f32_16x16x32_bf16 v[80:83], v[156:159], v[144:147], v[80:83]
    ds_read_b64_tr_b16 v[194:195], v69 offset:12288
    ds_read_b128 v[200:203], v70 offset:10240
    v_mfma_f32_16x16x32_bf16 v[84:87], v[156:159], v[148:151], v[84:87]
    ds_read_b128 v[204:207], v70 offset:11264
    ds_read_b128 v[208:211], v70 offset:12288
    v_mfma_f32_16x16x32_bf16 v[88:91], v[160:163], v[144:147], v[88:91]
    ds_read_b128 v[212:215], v70 offset:13312
    ds_read_b128 v[216:219], v70 offset:14336
    v_mfma_f32_16x16x32_bf16 v[92:95], v[160:163], v[148:151], v[92:95]
    ds_read_b128 v[220:223], v70 offset:15360
    ds_read_b128 v[224:227], v70 offset:16384
    v_mfma_f32_16x16x32_bf16 v[96:99], v[164:167], v[144:147], v[96:99]
    ds_read_b128 v[228:231], v70 offset:17408
    s_add_u32 s40, s40, 1
    v_mfma_f32_16x16x32_bf16 v[100:103], v[164:167], v[148:151], v[100:103]
    s_cmp_eq_u32 s40, 4
    s_cselect_b32 s42, 0xfffe5000, s43
    v_mfma_f32_16x16x32_bf16 v[104:107], v[168:171], v[144:147], v[104:107]
    s_cselect_b32 s40, 0, s40
    v_add_u32 v68, s42, v68
    v_mfma_f32_16x16x32_bf16 v[108:111], v[168:171], v[148:151], v[108:111]
    v_add_u32 v69, s42, v69
    v_add_u32 v70, s42, v70
    v_mfma_f32_16x16x32_bf16 v[112:115], v[172:175], v[144:147], v[112:115]
    s_add_u32 s41, s41, 1
    s_cmp_lt_u32 s41, 18
    v_mfma_f32_16x16x32_bf16 v[116:119], v[172:175], v[148:151], v[116:119]
    v_mfma_f32_16x16x32_bf16 v[120:123], v[176:179], v[144:147], v[120:123]
    v_mfma_f32_16x16x32_bf16 v[124:127], v[176:179], v[148:151], v[124:127]
    v_mfma_f32_16x16x32_bf16 v[128:131], v[180:183], v[144:147], v[128:131]
    v_mfma_f32_16x16x32_bf16 v[132:135], v[180:183], v[148:151], v[132:135]
    v_mfma_f32_16x16x32_bf16 v[136:139], v[184:187], v[144:147], v[136:139]
    v_mfma_f32_16x16x32_bf16 v[140:143], v[184:187], v[148:151], v[140:143]
    s_waitcnt lgkmcnt(0)
    v_mfma_f32_16x16x32_bf16 v[72:75], v[196:199], v[188:191], v[72:75]
    v_mfma_f32_16x16x32_bf16 v[76:79], v[196:199], v[192:195], v[76:79]
    v_mfma_f32_16x16x32_bf16 v[80:83], v[200:203], v[188:191], v[80:83]
    s_cbranch_scc0 g4_clast
    s_barrier
    v_mfma_f32_16x16x32_bf16 v[84:87], v[200:203], v[192:195], v[84:87]
    ds_read_b128 v[152:155], v70 offset:0
    ds_read_b64_tr_b16 v[144:145], v68 offset:0
    v_mfma_f32_16x16x32_bf16 v[88:91], v[204:207], v[188:191], v[88:91]
    ds_read_b64_tr_b16 v[146:147], v68 offset:4096
    ds_read_b64_tr_b16 v[148:149], v69 offset:0
    v_mfma_f32_16x16x32_bf16 v[92:95], v[204:207], v[192:195], v[92:95]
    ds_read_b64_tr_b16 v[150:151], v69 offset:4096
    ds_read_b128 v[156:159], v70 offset:1024
    v_mfma_f32_16x16x32_bf16 v[96:99], v[208:211], v[188:191], v[96:99]
    ds_read_b128 v[160:163], v70 offset:2048
    ds_read_b128 v[164:167], v70 offset:3072
    v_mfma_f32_16x16x32_bf16 v[100:103], v[208:211], v[192:195], v[100:103]
    ds_read_b128 v[168:171], v70 offset:4096
    ds_read_b128 v[172:175], v70 offset:5120
    v_mfma_f32_16x16x32_bf16 v[104:107], v[212:215], v[188:191], v[104:107]
    ds_read_b128 v[176:179], v70 offset:6144
    ds_read_b128 v[180:183], v70 offset:7168
    v_mfma_f32_16x16x32_bf16 v[108:111], v[212:215], v[192:195], v[108:111]
    ds_read_b128 v[184:187], v70 offset:8192
    v_mfma_f32_16x16x32_bf16 v[112:115], v[216:219], v[188:191], v[112:115]
    v_mfma_f32_16x16x32_bf16 v[116:119], v[216:219], v[192:195], v[116:119]
    v_mfma_f32_16x16x32_bf16 v[120:123], v[220:223], v[188:191], v[120:123]
    v_mfma_f32_16x16x32_bf16 v[124:127], v[220:223], v[192:195], v[124:127]
    v_mfma_f32_16x16x32_bf16 v[128:131], v[224:227], v[188:191], v[128:131]
    v_mfma_f32_16x16x32_bf16 v[132:135], v[224:227], v[192:195], v[132:135]
    v_mfma_f32_16x16x32_bf16 v[136:139], v[228:231], v[188:191], v[136:139]
    v_mfma_f32_16x16x32_bf16 v[140:143], v[228:231], v[192:195], v[140:143]
    s_branch g4_cloop
g4_clast:
    v_mfma_f32_16x16x32_bf16 v[84:87], v[200:203], v[192:195], v[84:87]
    v_mfma_f32_16x16x32_bf16 v[88:91], v[204:207], v[188:191], v[88:91]
    v_mfma_f32_16x16x32_bf16 v[92:95], v[204:207], v[192:195], v[92:95]
    v_mfma_f32_16x16x32_bf16 v[96:99], v[208:211], v[188:191], v[96:99]
    v_mfma_f32_16x16x32_bf16 v[100:103], v[208:211], v[192:195], v[100:103]
    v_mfma_f32_16x16x32_bf16 v[104:107], v[212:215], v[188:191], v[104:107]
    v_mfma_f32_16x16x32_bf16 v[108:111], v[212:215], v[192:195], v[108:111]
    v_mfma_f32_16x16x32_bf16 v[112:115], v[216:219], v[188:191], v[112:115]
    v_mfma_f32_16x16x32_bf16 v[116:119], v[216:219], v[192:195], v[116:119]
    v_mfma_f32_16x16x32_bf16 v[120:123], v[220:223], v[188:191], v[120:123]
    v_mfma_f32_16x16x32_bf16 v[124:127], v[220:223], v[192:195], v[124:127]
    v_mfma_f32_16x16x32_bf16 v[128:131], v[224:227], v[188:191], v[128:131]
    v_mfma_f32_16x16x32_bf16 v[132:135], v[224:227], v[192:195], v[132:135]
    v_mfma_f32_16x16x32_bf16 v[136:139], v[228:231], v[188:191], v[136:139]
    v_mfma_f32_16x16x32_bf16 v[140:143], v[228:231], v[192:195], v[140:143]
    s_setprio 0
    s_cmp_eq_u32 s13, s10
    s_cbranch_scc1 g4_own_34
    s_lshl_b32 s17, s46, 2
    s_add_u32 s17, s17, s13
    s_lshl_b32 s17, s17, 2
    s_add_u32 s17, s17, s10
    s_mul_i32 s17, s17, 9216
    s_add_u32 s18, s17, 4096
    s_add_u32 s19, s17, 8192
    v_cvt_pk_bf16_f32 v144, v72, v73
    v_cvt_pk_bf16_f32 v145, v74, v75
    v_cvt_pk_bf16_f32 v146, v76, v77
    v_cvt_pk_bf16_f32 v147, v78, v79
    buffer_store_dwordx4 v[144:147], v8, s[48:51], s17 offen offset:0 sc1
    v_cvt_pk_bf16_f32 v148, v80, v81
    v_cvt_pk_bf16_f32 v149, v82, v83
    v_cvt_pk_bf16_f32 v150, v84, v85
    v_cvt_pk_bf16_f32 v151, v86, v87
    buffer_store_dwordx4 v[148:151], v8, s[48:51], s17 offen offset:1024 sc1
    v_cvt_pk_bf16_f32 v152, v88, v89
    v_cvt_pk_bf16_f32 v153, v90, v91
    v_cvt_pk_bf16_f32 v154, v92, v93
    v_cvt_pk_bf16_f32 v155, v94, v95
    buffer_store_dwordx4 v[152:155], v8, s[48:51], s17 offen offset:2048 sc1
    v_cvt_pk_bf16_f32 v156, v96, v97
    v_cvt_pk_bf16_f32 v157, v98, v99
    v_cvt_pk_bf16_f32 v158, v100, v101
    v_cvt_pk_bf16_f32 v159, v102, v103
    buffer_store_dwordx4 v[156:159], v8, s[48:51], s17 offen offset:3072 sc1
    v_cvt_pk_bf16_f32 v160, v104, v105
    v_cvt_pk_bf16_f32 v161, v106, v107
    v_cvt_pk_bf16_f32 v162, v108, v109
    v_cvt_pk_bf16_f32 v163, v110, v111
    buffer_store_dwordx4 v[160:163], v8, s[48:51], s18 offen offset:0 sc1
    v_cvt_pk_bf16_f32 v164, v112, v113
    v_cvt_pk_bf16_f32 v165, v114, v115
    v_cvt_pk_bf16_f32 v166, v116, v117
    v_cvt_pk_bf16_f32 v167, v118, v119
    buffer_store_dwordx4 v[164:167], v8, s[48:51], s18 offen offset:1024 sc1
    v_cvt_pk_bf16_f32 v168, v120, v121
    v_cvt_pk_bf16_f32 v169, v122, v123
    v_cvt_pk_bf16_f32 v170, v124, v125
    v_cvt_pk_bf16_f32 v171, v126, v127
    buffer_store_dwordx4 v[168:171], v8, s[48:51], s18 offen offset:2048 sc1
    v_cvt_pk_bf16_f32 v172, v128, v129
    v_cvt_pk_bf16_f32 v173, v130, v131
    v_cvt_pk_bf16_f32 v174, v132, v133
    v_cvt_pk_bf16_f32 v175, v134, v135
    buffer_store_dwordx4 v[172:175], v8, s[48:51], s18 offen offset:3072 sc1
    v_cvt_pk_bf16_f32 v176, v136, v137
    v_cvt_pk_bf16_f32 v177, v138, v139
    v_cvt_pk_bf16_f32 v178, v140, v141
    v_cvt_pk_bf16_f32 v179, v142, v143
    buffer_store_dwordx4 v[176:179], v8, s[48:51], s19 offen offset:0 sc1
    s_barrier
    s_lshl_b32 s16, s46, 2
    s_add_u32 s16, s16, s13
    s_lshl_b32 s16, s16, 7
    s_lshl_b32 s17, s10, 2
    s_add_u32 s16, s16, s17
    v_mov_b32 v5, 1
    v_mov_b32 v7, 0
    s_waitcnt vmcnt(0)
    s_mov_b64 exec, 1
    buffer_store_dword v5, v7, s[52:55], s16 offen sc1
    s_mov_b64 exec, -1
    s_branch g4_qd_35
g4_own_34:
    s_barrier
    s_nop 7
    ds_write_b128 v8, v[72:75] offset:0
    ds_write_b128 v8, v[76:79] offset:1024
    ds_write_b128 v8, v[80:83] offset:2048
    ds_write_b128 v8, v[84:87] offset:3072
    ds_write_b128 v8, v[88:91] offset:4096
    ds_write_b128 v8, v[92:95] offset:5120
    ds_write_b128 v8, v[96:99] offset:6144
    ds_write_b128 v8, v[100:103] offset:7168
    ds_write_b128 v8, v[104:107] offset:8192
    ds_write_b128 v8, v[108:111] offset:9216
    ds_write_b128 v8, v[112:115] offset:10240
    ds_write_b128 v8, v[116:119] offset:11264
    ds_write_b128 v8, v[120:123] offset:12288
    ds_write_b128 v8, v[124:127] offset:13312
    ds_write_b128 v8, v[128:131] offset:14336
    ds_write_b128 v8, v[132:135] offset:15360
    ds_write_b128 v8, v[136:139] offset:16384
    ds_write_b128 v8, v[140:143] offset:17408
g4_qd_35:
g4_join:
    s_cmp_lg_u32 s13, 4
    s_cbranch_scc1 g4_np_36
    s_lshl_b32 s16, s46, 2
    s_add_u32 s16, s16, s10
    s_lshl_b32 s16, s16, 7
    v_and_b32 v6, 3, v1
    v_cmp_ne_u32 s[18:19], s10, v6
    v_lshlrev_b32 v6, 2, v6
    s_mov_b32 s17, 0
g4_poll_37:
    buffer_load_dword v5, v6, s[52:55], s16 offen sc1
    s_add_u32 s17, s17, 1
    s_cmp_gt_u32 s17, 0x100000
    s_cbranch_scc1 g4_pd_38
    s_waitcnt vmcnt(0)
    v_cmp_ne_u32 vcc, 1, v5
    s_nop 0
    s_and_b64 vcc, vcc, s[18:19]
    s_cbranch_vccnz g4_poll_37
g4_pd_38:
g4_np_36:
    s_lshl_b32 s17, s46, 2
    s_add_u32 s17, s17, s10
    s_mul_i32 s17, s17, 36864
    s_lshl_b32 s18, s13, 10
    s_add_u32 s17, s17, s18
    s_add_u32 s18, s10, 1
    s_and_b32 s18, s18, 3
    s_mul_i32 s18, s18, 9216
    s_add_u32 s86, s17, s18
    s_add_u32 s18, s10, 2
    s_and_b32 s18, s18, 3
    s_mul_i32 s18, s18, 9216
    s_add_u32 s87, s17, s18
    s_add_u32 s18, s10, 3
    s_and_b32 s18, s18, 3
    s_mul_i32 s18, s18, 9216
    s_add_u32 s88, s17, s18
    s_cmp_eq_u32 s13, 0
    s_cselect_b32 s18, 8192, 0x40000000
    v_add_u32 v3, s18, v8
    s_lshl_b32 s18, s13, 11
    v_add_u32 v4, s18, v8
    v_and_b32 v5, 15, v1
    v_mul_u32_u24 v5, 592, v5
    v_lshl_add_u32 v2, v2, 4, v5
    s_lshl_b32 s18, s13, 6
    v_add_u32 v2, s18, v2
    s_waitcnt lgkmcnt(0)
    s_barrier
    buffer_load_dwordx4 v[28:31], v8, s[48:51], s86 offen sc1
    buffer_load_dwordx4 v[32:35], v8, s[48:51], s87 offen sc1
    buffer_load_dwordx4 v[36:39], v8, s[48:51], s88 offen sc1
    buffer_load_dwordx4 v[40:43], v3, s[48:51], s86 offen sc1
    buffer_load_dwordx4 v[44:47], v3, s[48:51], s87 offen sc1
    buffer_load_dwordx4 v[48:51], v3, s[48:51], s88 offen sc1
    ds_read_b128 v[52:55], v4 offset:0
    ds_read_b128 v[56:59], v4 offset:1024
    ds_read_b128 v[60:63], v4 offset:16384
    ds_read_b128 v[64:67], v4 offset:17408
    s_waitcnt lgkmcnt(0)
    s_waitcnt vmcnt(3)
    v_lshlrev_b32 v5, 16, v28
    v_and_b32 v6, 0xffff0000, v28
    v_add_f32 v52, v52, v5
    v_add_f32 v53, v53, v6
    v_lshlrev_b32 v5, 16, v29
    v_and_b32 v6, 0xffff0000, v29
    v_add_f32 v54, v54, v5
    v_add_f32 v55, v55, v6
    v_lshlrev_b32 v5, 16, v30
    v_and_b32 v6, 0xffff0000, v30
    v_add_f32 v56, v56, v5
    v_add_f32 v57, v57, v6
    v_lshlrev_b32 v5, 16, v31
    v_and_b32 v6, 0xffff0000, v31
    v_add_f32 v58, v58, v5
    v_add_f32 v59, v59, v6
    v_lshlrev_b32 v5, 16, v32
    v_and_b32 v6, 0xffff0000, v32
    v_add_f32 v52, v52, v5
    v_add_f32 v53, v53, v6
    v_lshlrev_b32 v5, 16, v33
    v_and_b32 v6, 0xffff0000, v33
    v_add_f32 v54, v54, v5
    v_add_f32 v55, v55, v6
    v_lshlrev_b32 v5, 16, v34
    v_and_b32 v6, 0xffff0000, v34
    v_add_f32 v56, v56, v5
    v_add_f32 v57, v57, v6
    v_lshlrev_b32 v5, 16, v35
    v_and_b32 v6, 0xffff0000, v35
    v_add_f32 v58, v58, v5
    v_add_f32 v59, v59, v6
    v_lshlrev_b32 v5, 16, v36
    v_and_b32 v6, 0xffff0000, v36
    v_add_f32 v52, v52, v5
    v_add_f32 v53, v53, v6
    v_lshlrev_b32 v5, 16, v37
    v_and_b32 v6, 0xffff0000, v37
    v_add_f32 v54, v54, v5
    v_add_f32 v55, v55, v6
    v_lshlrev_b32 v5, 16, v38
    v_and_b32 v6, 0xffff0000, v38
    v_add_f32 v56, v56, v5
    v_add_f32 v57, v57, v6
    v_lshlrev_b32 v5, 16, v39
    v_and_b32 v6, 0xffff0000, v39
    v_add_f32 v58, v58, v5
    v_add_f32 v59, v59, v6
    ds_write_b128 v2, v[52:55] offset:20480
    ds_write_b128 v2, v[56:59] offset:29952
    s_cmp_lg_u32 s13, 0
    s_cbranch_scc1 g4_sk_39
    s_waitcnt vmcnt(0)
    v_lshlrev_b32 v5, 16, v40
    v_and_b32 v6, 0xffff0000, v40
    v_add_f32 v60, v60, v5
    v_add_f32 v61, v61, v6
    v_lshlrev_b32 v5, 16, v41
    v_and_b32 v6, 0xffff0000, v41
    v_add_f32 v62, v62, v5
    v_add_f32 v63, v63, v6
    v_lshlrev_b32 v5, 16, v42
    v_and_b32 v6, 0xffff0000, v42
    v_add_f32 v64, v64, v5
    v_add_f32 v65, v65, v6
    v_lshlrev_b32 v5, 16, v43
    v_and_b32 v6, 0xffff0000, v43
    v_add_f32 v66, v66, v5
    v_add_f32 v67, v67, v6
    v_lshlrev_b32 v5, 16, v44
    v_and_b32 v6, 0xffff0000, v44
    v_add_f32 v60, v60, v5
    v_add_f32 v61, v61, v6
    v_lshlrev_b32 v5, 16, v45
    v_and_b32 v6, 0xffff0000, v45
    v_add_f32 v62, v62, v5
    v_add_f32 v63, v63, v6
    v_lshlrev_b32 v5, 16, v46
    v_and_b32 v6, 0xffff0000, v46
    v_add_f32 v64, v64, v5
    v_add_f32 v65, v65, v6
    v_lshlrev_b32 v5, 16, v47
    v_and_b32 v6, 0xffff0000, v47
    v_add_f32 v66, v66, v5
    v_add_f32 v67, v67, v6
    v_lshlrev_b32 v5, 16, v48
    v_and_b32 v6, 0xffff0000, v48
    v_add_f32 v60, v60, v5
    v_add_f32 v61, v61, v6
    v_lshlrev_b32 v5, 16, v49
    v_and_b32 v6, 0xffff0000, v49
    v_add_f32 v62, v62, v5
    v_add_f32 v63, v63, v6
    v_lshlrev_b32 v5, 16, v50
    v_and_b32 v6, 0xffff0000, v50
    v_add_f32 v64, v64, v5
    v_add_f32 v65, v65, v6
    v_lshlrev_b32 v5, 16, v51
    v_and_b32 v6, 0xffff0000, v51
    v_add_f32 v66, v66, v5
    v_add_f32 v67, v67, v6
    ds_write_b128 v2, v[60:63] offset:20992
    ds_write_b128 v2, v[64:67] offset:30464
g4_sk_39:
    s_waitcnt vmcnt(0) lgkmcnt(0)
    s_barrier
    ds_read_b128 v[28:31], v24 offset:20480
    ds_read_b128 v[32:35], v24 offset:20496
    ds_read_b128 v[36:39], v25 offset:20480
    ds_read_b128 v[40:43], v25 offset:20496
    s_waitcnt lgkmcnt(2)
    v_lshlrev_b32 v20, 16, v20
    v_lshlrev_b32 v5, 16, v12
    v_and_b32 v6, 0xffff0000, v12
    v_add_f32 v5, v5, v20
    v_add_f32 v6, v6, v20
    v_add_f32 v5, v5, v28
    v_add_f32 v6, v6, v29
    v_cvt_pk_bf16_f32 v12, v5, v6
    v_lshlrev_b32 v5, 16, v13
    v_and_b32 v6, 0xffff0000, v13
    v_add_f32 v5, v5, v20
    v_add_f32 v6, v6, v20
    v_add_f32 v5, v5, v30
    v_add_f32 v6, v6, v31
    v_cvt_pk_bf16_f32 v13, v5, v6
    v_lshlrev_b32 v5, 16, v14
    v_and_b32 v6, 0xffff0000, v14
    v_add_f32 v5, v5, v20
    v_add_f32 v6, v6, v20
    v_add_f32 v5, v5, v32
    v_add_f32 v6, v6, v33
    v_cvt_pk_bf16_f32 v14, v5, v6
    v_lshlrev_b32 v5, 16, v15
    v_and_b32 v6, 0xffff0000, v15
    v_add_f32 v5, v5, v20
    v_add_f32 v6, v6, v20
    v_add_f32 v5, v5, v34
    v_add_f32 v6, v6, v35
    v_cvt_pk_bf16_f32 v15, v5, v6
    buffer_store_dwordx4 v[12:15], v22, s[56:59], 0 offen
    s_waitcnt lgkmcnt(0)
    v_lshlrev_b32 v21, 16, v21
    v_lshlrev_b32 v5, 16, v16
    v_and_b32 v6, 0xffff0000, v16
    v_add_f32 v5, v5, v21
    v_add_f32 v6, v6, v21
    v_add_f32 v5, v5, v36
    v_add_f32 v6, v6, v37
    v_cvt_pk_bf16_f32 v16, v5, v6
    v_lshlrev_b32 v5, 16, v17
    v_and_b32 v6, 0xffff0000, v17
    v_add_f32 v5, v5, v21
    v_add_f32 v6, v6, v21
    v_add_f32 v5, v5, v38
    v_add_f32 v6, v6, v39
    v_cvt_pk_bf16_f32 v17, v5, v6
    v_lshlrev_b32 v5, 16, v18
    v_and_b32 v6, 0xffff0000, v18
    v_add_f32 v5, v5, v21
    v_add_f32 v6, v6, v21
    v_add_f32 v5, v5, v40
    v_add_f32 v6, v6, v41
    v_cvt_pk_bf16_f32 v18, v5, v6
    v_lshlrev_b32 v5, 16, v19
    v_and_b32 v6, 0xffff0000, v19
    v_add_f32 v5, v5, v21
    v_add_f32 v6, v6, v21
    v_add_f32 v5, v5, v42
    v_add_f32 v6, v6, v43
    v_cvt_pk_bf16_f32 v19, v5, v6
    buffer_store_dwordx4 v[16:19], v23, s[56:59], 0 offen
g4_end:
    s_endpgm
mega_end:
.section .rodata,"a"
.p2align 6
.amdhsa_kernel sequential_preLN__linear_kernel_hedgehog__mixer_token_mlp__prompt_kernel
  .amdhsa_next_free_vgpr 256
  .amdhsa_next_free_sgpr 102
  .amdhsa_accum_offset 256
  .amdhsa_group_segment_fixed_size 0
  .amdhsa_kernarg_size 96
  .amdhsa_user_sgpr_count 2
  .amdhsa_user_sgpr_kernarg_segment_ptr 1
  .amdhsa_system_sgpr_workgroup_id_x 1
  .amdhsa_float_denorm_mode_32 3
.end_amdhsa_kernel
```
